```python
import torch

def _softmax(x, axis=-1):
    return torch.softmax(x, dim=axis)
def _gelu(x):
    return torch.nn.functional.gelu(x, approximate="tanh")
def _silu(x):
    return torch.nn.functional.silu(x)
def _sigmoid(x):
    return torch.sigmoid(x)
def _layernorm(x, axis=-1, eps=1e-5):
    m = x.mean(dim=axis, keepdim=True)
    v = x.var(dim=axis, keepdim=True, unbiased=False)
    return (x - m) / torch.sqrt(v + eps)
def _scatter_add(tgt, idx, src, axis=0):
    return tgt.clone().index_add_(axis, idx, src)
def _segment_sum(src, seg, n):
    out = torch.zeros((n,) + src.shape[1:], dtype=src.dtype)
    return out.index_add_(0, seg, src)
def _pad(x, pw):
    flat = tuple(v for pair in reversed(pw) for v in pair)
    return torch.nn.functional.pad(x, flat)

kernel_name = 'parallel_sum__sliding_local_dilated__geglu_ffn__prompt'

def setup_inputs():

    _w = (lambda a: (lambda t: t.to(torch.bfloat16) if t.is_floating_point() else t)(torch.as_tensor(a)))
    def _A_setup():
        B, S, D = 1, 2048, 640
        return {
            "x": _w((lambda *s: torch.randn(*s, dtype=torch.bfloat16) * 0.05)(B, S, D)),
            "wqkv": _w((lambda *s: torch.randn(*s, dtype=torch.bfloat16) * 0.05)(D, 3 * D)),
            "wo": _w((lambda *s: torch.randn(*s, dtype=torch.bfloat16) * 0.05)(D, D)),
        }
    _A_in = _A_setup()

    def _B_setup():
        B, S, D, F = 1, 2048, 640, 1728
        return {
            "x": _w((lambda *s: torch.randn(*s, dtype=torch.bfloat16) * 0.05)(B, S, D)),
            "w_gate": _w((lambda *s: torch.randn(*s, dtype=torch.bfloat16) * 0.05)(D, F)),
            "w_up": _w((lambda *s: torch.randn(*s, dtype=torch.bfloat16) * 0.05)(D, F)),
            "w_down": _w((lambda *s: torch.randn(*s, dtype=torch.bfloat16) * 0.05)(F, D)),
        }
    _B_in = _B_setup()

    return {
        "A_x": _A_in["x"],
        "A_wqkv": _A_in["wqkv"],
        "A_wo": _A_in["wo"],
        "B_x": _B_in["x"],
        "B_w_gate": _B_in["w_gate"],
        "B_w_up": _B_in["w_up"],
        "B_w_down": _B_in["w_down"],
    }

def reference(A_x, A_wqkv, A_wo, B_x, B_w_gate, B_w_up, B_w_down):
    def _A_ref(x, wqkv, wo):
        B, S, D = x.shape
        H = 32; Dh = D // H
        W, dil = 8, 2
        qkv = (lambda x, *d: x.permute(*d))((x @ wqkv).reshape(B, S, 3, H, Dh), 2, 0, 3, 1, 4)
        q, k, v = qkv[0], qkv[1], qkv[2]
        scale = Dh ** -0.5
        pos = torch.arange(S)
        off = torch.arange(W) * dil
        idx = pos[:, None] - off[None, :]
        mask = idx >= 0
        idx_c = torch.where(mask, idx, 0).reshape(-1)
        kg = k[:, :, idx_c, :].reshape(B, H, S, W, Dh)
        vg = v[:, :, idx_c, :].reshape(B, H, S, W, Dh)
        logits = torch.einsum("bhsd,bhswd->bhsw", q, kg) * scale
        logits = torch.where(mask[None, None, :, :], logits, -1e9)
        attn = _softmax(logits, axis=-1)
        o = torch.einsum("bhsw,bhswd->bhsd", attn, vg)
        return (lambda x, *d: x.permute(*d))(o, 0, 2, 1, 3).reshape(B, S, D) @ wo

    def _B_ref(x, w_gate, w_up, w_down):
        return (_gelu(x @ w_gate) * (x @ w_up)) @ w_down

    x = A_x
    xn = _layernorm(x, axis=-1)
    return x + _A_ref(xn, A_wqkv, A_wo) + _B_ref(xn, B_w_gate, B_w_up, B_w_down)
```

```asm
; @launch grid=(256,1,1) block=(512,1,1) lds=155648
.amdgcn_target "amdgcn-amd-amdhsa--gfx950"
.text
.globl parallel_sum__sliding_local_dilated__geglu_ffn__prompt_kernel
.p2align 8
.type parallel_sum__sliding_local_dilated__geglu_ffn__prompt_kernel,@function
parallel_sum__sliding_local_dilated__geglu_ffn__prompt_kernel:
    s_cmp_ge_u32 s2, 256
    s_cbranch_scc1 L_k1_end
    s_load_dwordx4 s[20:23], s[0:1], 64
    s_load_dwordx4 s[4:7], s[0:1], 0
    s_load_dwordx2 s[8:9], s[0:1], 16
    s_load_dwordx4 s[12:15], s[0:1], 32
    s_load_dwordx4 s[16:19], s[0:1], 48
    v_lshrrev_b32 v1, 6, v0
    v_and_b32 v2, 63, v0
    v_readfirstlane_b32 s56, v1
    v_lshlrev_b32 v3, 4, v2
    s_getreg_b32 s78, hwreg(HW_REG_XCC_ID)
    s_and_b32 s57, s2, 7
    s_lshr_b32 s58, s2, 3
    s_and_b32 s78, s78, 7
    s_lshl_b32 s66, s78, 5
    v_mov_b32 v17, s66
    v_mov_b32 v1, 0x40000000
    v_cmp_eq_u32 vcc, 0, v0
    v_mov_b32 v18, 1
    s_lshr_b32 s59, s56, 2
    s_and_b32 s60, s56, 3
    v_cndmask_b32 v17, v1, v17, vcc
    s_waitcnt lgkmcnt(0)
    s_mov_b32 s52, s20
    s_mov_b32 s53, s21
    s_mov_b32 s54, 0x100
    s_mov_b32 s55, 0x00020000
    s_cmp_lg_u32 s56, 0
    s_cbranch_scc1 L_tk_skip
    buffer_atomic_add v18, v17, s[52:55], 0 offen sc0
L_tk_skip:
    s_mov_b32 s24, s4
    s_mov_b32 s25, s5
    s_mov_b32 s26, 0x280000
    s_mov_b32 s27, 0x00020000
    s_add_u32 s32, s22, 0x400000
    s_addc_u32 s33, s23, 0
    s_mov_b32 s34, 0x960000
    s_mov_b32 s35, 0x00020000
    s_mov_b32 s36, s22
    s_mov_b32 s37, s23
    s_mov_b32 s38, 0x18000
    s_mov_b32 s39, 0x00020000
    s_mov_b32 s44, s16
    s_mov_b32 s45, s17
    s_mov_b32 s46, 0x21c000
    s_mov_b32 s47, 0x00020000
    s_mov_b32 s48, s8
    s_mov_b32 s49, s9
    s_mov_b32 s50, 0xc8000
    s_mov_b32 s51, 0x00020000
    s_cmp_eq_u32 s56, 7
    s_cbranch_scc1 L_tw7
    s_mov_b32 s40, s4
    s_mov_b32 s41, s5
    s_mov_b32 s42, 0x280000
    s_mov_b32 s43, 0x00020000
    s_cmp_eq_u32 s56, 1
    s_cselect_b32 s40, s6, s40
    s_cselect_b32 s41, s7, s41
    s_cselect_b32 s42, 2457600, s42
    s_cmp_eq_u32 s56, 2
    s_cselect_b32 s40, s12, s40
    s_cselect_b32 s41, s13, s41
    s_cselect_b32 s42, 2211840, s42
    s_cmp_eq_u32 s56, 3
    s_cselect_b32 s40, s14, s40
    s_cselect_b32 s41, s15, s41
    s_cselect_b32 s42, 2211840, s42
    s_cmp_eq_u32 s56, 4
    s_cselect_b32 s40, s16, s40
    s_cselect_b32 s41, s17, s41
    s_cselect_b32 s42, 2211840, s42
    s_cmp_eq_u32 s56, 5
    s_cselect_b32 s40, s8, s40
    s_cselect_b32 s41, s9, s41
    s_cselect_b32 s42, 819200, s42
    s_cmp_eq_u32 s56, 6
    s_cselect_b32 s40, s18, s40
    s_cselect_b32 s41, s19, s41
    s_cselect_b32 s42, 2621440, s42
    v_lshlrev_b32 v1, 16, v2
    buffer_load_dword v255, v1, s[40:43], 0 offen
    s_branch L_tw_done
L_tw7:
    s_mov_b32 s40, s22
    s_mov_b32 s41, s23
    s_mov_b32 s42, 0xd60000
    s_mov_b32 s43, 0x00020000
    s_and_b32 s66, s2, 1
    s_lshl_b32 s66, s66, 6
    v_add_u32 v1, s66, v2
    v_mul_u32_u24 v1, 76800, v1
    v_add_u32 v1, 4270080, v1
    v_cmp_eq_u32 vcc, 0, v2
    v_mov_b32 v255, 61440
    s_nop 0
    v_cndmask_b32 v1, v1, v255, vcc
    buffer_load_dword v255, v1, s[40:43], 0 offen
L_tw_done:
    s_lshl_b32 s66, s2, 3
    s_add_u32 s66, s66, s56
    s_mul_i32 s67, s66, 1280
    v_mov_b32 v9, 0x40000000
    v_add_u32 v1, s67, v3
    v_cmp_gt_u32 vcc, 40, v2
    s_lshl_b32 s67, s2, 7
    v_lshl_add_u32 v5, v2, 3, s67
    v_cndmask_b32 v30, v9, v1, vcc
    v_cmp_gt_u32 vcc, 16, v0
    s_cmp_ge_u32 s58, 6
    s_cselect_b32 s68, 2, 1
    v_cndmask_b32 v32, v9, v5, vcc
    s_cselect_b32 s67, 6, 0
    s_sub_u32 s66, s58, s67
    s_mul_i32 s69, s57, 6
    s_add_u32 s69, s69, s66
    s_sub_u32 s66, s58, 12
    s_lshl_b32 s66, s66, 3
    s_add_u32 s66, s66, s57
    s_mov_b32 s73, 0
    s_cmp_ge_u32 s66, 60
    s_cselect_b32 s73, 1, s73
    s_cselect_b32 s75, 12, 0
    s_sub_u32 s74, s66, s75
    s_cmp_ge_u32 s66, 66
    s_cselect_b32 s73, 2, s73
    s_cselect_b32 s75, 6, 0
    s_sub_u32 s74, s74, s75
    s_cmp_ge_u32 s58, 12
    s_cselect_b32 s68, s73, s68
    s_cselect_b32 s69, s74, s69
    s_cmp_ge_u32 s58, 21
    s_cselect_b32 s71, 1, 0
    s_cmp_eq_u32 s68, 1
    s_cselect_b32 s40, s12, s14
    s_cselect_b32 s41, s13, s15
    s_mov_b32 s72, 3648
    s_cselect_b32 s72, 1920, s72
    s_cmp_eq_u32 s68, 0
    s_cselect_b32 s40, s6, s40
    s_cselect_b32 s41, s7, s41
    s_cselect_b32 s72, 0, s72
    s_mov_b32 s73, 3456
    s_cselect_b32 s73, 3840, s73
    s_mul_i32 s42, s73, 640
    s_mov_b32 s43, 0x00020000
    v_lshrrev_b32 v1, 4, v2
    v_bfe_u32 v5, v2, 2, 2
    v_lshl_add_u32 v1, v1, 2, v5
    s_lshl_b32 s75, s56, 4
    v_add_u32 v1, s75, v1
    v_mul_lo_u32 v1, v1, s73
    v_and_b32 v5, 3, v2
    v_lshl_add_u32 v1, v5, 4, v1
    s_lshl_b32 s74, s69, 6
    s_cmp_eq_u32 s71, 1
    s_cselect_b32 s74, 0x40000000, s74
    v_add_u32 v31, s74, v1
    s_lshl_b32 s77, s73, 7
    s_lshl_b32 s75, s69, 5
    s_add_u32 s74, s72, s75
    s_lshl_b32 s74, s74, 2
    s_add_u32 s74, s74, 32768
    s_or_b32 s75, s71, s56
    s_cmp_eq_u32 s75, 0
    s_cselect_b32 s74, s74, 0x40000000
    v_lshl_add_u32 v1, v2, 2, s74
    v_cmp_gt_u32 vcc, 32, v2
    v_and_b32 v5, 15, v2
    v_lshlrev_b32 v6, 4, v5
    v_cndmask_b32 v33, v9, v1, vcc
    v_cmp_gt_u32 vcc, 8, v5
    s_lshl_b32 s74, s56, 7
    s_add_u32 s74, s74, 148480
    v_add_u32 v7, s74, v6
    v_add_u32 v6, 149504, v6
    v_cndmask_b32 v35, v6, v7, vcc
    v_cmp_eq_u32 vcc, 0, v5
    v_mov_b32 v6, 0x3f80
    v_cmp_eq_u32 s[68:69], 1, v5
    v_cndmask_b32 v240, 0, v6, vcc
    v_mov_b32 v6, 0x3f800000
    v_cndmask_b32 v240, v240, v6, s[68:69]
    v_cmp_eq_u32 vcc, 2, v5
    v_mov_b32 v6, 0x3f80
    v_cmp_eq_u32 s[68:69], 3, v5
    v_cndmask_b32 v241, 0, v6, vcc
    v_mov_b32 v6, 0x3f800000
    v_cndmask_b32 v241, v241, v6, s[68:69]
    v_cmp_eq_u32 vcc, 4, v5
    v_mov_b32 v6, 0x3f80
    v_cmp_eq_u32 s[68:69], 5, v5
    v_cndmask_b32 v242, 0, v6, vcc
    v_mov_b32 v6, 0x3f800000
    v_cndmask_b32 v242, v242, v6, s[68:69]
    v_cmp_eq_u32 vcc, 6, v5
    v_mov_b32 v6, 0x3f80
    v_cmp_eq_u32 s[68:69], 7, v5
    v_cndmask_b32 v243, 0, v6, vcc
    v_mov_b32 v6, 0x3f800000
    v_cndmask_b32 v243, v243, v6, s[68:69]
    v_and_b32 v5, 7, v2
    v_bfe_u32 v6, v2, 3, 2
    v_lshlrev_b32 v6, 2, v6
    v_lshl_add_u32 v5, v5, 4, v6
    v_cmp_eq_u32 vcc, 0, v0
    v_add_u32 v29, 148480, v5
    s_lshl_b32 s76, s77, 1
    v_mov_b32 v5, 240
    v_cndmask_b32 v34, v9, v5, vcc
    s_add_u32 s75, s76, s77
    s_lshl_b32 s74, s77, 2
    v_lshrrev_b32 v4, 4, v2
    v_lshlrev_b32 v5, 10, v4
    v_bfe_u32 v6, v2, 2, 2
    v_lshl_add_u32 v5, v6, 7, v5
    v_and_b32 v6, 3, v2
    v_lshl_add_u32 v5, v6, 3, v5
    v_bfe_u32 v6, v2, 3, 2
    v_bfe_u32 v26, v2, 4, 1
    v_lshrrev_b32 v7, 3, v2
    v_bfe_u32 v8, v2, 1, 2
    v_xor_b32 v8, v8, v26
    v_and_b32 v9, 1, v2
    v_and_b32 v10, 7, v2
    v_lshrrev_b32 v11, 4, v2
    v_xor_b32 v10, v10, v11
    v_lshlrev_b32 v10, 4, v10
    v_mul_u32_u24 v11, 1280, v7
    v_add_u32 v10, v10, v11
    v_bfe_u32 v15, v2, 1, 3
    v_xor_b32 v15, v15, v4
    v_lshlrev_b32 v15, 4, v15
    v_and_b32 v16, 7, v2
    v_lshl_add_u32 v15, v16, 7, v15
    v_bfe_u32 v16, v2, 3, 1
    v_lshl_add_u32 v15, v16, 10, v15
    s_cmp_lg_u32 s56, 0
    s_cbranch_scc1 L_tk_done
    s_mov_b32 s67, 0
    s_waitcnt vmcnt(1)
L_tk_loop:
    v_readfirstlane_b32 s68, v18
    s_add_u32 s67, s67, 1
    s_nop 2
    s_cmp_lt_u32 s68, 32
    s_cbranch_scc1 L_tk_got
    s_cmp_ge_u32 s67, 16
    s_cbranch_scc1 L_tk_got
    s_add_u32 s78, s78, 1
    s_and_b32 s78, s78, 7
    s_lshl_b32 s68, s78, 5
    v_writelane_b32 v17, s68, 0
    v_mov_b32 v18, 1
    buffer_atomic_add v18, v17, s[52:55], 0 offen sc0
    s_waitcnt vmcnt(0)
    s_branch L_tk_loop
L_tk_got:
    s_and_b32 s68, s68, 31
    s_lshl_b32 s68, s68, 3
    s_add_u32 s68, s68, s78
    v_mov_b32 v17, 150524
    v_mov_b32 v18, s68
    ds_write_b32 v17, v18
    s_waitcnt lgkmcnt(0)
L_tk_done:
    s_barrier
    v_mov_b32 v1, 150524
    ds_read_b32 v1, v1
    s_waitcnt lgkmcnt(0)
    v_readfirstlane_b32 s2, v1
    s_nop 3
    s_and_b32 s57, s2, 7
    s_lshr_b32 s58, s2, 3
    s_lshl_b32 s66, s2, 7
    s_add_u32 s66, s66, 65536
    v_mov_b32 v17, s66
    v_mov_b32 v1, 0x40000000
    v_cmp_eq_u32 vcc, 0, v0
    v_mov_b32 v18, 0
    s_nop 0
    v_cndmask_b32 v17, v1, v17, vcc
    buffer_store_dword v18, v17, s[36:39], 0 offen sc1
    s_cmp_lt_u32 s58, 13
    s_cbranch_scc1 L_k1_att
    s_cmp_lt_u32 s58, 31
    s_cbranch_scc0 L_k1_extra
    s_sub_u32 s58, s58, 13
    s_lshl_b32 s66, s57, 1
    s_add_u32 s66, s66, s58
    s_sub_u32 s66, s66, 16
    s_cmp_lt_u32 s58, 16
    s_cselect_b32 s61, s57, 8
    s_cselect_b32 s62, s58, s66
    s_cmp_lt_u32 s56, 4
    s_cselect_b32 s28, s12, s14
    s_cselect_b32 s29, s13, s15
    s_mov_b32 s30, 2211840
    s_mov_b32 s31, 0x00020000
    s_add_u32 s66, s62, s61
    s_cmp_ge_u32 s66, 10
    s_cselect_b32 s67, 10, 0
    s_sub_u32 s66, s66, s67
    s_cmp_ge_u32 s66, 10
    s_cselect_b32 s67, 10, 0
    s_sub_u32 s66, s66, s67
    s_and_b32 s66, s66, 14
    s_lshl_b32 s64, s66, 7
    s_mul_i32 s65, s66, 221184
    s_mul_i32 s70, s61, 384
    v_mul_u32_u24 v16, 3456, v7
    v_add_u32 v16, s70, v16
    v_lshlrev_b32 v1, 5, v8
    v_lshl_add_u32 v1, v9, 4, v1
    s_mul_i32 s66, s56, 3
    s_add_u32 s66, s66, 0
    s_and_b32 s67, s66, 3
    s_lshr_b32 s68, s66, 2
    s_cmp_ge_u32 s68, 3
    s_cselect_b32 s69, 3, 0
    s_sub_u32 s68, s68, s69
    s_and_b32 s69, s67, 1
    s_lshl_b32 s69, s69, 6
    v_xor_b32 v12, s69, v1
    s_mul_i32 s67, s67, 27648
    s_lshl_b32 s68, s68, 7
    s_add_u32 s67, s67, s68
    v_add3_u32 v12, v12, v16, s67
    s_mul_i32 s66, s56, 3
    s_add_u32 s66, s66, 1
    s_and_b32 s67, s66, 3
    s_lshr_b32 s68, s66, 2
    s_cmp_ge_u32 s68, 3
    s_cselect_b32 s69, 3, 0
    s_sub_u32 s68, s68, s69
    s_and_b32 s69, s67, 1
    s_lshl_b32 s69, s69, 6
    v_xor_b32 v13, s69, v1
    s_mul_i32 s67, s67, 27648
    s_lshl_b32 s68, s68, 7
    s_add_u32 s67, s67, s68
    v_add3_u32 v13, v13, v16, s67
    s_mul_i32 s66, s56, 3
    s_add_u32 s66, s66, 2
    s_and_b32 s67, s66, 3
    s_lshr_b32 s68, s66, 2
    s_cmp_ge_u32 s68, 3
    s_cselect_b32 s69, 3, 0
    s_sub_u32 s68, s68, s69
    s_and_b32 s69, s67, 1
    s_lshl_b32 s69, s69, 6
    v_xor_b32 v14, s69, v1
    s_mul_i32 s67, s67, 27648
    s_lshl_b32 s68, s68, 7
    s_add_u32 s67, s67, s68
    v_add3_u32 v14, v14, v16, s67
    s_lshl_b32 s66, s62, 3
    s_add_u32 s66, s66, s56
    s_mul_i32 s66, s66, 20480
    v_xor_b32 v11, 64, v10
    v_add_u32 v10, s66, v10
    s_add_u32 s66, s66, 10240
    v_add_u32 v11, s66, v11
    s_mul_i32 s3, s56, 3072
    s_lshl_b32 s79, s56, 11
    s_lshl_b32 s66, s59, 13
    s_add_u32 s66, s66, 98304
    v_xor_b32 v16, 64, v15
    v_add_u32 v16, s66, v16
    v_add_u32 v15, s66, v15
    s_mul_i32 s66, s60, 3
    s_add_u32 s66, s66, 0
    s_and_b32 s67, s66, 3
    s_lshr_b32 s66, s66, 2
    s_lshl_b32 s66, s66, 12
    v_xor_b32 v19, s67, v6
    v_lshl_add_u32 v19, v19, 5, v5
    v_add_u32 v19, s66, v19
    v_add_u32 v22, 0xc000, v19
    s_mul_i32 s66, s60, 3
    s_add_u32 s66, s66, 1
    s_and_b32 s67, s66, 3
    s_lshr_b32 s66, s66, 2
    s_lshl_b32 s66, s66, 12
    v_xor_b32 v20, s67, v6
    v_lshl_add_u32 v20, v20, 5, v5
    v_add_u32 v20, s66, v20
    v_add_u32 v23, 0xc000, v20
    s_mul_i32 s66, s60, 3
    s_add_u32 s66, s66, 2
    s_and_b32 s67, s66, 3
    s_lshr_b32 s66, s66, 2
    s_lshl_b32 s66, s66, 12
    v_xor_b32 v21, s67, v6
    v_lshl_add_u32 v21, v21, 5, v5
    v_add_u32 v21, s66, v21
    v_add_u32 v24, 0xc000, v21
    s_add_u32 m0, s3, 0x0
    s_nop 0
    buffer_load_dwordx4 v12, s[28:31], s65 offen lds
    s_add_u32 m0, s3, 0x400
    s_nop 0
    buffer_load_dwordx4 v13, s[28:31], s65 offen lds
    s_add_u32 m0, s3, 0x800
    s_nop 0
    buffer_load_dwordx4 v14, s[28:31], s65 offen lds
    s_add_u32 s65, s65, 110592
    s_cmp_ge_u32 s65, 2211840
    s_cselect_b32 s65, 0, s65
    s_add_u32 m0, s79, 0x18000
    s_nop 0
    buffer_load_dwordx4 v10, s[24:27], s64 offen lds
    s_add_u32 m0, s79, 0x18400
    s_nop 0
    buffer_load_dwordx4 v11, s[24:27], s64 offen lds
    s_add_u32 s64, s64, 128
    s_cmp_ge_u32 s64, 1280
    s_cselect_b32 s64, 0, s64
    s_add_u32 m0, s3, 0x6000
    s_nop 0
    buffer_load_dwordx4 v12, s[28:31], s65 offen lds
    s_add_u32 m0, s3, 0x6400
    s_nop 0
    buffer_load_dwordx4 v13, s[28:31], s65 offen lds
    s_add_u32 m0, s3, 0x6800
    s_nop 0
    buffer_load_dwordx4 v14, s[28:31], s65 offen lds
    s_add_u32 s65, s65, 110592
    s_cmp_ge_u32 s65, 2211840
    s_cselect_b32 s65, 0, s65
    s_add_u32 m0, s79, 0x1c000
    s_nop 0
    buffer_load_dwordx4 v10, s[24:27], s64 offen lds
    s_add_u32 m0, s79, 0x1c400
    s_nop 0
    buffer_load_dwordx4 v11, s[24:27], s64 offen lds
    s_add_u32 s64, s64, 128
    s_cmp_ge_u32 s64, 1280
    s_cselect_b32 s64, 0, s64
    buffer_load_dwordx4 v[36:39], v30, s[24:27], 0 offen
    buffer_load_dwordx4 v[40:43], v30, s[24:27], 0 offen offset:640
    buffer_load_dwordx4 v[48:51], v31, s[40:43], s77 offen
    v_and_b32 v25, 1, v4
    s_mov_b32 s66, 76800
    v_mul_lo_u32 v25, v25, s66
    v_lshrrev_b32 v1, 1, v4
    v_lshl_add_u32 v25, v1, 8, v25
    v_and_b32 v1, 15, v2
    v_lshl_add_u32 v25, v1, 4, v25
    s_mul_i32 s66, s59, 307200
    s_mul_i32 s67, s60, 1536
    s_add_u32 s66, s66, s67
    v_add_u32 v25, s66, v25
    s_mul_i32 s70, s62, 614400
    s_mul_i32 s67, s61, 6144
    s_add_u32 s70, s70, s67
    s_add_u32 s70, s70, 20480
    s_add_u32 s71, s70, 153600
    s_lshl_b32 s66, s62, 1
    s_add_u32 s66, s66, s59
    s_lshl_b32 s66, s66, 10
    v_and_b32 v26, 7, v2
    v_lshl_add_u32 v26, v26, 3, s66
    v_bfe_u32 v1, v2, 3, 1
    v_lshl_add_u32 v26, v1, 7, v26
    v_cmp_gt_u32 vcc, 48, v2
    v_mov_b32 v1, 0x40000000
    s_nop 0
    v_cndmask_b32 v27, v1, v3, vcc
    s_mul_i32 s72, s61, 768
    s_add_u32 s72, s72, 40448
    s_add_u32 s73, s72, 6912
    s_mul_i32 s66, s60, 192
    s_add_u32 s66, s66, 150528
    v_lshl_add_u32 v28, v4, 4, s66
    s_waitcnt vmcnt(5)
    s_barrier
    ds_read_b64_tr_b16 v[176:177], v19 offset:0
    ds_read_b64_tr_b16 v[178:179], v19 offset:512
    ds_read_b64_tr_b16 v[180:181], v20 offset:0
    ds_read_b64_tr_b16 v[182:183], v20 offset:512
    ds_read_b64_tr_b16 v[184:185], v21 offset:0
    ds_read_b64_tr_b16 v[186:187], v21 offset:512
    ds_read_b64_tr_b16 v[188:189], v19 offset:12288
    ds_read_b64_tr_b16 v[190:191], v19 offset:12800
    ds_read_b64_tr_b16 v[192:193], v20 offset:12288
    ds_read_b64_tr_b16 v[194:195], v20 offset:12800
    ds_read_b64_tr_b16 v[196:197], v21 offset:12288
    ds_read_b64_tr_b16 v[198:199], v21 offset:12800
    ds_read_b128 v[160:163], v15 offset:0
    ds_read_b128 v[164:167], v15 offset:2048
    ds_read_b128 v[168:171], v15 offset:4096
    ds_read_b128 v[172:175], v15 offset:6144
    s_waitcnt vmcnt(2) lgkmcnt(0)
    s_barrier
    v_mfma_f32_16x16x32_bf16 v[64:67], v[176:179], v[160:163], 0
    s_add_u32 m0, s3, 0xc000
    ds_read_b64_tr_b16 v[216:217], v19 offset:24576
    buffer_load_dwordx4 v12, s[28:31], s65 offen lds
    v_mfma_f32_16x16x32_bf16 v[68:71], v[180:183], v[160:163], 0
    s_add_u32 m0, s3, 0xc400
    ds_read_b64_tr_b16 v[218:219], v19 offset:25088
    buffer_load_dwordx4 v13, s[28:31], s65 offen lds
    v_mfma_f32_16x16x32_bf16 v[72:75], v[184:187], v[160:163], 0
    s_add_u32 m0, s3, 0xc800
    ds_read_b64_tr_b16 v[220:221], v20 offset:24576
    buffer_load_dwordx4 v14, s[28:31], s65 offen lds
    s_add_u32 s65, s65, 110592
    s_cmp_ge_u32 s65, 2211840
    s_cselect_b32 s65, 0, s65
    v_mfma_f32_16x16x32_bf16 v[76:79], v[188:191], v[160:163], 0
    s_add_u32 m0, s3, 0x12000
    ds_read_b64_tr_b16 v[222:223], v20 offset:25088
    buffer_load_dwordx4 v12, s[28:31], s65 offen lds
    v_mfma_f32_16x16x32_bf16 v[80:83], v[192:195], v[160:163], 0
    s_add_u32 m0, s3, 0x12400
    ds_read_b64_tr_b16 v[224:225], v21 offset:24576
    buffer_load_dwordx4 v13, s[28:31], s65 offen lds
    v_mfma_f32_16x16x32_bf16 v[84:87], v[196:199], v[160:163], 0
    s_add_u32 m0, s3, 0x12800
    ds_read_b64_tr_b16 v[226:227], v21 offset:25088
    buffer_load_dwordx4 v14, s[28:31], s65 offen lds
    s_add_u32 s65, s65, 110592
    s_cmp_ge_u32 s65, 2211840
    s_cselect_b32 s65, 0, s65
    v_mfma_f32_16x16x32_bf16 v[88:91], v[176:179], v[164:167], 0
    s_add_u32 m0, s79, 0x20000
    ds_read_b64_tr_b16 v[228:229], v19 offset:36864
    buffer_load_dwordx4 v10, s[24:27], s64 offen lds
    v_mfma_f32_16x16x32_bf16 v[92:95], v[180:183], v[164:167], 0
    ds_read_b64_tr_b16 v[230:231], v19 offset:37376
    v_mfma_f32_16x16x32_bf16 v[96:99], v[184:187], v[164:167], 0
    ds_read_b64_tr_b16 v[232:233], v20 offset:36864
    v_mfma_f32_16x16x32_bf16 v[100:103], v[188:191], v[164:167], 0
    ds_read_b64_tr_b16 v[234:235], v20 offset:37376
    v_mfma_f32_16x16x32_bf16 v[104:107], v[192:195], v[164:167], 0
    ds_read_b64_tr_b16 v[236:237], v21 offset:36864
    v_mfma_f32_16x16x32_bf16 v[108:111], v[196:199], v[164:167], 0
    ds_read_b64_tr_b16 v[238:239], v21 offset:37376
    v_mfma_f32_16x16x32_bf16 v[112:115], v[176:179], v[168:171], 0
    ds_read_b128 v[200:203], v16 offset:0
    v_mfma_f32_16x16x32_bf16 v[116:119], v[180:183], v[168:171], 0
    ds_read_b128 v[204:207], v16 offset:2048
    v_mfma_f32_16x16x32_bf16 v[120:123], v[184:187], v[168:171], 0
    ds_read_b128 v[208:211], v16 offset:4096
    v_mfma_f32_16x16x32_bf16 v[124:127], v[188:191], v[168:171], 0
    ds_read_b128 v[212:215], v16 offset:6144
    v_mfma_f32_16x16x32_bf16 v[128:131], v[192:195], v[168:171], 0
    buffer_load_dwordx4 v[52:55], v31, s[40:43], s76 offen
    v_mfma_f32_16x16x32_bf16 v[132:135], v[196:199], v[168:171], 0
    buffer_load_dwordx4 v[44:47], v31, s[40:43], 0 offen
    v_mfma_f32_16x16x32_bf16 v[136:139], v[176:179], v[172:175], 0
    buffer_load_dwordx4 v[56:59], v31, s[40:43], s75 offen
    v_mfma_f32_16x16x32_bf16 v[140:143], v[180:183], v[172:175], 0
    buffer_load_dwordx4 v[60:63], v31, s[40:43], s74 offen
    v_mfma_f32_16x16x32_bf16 v[144:147], v[184:187], v[172:175], 0
    v_mfma_f32_16x16x32_bf16 v[148:151], v[188:191], v[172:175], 0
    v_mfma_f32_16x16x32_bf16 v[152:155], v[192:195], v[172:175], 0
    v_mfma_f32_16x16x32_bf16 v[156:159], v[196:199], v[172:175], 0
    s_waitcnt vmcnt(4) lgkmcnt(0)
    s_barrier
    v_mfma_f32_16x16x32_bf16 v[64:67], v[216:219], v[200:203], v[64:67]
    s_add_u32 m0, s3, 0x0
    ds_read_b64_tr_b16 v[176:177], v22 offset:0
    buffer_load_dwordx4 v12, s[28:31], s65 offen lds
    v_mfma_f32_16x16x32_bf16 v[68:71], v[220:223], v[200:203], v[68:71]
    s_add_u32 m0, s3, 0x400
    ds_read_b64_tr_b16 v[178:179], v22 offset:512
    buffer_load_dwordx4 v13, s[28:31], s65 offen lds
    v_mfma_f32_16x16x32_bf16 v[72:75], v[224:227], v[200:203], v[72:75]
    s_add_u32 m0, s3, 0x800
    ds_read_b64_tr_b16 v[180:181], v23 offset:0
    buffer_load_dwordx4 v14, s[28:31], s65 offen lds
    s_add_u32 s65, s65, 110592
    s_cmp_ge_u32 s65, 2211840
    s_cselect_b32 s65, 0, s65
    v_mfma_f32_16x16x32_bf16 v[76:79], v[228:231], v[200:203], v[76:79]
    s_add_u32 m0, s3, 0x6000
    ds_read_b64_tr_b16 v[182:183], v23 offset:512
    buffer_load_dwordx4 v12, s[28:31], s65 offen lds
    v_mfma_f32_16x16x32_bf16 v[80:83], v[232:235], v[200:203], v[80:83]
    s_add_u32 m0, s3, 0x6400
    ds_read_b64_tr_b16 v[184:185], v24 offset:0
    buffer_load_dwordx4 v13, s[28:31], s65 offen lds
    v_mfma_f32_16x16x32_bf16 v[84:87], v[236:239], v[200:203], v[84:87]
    s_add_u32 m0, s3, 0x6800
    ds_read_b64_tr_b16 v[186:187], v24 offset:512
    buffer_load_dwordx4 v14, s[28:31], s65 offen lds
    s_add_u32 s65, s65, 110592
    s_cmp_ge_u32 s65, 2211840
    s_cselect_b32 s65, 0, s65
    v_mfma_f32_16x16x32_bf16 v[88:91], v[216:219], v[204:207], v[88:91]
    s_add_u32 m0, s79, 0x20400
    ds_read_b64_tr_b16 v[188:189], v22 offset:12288
    buffer_load_dwordx4 v11, s[24:27], s64 offen lds
    s_add_u32 s64, s64, 128
    s_cmp_ge_u32 s64, 1280
    s_cselect_b32 s64, 0, s64
    v_mfma_f32_16x16x32_bf16 v[92:95], v[220:223], v[204:207], v[92:95]
    ds_read_b64_tr_b16 v[190:191], v22 offset:12800
    v_mfma_f32_16x16x32_bf16 v[96:99], v[224:227], v[204:207], v[96:99]
    ds_read_b64_tr_b16 v[192:193], v23 offset:12288
    v_mfma_f32_16x16x32_bf16 v[100:103], v[228:231], v[204:207], v[100:103]
    ds_read_b64_tr_b16 v[194:195], v23 offset:12800
    v_mfma_f32_16x16x32_bf16 v[104:107], v[232:235], v[204:207], v[104:107]
    ds_read_b64_tr_b16 v[196:197], v24 offset:12288
    v_mfma_f32_16x16x32_bf16 v[108:111], v[236:239], v[204:207], v[108:111]
    ds_read_b64_tr_b16 v[198:199], v24 offset:12800
    v_mfma_f32_16x16x32_bf16 v[112:115], v[216:219], v[208:211], v[112:115]
    ds_read_b128 v[160:163], v15 offset:16384
    v_mfma_f32_16x16x32_bf16 v[116:119], v[220:223], v[208:211], v[116:119]
    ds_read_b128 v[164:167], v15 offset:18432
    v_mfma_f32_16x16x32_bf16 v[120:123], v[224:227], v[208:211], v[120:123]
    ds_read_b128 v[168:171], v15 offset:20480
    v_mfma_f32_16x16x32_bf16 v[124:127], v[228:231], v[208:211], v[124:127]
    ds_read_b128 v[172:175], v15 offset:22528
    v_mfma_f32_16x16x32_bf16 v[128:131], v[232:235], v[208:211], v[128:131]
    v_mfma_f32_16x16x32_bf16 v[132:135], v[236:239], v[208:211], v[132:135]
    v_mfma_f32_16x16x32_bf16 v[136:139], v[216:219], v[212:215], v[136:139]
    v_mfma_f32_16x16x32_bf16 v[140:143], v[220:223], v[212:215], v[140:143]
    v_mfma_f32_16x16x32_bf16 v[144:147], v[224:227], v[212:215], v[144:147]
    v_mfma_f32_16x16x32_bf16 v[148:151], v[228:231], v[212:215], v[148:151]
    v_mfma_f32_16x16x32_bf16 v[152:155], v[232:235], v[212:215], v[152:155]
    v_mfma_f32_16x16x32_bf16 v[156:159], v[236:239], v[212:215], v[156:159]
    s_waitcnt vmcnt(0) lgkmcnt(0)
    s_barrier
    v_mfma_f32_16x16x32_bf16 v[64:67], v[176:179], v[160:163], v[64:67]
    s_add_u32 m0, s3, 0xc000
    ds_read_b64_tr_b16 v[216:217], v22 offset:24576
    buffer_load_dwordx4 v12, s[28:31], s65 offen lds
    s_add_u32 m0, s3, 0xc400
    ds_read_b64_tr_b16 v[218:219], v22 offset:25088
    buffer_load_dwordx4 v13, s[28:31], s65 offen lds
    s_add_u32 m0, s3, 0xc800
    ds_read_b64_tr_b16 v[220:221], v23 offset:24576
    buffer_load_dwordx4 v14, s[28:31], s65 offen lds
    s_add_u32 s65, s65, 110592
    s_cmp_ge_u32 s65, 2211840
    s_cselect_b32 s65, 0, s65
    v_mfma_f32_16x16x32_bf16 v[68:71], v[180:183], v[160:163], v[68:71]
    s_add_u32 m0, s79, 0x18000
    ds_read_b64_tr_b16 v[222:223], v23 offset:25088
    buffer_load_dwordx4 v10, s[24:27], s64 offen lds
    s_add_u32 m0, s79, 0x18400
    ds_read_b64_tr_b16 v[224:225], v24 offset:24576
    buffer_load_dwordx4 v11, s[24:27], s64 offen lds
    s_add_u32 s64, s64, 128
    s_cmp_ge_u32 s64, 1280
    s_cselect_b32 s64, 0, s64
    ds_read_b64_tr_b16 v[226:227], v24 offset:25088
    v_mfma_f32_16x16x32_bf16 v[72:75], v[184:187], v[160:163], v[72:75]
    ds_read_b64_tr_b16 v[228:229], v22 offset:36864
    ds_read_b64_tr_b16 v[230:231], v22 offset:37376
    ds_read_b64_tr_b16 v[232:233], v23 offset:36864
    v_mfma_f32_16x16x32_bf16 v[76:79], v[188:191], v[160:163], v[76:79]
    ds_read_b64_tr_b16 v[234:235], v23 offset:37376
    ds_read_b64_tr_b16 v[236:237], v24 offset:36864
    ds_read_b64_tr_b16 v[238:239], v24 offset:37376
    v_mfma_f32_16x16x32_bf16 v[80:83], v[192:195], v[160:163], v[80:83]
    ds_read_b128 v[200:203], v16 offset:16384
    ds_read_b128 v[204:207], v16 offset:18432
    ds_read_b128 v[208:211], v16 offset:20480
    v_mfma_f32_16x16x32_bf16 v[84:87], v[196:199], v[160:163], v[84:87]
    ds_read_b128 v[212:215], v16 offset:22528
    v_mfma_f32_16x16x32_bf16 v[244:247], v[44:47], v[240:243], 0
    v_mfma_f32_16x16x32_bf16 v[244:247], v[48:51], v[240:243], v[244:247]
    v_mfma_f32_16x16x32_bf16 v[88:91], v[176:179], v[164:167], v[88:91]
    v_mfma_f32_16x16x32_bf16 v[244:247], v[52:55], v[240:243], v[244:247]
    v_mfma_f32_16x16x32_bf16 v[244:247], v[56:59], v[240:243], v[244:247]
    v_mfma_f32_16x16x32_bf16 v[244:247], v[60:63], v[240:243], v[244:247]
    v_mfma_f32_16x16x32_bf16 v[92:95], v[180:183], v[164:167], v[92:95]
    v_mov_b32 v252, 0x3f803f80
    v_dot2_f32_bf16 v248, v36, v252, 0
    v_dot2_f32_bf16 v250, v36, v36, 0
    v_mfma_f32_16x16x32_bf16 v[96:99], v[184:187], v[164:167], v[96:99]
    v_dot2_f32_bf16 v249, v37, v252, 0
    v_dot2_f32_bf16 v251, v37, v37, 0
    v_dot2_f32_bf16 v248, v38, v252, v248
    v_mfma_f32_16x16x32_bf16 v[100:103], v[188:191], v[164:167], v[100:103]
    v_dot2_f32_bf16 v250, v38, v38, v250
    v_dot2_f32_bf16 v249, v39, v252, v249
    v_dot2_f32_bf16 v251, v39, v39, v251
    v_mfma_f32_16x16x32_bf16 v[104:107], v[192:195], v[164:167], v[104:107]
    v_dot2_f32_bf16 v248, v40, v252, v248
    v_dot2_f32_bf16 v250, v40, v40, v250
    v_dot2_f32_bf16 v249, v41, v252, v249
    v_mfma_f32_16x16x32_bf16 v[108:111], v[196:199], v[164:167], v[108:111]
    v_dot2_f32_bf16 v251, v41, v41, v251
    v_dot2_f32_bf16 v248, v42, v252, v248
    v_dot2_f32_bf16 v250, v42, v42, v250
    v_mfma_f32_16x16x32_bf16 v[112:115], v[176:179], v[168:171], v[112:115]
    v_dot2_f32_bf16 v249, v43, v252, v249
    v_dot2_f32_bf16 v251, v43, v43, v251
    s_nop 2
    v_mfma_f32_16x16x32_bf16 v[116:119], v[180:183], v[168:171], v[116:119]
    v_add_f32 v248, v248, v249
    v_add_f32 v250, v250, v251
    s_nop 1
    v_mfma_f32_16x16x32_bf16 v[120:123], v[184:187], v[168:171], v[120:123]
    v_add_f32_dpp v248, v248, v248 row_ror:8 row_mask:0xf bank_mask:0xf
    v_add_f32_dpp v250, v250, v250 row_ror:8 row_mask:0xf bank_mask:0xf
    s_nop 1
    v_mfma_f32_16x16x32_bf16 v[124:127], v[188:191], v[168:171], v[124:127]
    v_add_f32_dpp v248, v248, v248 row_ror:4 row_mask:0xf bank_mask:0xf
    v_add_f32_dpp v250, v250, v250 row_ror:4 row_mask:0xf bank_mask:0xf
    v_mfma_f32_16x16x32_bf16 v[128:131], v[192:195], v[168:171], v[128:131]
    s_nop 1
    v_add_f32_dpp v248, v248, v248 row_ror:2 row_mask:0xf bank_mask:0xf
    v_mfma_f32_16x16x32_bf16 v[132:135], v[196:199], v[168:171], v[132:135]
    v_add_f32_dpp v250, v250, v250 row_ror:2 row_mask:0xf bank_mask:0xf
    s_nop 1
    v_mfma_f32_16x16x32_bf16 v[136:139], v[176:179], v[172:175], v[136:139]
    v_add_f32_dpp v248, v248, v248 row_ror:1 row_mask:0xf bank_mask:0xf
    v_add_f32_dpp v250, v250, v250 row_ror:1 row_mask:0xf bank_mask:0xf
    v_mfma_f32_16x16x32_bf16 v[140:143], v[180:183], v[172:175], v[140:143]
    v_mov_b32 v249, v248
    v_mov_b32 v251, v250
    v_mfma_f32_16x16x32_bf16 v[144:147], v[184:187], v[172:175], v[144:147]
    v_mov_b32 v44, v244
    v_mov_b32 v45, v245
    v_mfma_f32_16x16x32_bf16 v[148:151], v[188:191], v[172:175], v[148:151]
    v_mov_b32 v46, v246
    v_mov_b32 v47, v247
    v_mfma_f32_16x16x32_bf16 v[152:155], v[192:195], v[172:175], v[152:155]
    s_nop 1
    v_permlane16_swap_b32 v248, v249
    v_mfma_f32_16x16x32_bf16 v[156:159], v[196:199], v[172:175], v[156:159]
    v_permlane16_swap_b32 v250, v251
    v_permlane16_swap_b32 v244, v44
    s_waitcnt vmcnt(5) lgkmcnt(0)
    s_barrier
    v_mfma_f32_16x16x32_bf16 v[64:67], v[216:219], v[200:203], v[64:67]
    s_add_u32 m0, s3, 0x12000
    ds_read_b64_tr_b16 v[176:177], v19 offset:0
    buffer_load_dwordx4 v12, s[28:31], s65 offen lds
    s_add_u32 m0, s3, 0x12400
    ds_read_b64_tr_b16 v[178:179], v19 offset:512
    buffer_load_dwordx4 v13, s[28:31], s65 offen lds
    s_add_u32 m0, s3, 0x12800
    ds_read_b64_tr_b16 v[180:181], v20 offset:0
    buffer_load_dwordx4 v14, s[28:31], s65 offen lds
    s_add_u32 s65, s65, 110592
    s_cmp_ge_u32 s65, 2211840
    s_cselect_b32 s65, 0, s65
    v_mfma_f32_16x16x32_bf16 v[68:71], v[220:223], v[200:203], v[68:71]
    s_add_u32 m0, s79, 0x1c000
    ds_read_b64_tr_b16 v[182:183], v20 offset:512
    buffer_load_dwordx4 v10, s[24:27], s64 offen lds
    ds_read_b64_tr_b16 v[184:185], v21 offset:0
    ds_read_b64_tr_b16 v[186:187], v21 offset:512
    v_mfma_f32_16x16x32_bf16 v[72:75], v[224:227], v[200:203], v[72:75]
    ds_read_b64_tr_b16 v[188:189], v19 offset:12288
    ds_read_b64_tr_b16 v[190:191], v19 offset:12800
    ds_read_b64_tr_b16 v[192:193], v20 offset:12288
    v_mfma_f32_16x16x32_bf16 v[76:79], v[228:231], v[200:203], v[76:79]
    ds_read_b64_tr_b16 v[194:195], v20 offset:12800
    ds_read_b64_tr_b16 v[196:197], v21 offset:12288
    ds_read_b64_tr_b16 v[198:199], v21 offset:12800
    v_mfma_f32_16x16x32_bf16 v[80:83], v[232:235], v[200:203], v[80:83]
    ds_read_b128 v[160:163], v15 offset:32768
    ds_read_b128 v[164:167], v15 offset:34816
    ds_read_b128 v[168:171], v15 offset:36864
    v_mfma_f32_16x16x32_bf16 v[84:87], v[236:239], v[200:203], v[84:87]
    ds_read_b128 v[172:175], v15 offset:38912
    v_permlane16_swap_b32 v245, v45
    v_permlane16_swap_b32 v246, v46
    v_mfma_f32_16x16x32_bf16 v[88:91], v[216:219], v[204:207], v[88:91]
    v_permlane16_swap_b32 v247, v47
    s_nop 1
    v_add_f32 v248, v248, v249
    v_mfma_f32_16x16x32_bf16 v[92:95], v[220:223], v[204:207], v[92:95]
    v_add_f32 v250, v250, v251
    v_add_f32 v244, v244, v44
    v_add_f32 v245, v245, v45
    v_mfma_f32_16x16x32_bf16 v[96:99], v[224:227], v[204:207], v[96:99]
    v_add_f32 v246, v246, v46
    v_add_f32 v247, v247, v47
    v_mov_b32 v249, v248
    v_mfma_f32_16x16x32_bf16 v[100:103], v[228:231], v[204:207], v[100:103]
    v_mov_b32 v251, v250
    v_mov_b32 v44, v244
    v_mov_b32 v45, v245
    v_mfma_f32_16x16x32_bf16 v[104:107], v[232:235], v[204:207], v[104:107]
    v_mov_b32 v46, v246
    v_mov_b32 v47, v247
    s_nop 1
    v_mfma_f32_16x16x32_bf16 v[108:111], v[236:239], v[204:207], v[108:111]
    v_permlane32_swap_b32 v248, v249
    v_permlane32_swap_b32 v250, v251
    v_permlane32_swap_b32 v244, v44
    v_mfma_f32_16x16x32_bf16 v[112:115], v[216:219], v[208:211], v[112:115]
    v_permlane32_swap_b32 v245, v45
    v_permlane32_swap_b32 v246, v46
    v_permlane32_swap_b32 v247, v47
    v_mfma_f32_16x16x32_bf16 v[116:119], v[220:223], v[208:211], v[116:119]
    s_nop 1
    v_add_f32 v248, v248, v249
    v_add_f32 v250, v250, v251
    v_mfma_f32_16x16x32_bf16 v[120:123], v[224:227], v[208:211], v[120:123]
    v_add_f32 v244, v244, v44
    v_add_f32 v245, v245, v45
    v_add_f32 v246, v246, v46
    v_mfma_f32_16x16x32_bf16 v[124:127], v[228:231], v[208:211], v[124:127]
    v_add_f32 v247, v247, v47
    ds_write_b128 v35, v[244:247]
    v_mfma_f32_16x16x32_bf16 v[128:131], v[232:235], v[208:211], v[128:131]
    v_mul_f32 v248, 0x3acccccd, v248
    v_mul_f32 v250, 0x3acccccd, v250
    v_mfma_f32_16x16x32_bf16 v[132:135], v[236:239], v[208:211], v[132:135]
    v_fma_f32 v250, -v248, v248, v250
    v_max_f32 v250, 0, v250
    v_mfma_f32_16x16x32_bf16 v[136:139], v[216:219], v[212:215], v[136:139]
    v_cvt_pk_bf16_f32 v249, v248, v250
    v_lshlrev_b32 v252, 16, v249
    v_mfma_f32_16x16x32_bf16 v[140:143], v[220:223], v[212:215], v[140:143]
    v_and_b32 v253, 0xffff0000, v249
    v_add_f32 v253, 0x3727c5ac, v253
    v_mfma_f32_16x16x32_bf16 v[144:147], v[224:227], v[212:215], v[144:147]
    v_cvt_pk_bf16_f32 v253, v253, v253
    v_lshlrev_b32 v253, 16, v253
    v_mfma_f32_16x16x32_bf16 v[148:151], v[228:231], v[212:215], v[148:151]
    v_sqrt_f32 v253, v253
    s_nop 0
    v_mfma_f32_16x16x32_bf16 v[152:155], v[232:235], v[212:215], v[152:155]
    v_cvt_pk_bf16_f32 v253, v253, v253
    v_lshlrev_b32 v253, 16, v253
    v_mfma_f32_16x16x32_bf16 v[156:159], v[236:239], v[212:215], v[156:159]
    s_lshl_b32 s66, s56, 3
    s_add_u32 s66, s66, 150016
    v_mov_b32 v248, s66
    ds_write_b64 v248, v[252:253] offset:0
    s_waitcnt vmcnt(9) lgkmcnt(0)
    s_barrier
    v_mfma_f32_16x16x32_bf16 v[64:67], v[176:179], v[160:163], v[64:67]
    s_add_u32 m0, s3, 0x0
    ds_read_b64_tr_b16 v[216:217], v19 offset:24576
    buffer_load_dwordx4 v12, s[28:31], s65 offen lds
    s_add_u32 m0, s3, 0x400
    ds_read_b64_tr_b16 v[218:219], v19 offset:25088
    buffer_load_dwordx4 v13, s[28:31], s65 offen lds
    v_mfma_f32_16x16x32_bf16 v[68:71], v[180:183], v[160:163], v[68:71]
    s_add_u32 m0, s3, 0x800
    ds_read_b64_tr_b16 v[220:221], v20 offset:24576
    buffer_load_dwordx4 v14, s[28:31], s65 offen lds
    s_add_u32 s65, s65, 110592
    s_cmp_ge_u32 s65, 2211840
    s_cselect_b32 s65, 0, s65
    s_add_u32 m0, s79, 0x1c400
    ds_read_b64_tr_b16 v[222:223], v20 offset:25088
    buffer_load_dwordx4 v11, s[24:27], s64 offen lds
    s_add_u32 s64, s64, 128
    s_cmp_ge_u32 s64, 1280
    s_cselect_b32 s64, 0, s64
    v_mfma_f32_16x16x32_bf16 v[72:75], v[184:187], v[160:163], v[72:75]
    ds_read_b64_tr_b16 v[224:225], v21 offset:24576
    ds_read_b64_tr_b16 v[226:227], v21 offset:25088
    v_mfma_f32_16x16x32_bf16 v[76:79], v[188:191], v[160:163], v[76:79]
    ds_read_b64_tr_b16 v[228:229], v19 offset:36864
    ds_read_b64_tr_b16 v[230:231], v19 offset:37376
    v_mfma_f32_16x16x32_bf16 v[80:83], v[192:195], v[160:163], v[80:83]
    ds_read_b64_tr_b16 v[232:233], v20 offset:36864
    v_mfma_f32_16x16x32_bf16 v[84:87], v[196:199], v[160:163], v[84:87]
    ds_read_b64_tr_b16 v[234:235], v20 offset:37376
    v_mfma_f32_16x16x32_bf16 v[88:91], v[176:179], v[164:167], v[88:91]
    ds_read_b64_tr_b16 v[236:237], v21 offset:36864
    v_mfma_f32_16x16x32_bf16 v[92:95], v[180:183], v[164:167], v[92:95]
    ds_read_b64_tr_b16 v[238:239], v21 offset:37376
    v_mfma_f32_16x16x32_bf16 v[96:99], v[184:187], v[164:167], v[96:99]
    ds_read_b128 v[200:203], v16 offset:32768
    v_mfma_f32_16x16x32_bf16 v[100:103], v[188:191], v[164:167], v[100:103]
    ds_read_b128 v[204:207], v16 offset:34816
    v_mfma_f32_16x16x32_bf16 v[104:107], v[192:195], v[164:167], v[104:107]
    ds_read_b128 v[208:211], v16 offset:36864
    v_mfma_f32_16x16x32_bf16 v[108:111], v[196:199], v[164:167], v[108:111]
    ds_read_b128 v[212:215], v16 offset:38912
    v_mfma_f32_16x16x32_bf16 v[112:115], v[176:179], v[168:171], v[112:115]
    ds_read_b32 v44, v29 offset:0
    v_mfma_f32_16x16x32_bf16 v[116:119], v[180:183], v[168:171], v[116:119]
    ds_read_b32 v45, v29 offset:128
    v_mfma_f32_16x16x32_bf16 v[120:123], v[184:187], v[168:171], v[120:123]
    ds_read_b32 v46, v29 offset:256
    v_mfma_f32_16x16x32_bf16 v[124:127], v[188:191], v[168:171], v[124:127]
    ds_read_b32 v47, v29 offset:384
    v_mfma_f32_16x16x32_bf16 v[128:131], v[192:195], v[168:171], v[128:131]
    ds_read_b32 v48, v29 offset:512
    v_mfma_f32_16x16x32_bf16 v[132:135], v[196:199], v[168:171], v[132:135]
    ds_read_b32 v49, v29 offset:640
    v_mfma_f32_16x16x32_bf16 v[136:139], v[176:179], v[172:175], v[136:139]
    ds_read_b32 v50, v29 offset:768
    v_mfma_f32_16x16x32_bf16 v[140:143], v[180:183], v[172:175], v[140:143]
    ds_read_b32 v51, v29 offset:896
    v_mfma_f32_16x16x32_bf16 v[144:147], v[184:187], v[172:175], v[144:147]
    v_and_b32 v248, 7, v2
    v_mfma_f32_16x16x32_bf16 v[148:151], v[188:191], v[172:175], v[148:151]
    v_lshlrev_b32 v248, 3, v248
    v_mfma_f32_16x16x32_bf16 v[152:155], v[192:195], v[172:175], v[152:155]
    v_add_u32 v248, 150016, v248
    v_mfma_f32_16x16x32_bf16 v[156:159], v[196:199], v[172:175], v[156:159]
    ds_read_b64 v[250:251], v248
    s_waitcnt vmcnt(8) lgkmcnt(0)
    s_barrier
    v_mfma_f32_16x16x32_bf16 v[64:67], v[216:219], v[200:203], v[64:67]
    s_add_u32 m0, s3, 0x6000
    ds_read_b64_tr_b16 v[176:177], v22 offset:0
    buffer_load_dwordx4 v12, s[28:31], s65 offen lds
    s_add_u32 m0, s3, 0x6400
    ds_read_b64_tr_b16 v[178:179], v22 offset:512
    buffer_load_dwordx4 v13, s[28:31], s65 offen lds
    v_mfma_f32_16x16x32_bf16 v[68:71], v[220:223], v[200:203], v[68:71]
    s_add_u32 m0, s3, 0x6800
    ds_read_b64_tr_b16 v[180:181], v23 offset:0
    buffer_load_dwordx4 v14, s[28:31], s65 offen lds
    s_add_u32 s65, s65, 110592
    s_cmp_ge_u32 s65, 2211840
    s_cselect_b32 s65, 0, s65
    v_mfma_f32_16x16x32_bf16 v[72:75], v[224:227], v[200:203], v[72:75]
    s_add_u32 m0, s79, 0x20000
    ds_read_b64_tr_b16 v[182:183], v23 offset:512
    buffer_load_dwordx4 v10, s[24:27], s64 offen lds
    v_mfma_f32_16x16x32_bf16 v[76:79], v[228:231], v[200:203], v[76:79]
    ds_read_b64_tr_b16 v[184:185], v24 offset:0
    v_mfma_f32_16x16x32_bf16 v[80:83], v[232:235], v[200:203], v[80:83]
    ds_read_b64_tr_b16 v[186:187], v24 offset:512
    v_mfma_f32_16x16x32_bf16 v[84:87], v[236:239], v[200:203], v[84:87]
    ds_read_b64_tr_b16 v[188:189], v22 offset:12288
    v_mfma_f32_16x16x32_bf16 v[88:91], v[216:219], v[204:207], v[88:91]
    ds_read_b64_tr_b16 v[190:191], v22 offset:12800
    v_mfma_f32_16x16x32_bf16 v[92:95], v[220:223], v[204:207], v[92:95]
    ds_read_b64_tr_b16 v[192:193], v23 offset:12288
    v_mfma_f32_16x16x32_bf16 v[96:99], v[224:227], v[204:207], v[96:99]
    ds_read_b64_tr_b16 v[194:195], v23 offset:12800
    v_mfma_f32_16x16x32_bf16 v[100:103], v[228:231], v[204:207], v[100:103]
    ds_read_b64_tr_b16 v[196:197], v24 offset:12288
    v_mfma_f32_16x16x32_bf16 v[104:107], v[232:235], v[204:207], v[104:107]
    ds_read_b64_tr_b16 v[198:199], v24 offset:12800
    v_mfma_f32_16x16x32_bf16 v[108:111], v[236:239], v[204:207], v[108:111]
    ds_read_b128 v[160:163], v15 offset:0
    v_mfma_f32_16x16x32_bf16 v[112:115], v[216:219], v[208:211], v[112:115]
    ds_read_b128 v[164:167], v15 offset:2048
    v_mfma_f32_16x16x32_bf16 v[116:119], v[220:223], v[208:211], v[116:119]
    ds_read_b128 v[168:171], v15 offset:4096
    v_mfma_f32_16x16x32_bf16 v[120:123], v[224:227], v[208:211], v[120:123]
    ds_read_b128 v[172:175], v15 offset:6144
    v_mfma_f32_16x16x32_bf16 v[124:127], v[228:231], v[208:211], v[124:127]
    v_add_f32 v44, v44, v45
    v_mfma_f32_16x16x32_bf16 v[128:131], v[232:235], v[208:211], v[128:131]
    v_add_f32 v46, v46, v47
    v_mfma_f32_16x16x32_bf16 v[132:135], v[236:239], v[208:211], v[132:135]
    v_add_f32 v48, v48, v49
    v_mfma_f32_16x16x32_bf16 v[136:139], v[216:219], v[212:215], v[136:139]
    v_add_f32 v50, v50, v51
    v_mfma_f32_16x16x32_bf16 v[140:143], v[220:223], v[212:215], v[140:143]
    v_add_f32 v44, v44, v46
    v_mfma_f32_16x16x32_bf16 v[144:147], v[224:227], v[212:215], v[144:147]
    v_add_f32 v48, v48, v50
    v_mfma_f32_16x16x32_bf16 v[148:151], v[228:231], v[212:215], v[148:151]
    v_add_f32 v44, v44, v48
    v_mfma_f32_16x16x32_bf16 v[152:155], v[232:235], v[212:215], v[152:155]
    buffer_store_dword v44, v33, s[36:39], 0 offen sc1
    v_mfma_f32_16x16x32_bf16 v[156:159], v[236:239], v[212:215], v[156:159]
    buffer_store_dwordx2 v[250:251], v32, s[36:39], 0 offen sc1
    s_waitcnt vmcnt(9) lgkmcnt(0)
    s_barrier
    v_mfma_f32_16x16x32_bf16 v[64:67], v[176:179], v[160:163], v[64:67]
    s_add_u32 m0, s3, 0xc000
    ds_read_b64_tr_b16 v[216:217], v22 offset:24576
    buffer_load_dwordx4 v12, s[28:31], s65 offen lds
    v_mfma_f32_16x16x32_bf16 v[68:71], v[180:183], v[160:163], v[68:71]
    s_add_u32 m0, s3, 0xc400
    ds_read_b64_tr_b16 v[218:219], v22 offset:25088
    buffer_load_dwordx4 v13, s[28:31], s65 offen lds
    v_mfma_f32_16x16x32_bf16 v[72:75], v[184:187], v[160:163], v[72:75]
    s_add_u32 m0, s3, 0xc800
    ds_read_b64_tr_b16 v[220:221], v23 offset:24576
    buffer_load_dwordx4 v14, s[28:31], s65 offen lds
    s_add_u32 s65, s65, 110592
    s_cmp_ge_u32 s65, 2211840
    s_cselect_b32 s65, 0, s65
    v_mfma_f32_16x16x32_bf16 v[76:79], v[188:191], v[160:163], v[76:79]
    s_add_u32 m0, s79, 0x20400
    ds_read_b64_tr_b16 v[222:223], v23 offset:25088
    buffer_load_dwordx4 v11, s[24:27], s64 offen lds
    s_add_u32 s64, s64, 128
    s_cmp_ge_u32 s64, 1280
    s_cselect_b32 s64, 0, s64
    v_mfma_f32_16x16x32_bf16 v[80:83], v[192:195], v[160:163], v[80:83]
    ds_read_b64_tr_b16 v[224:225], v24 offset:24576
    v_mfma_f32_16x16x32_bf16 v[84:87], v[196:199], v[160:163], v[84:87]
    ds_read_b64_tr_b16 v[226:227], v24 offset:25088
    v_mfma_f32_16x16x32_bf16 v[88:91], v[176:179], v[164:167], v[88:91]
    ds_read_b64_tr_b16 v[228:229], v22 offset:36864
    v_mfma_f32_16x16x32_bf16 v[92:95], v[180:183], v[164:167], v[92:95]
    ds_read_b64_tr_b16 v[230:231], v22 offset:37376
    v_mfma_f32_16x16x32_bf16 v[96:99], v[184:187], v[164:167], v[96:99]
    ds_read_b64_tr_b16 v[232:233], v23 offset:36864
    v_mfma_f32_16x16x32_bf16 v[100:103], v[188:191], v[164:167], v[100:103]
    ds_read_b64_tr_b16 v[234:235], v23 offset:37376
    v_mfma_f32_16x16x32_bf16 v[104:107], v[192:195], v[164:167], v[104:107]
    ds_read_b64_tr_b16 v[236:237], v24 offset:36864
    v_mfma_f32_16x16x32_bf16 v[108:111], v[196:199], v[164:167], v[108:111]
    ds_read_b64_tr_b16 v[238:239], v24 offset:37376
    v_mfma_f32_16x16x32_bf16 v[112:115], v[176:179], v[168:171], v[112:115]
    ds_read_b128 v[200:203], v16 offset:0
    v_mfma_f32_16x16x32_bf16 v[116:119], v[180:183], v[168:171], v[116:119]
    ds_read_b128 v[204:207], v16 offset:2048
    v_mfma_f32_16x16x32_bf16 v[120:123], v[184:187], v[168:171], v[120:123]
    ds_read_b128 v[208:211], v16 offset:4096
    v_mfma_f32_16x16x32_bf16 v[124:127], v[188:191], v[168:171], v[124:127]
    ds_read_b128 v[212:215], v16 offset:6144
    v_mfma_f32_16x16x32_bf16 v[128:131], v[192:195], v[168:171], v[128:131]
    v_mfma_f32_16x16x32_bf16 v[132:135], v[196:199], v[168:171], v[132:135]
    v_mfma_f32_16x16x32_bf16 v[136:139], v[176:179], v[172:175], v[136:139]
    v_mfma_f32_16x16x32_bf16 v[140:143], v[180:183], v[172:175], v[140:143]
    v_mfma_f32_16x16x32_bf16 v[144:147], v[184:187], v[172:175], v[144:147]
    v_mfma_f32_16x16x32_bf16 v[148:151], v[188:191], v[172:175], v[148:151]
    v_mfma_f32_16x16x32_bf16 v[152:155], v[192:195], v[172:175], v[152:155]
    v_mfma_f32_16x16x32_bf16 v[156:159], v[196:199], v[172:175], v[156:159]
    s_waitcnt vmcnt(8) lgkmcnt(0)
    s_barrier
    v_mfma_f32_16x16x32_bf16 v[64:67], v[216:219], v[200:203], v[64:67]
    s_add_u32 m0, s3, 0x12000
    ds_read_b64_tr_b16 v[176:177], v19 offset:0
    buffer_load_dwordx4 v12, s[28:31], s65 offen lds
    v_mfma_f32_16x16x32_bf16 v[68:71], v[220:223], v[200:203], v[68:71]
    s_add_u32 m0, s3, 0x12400
    ds_read_b64_tr_b16 v[178:179], v19 offset:512
    buffer_load_dwordx4 v13, s[28:31], s65 offen lds
    v_mfma_f32_16x16x32_bf16 v[72:75], v[224:227], v[200:203], v[72:75]
    s_add_u32 m0, s3, 0x12800
    ds_read_b64_tr_b16 v[180:181], v20 offset:0
    buffer_load_dwordx4 v14, s[28:31], s65 offen lds
    s_add_u32 s65, s65, 110592
    s_cmp_ge_u32 s65, 2211840
    s_cselect_b32 s65, 0, s65
    v_mfma_f32_16x16x32_bf16 v[76:79], v[228:231], v[200:203], v[76:79]
    s_add_u32 m0, s79, 0x18000
    ds_read_b64_tr_b16 v[182:183], v20 offset:512
    buffer_load_dwordx4 v10, s[24:27], s64 offen lds
    v_mfma_f32_16x16x32_bf16 v[80:83], v[232:235], v[200:203], v[80:83]
    ds_read_b64_tr_b16 v[184:185], v21 offset:0
    v_mfma_f32_16x16x32_bf16 v[84:87], v[236:239], v[200:203], v[84:87]
    ds_read_b64_tr_b16 v[186:187], v21 offset:512
    v_mfma_f32_16x16x32_bf16 v[88:91], v[216:219], v[204:207], v[88:91]
    ds_read_b64_tr_b16 v[188:189], v19 offset:12288
    v_mfma_f32_16x16x32_bf16 v[92:95], v[220:223], v[204:207], v[92:95]
    ds_read_b64_tr_b16 v[190:191], v19 offset:12800
    v_mfma_f32_16x16x32_bf16 v[96:99], v[224:227], v[204:207], v[96:99]
    ds_read_b64_tr_b16 v[192:193], v20 offset:12288
    v_mfma_f32_16x16x32_bf16 v[100:103], v[228:231], v[204:207], v[100:103]
    ds_read_b64_tr_b16 v[194:195], v20 offset:12800
    v_mfma_f32_16x16x32_bf16 v[104:107], v[232:235], v[204:207], v[104:107]
    ds_read_b64_tr_b16 v[196:197], v21 offset:12288
    v_mfma_f32_16x16x32_bf16 v[108:111], v[236:239], v[204:207], v[108:111]
    ds_read_b64_tr_b16 v[198:199], v21 offset:12800
    v_mfma_f32_16x16x32_bf16 v[112:115], v[216:219], v[208:211], v[112:115]
    ds_read_b128 v[160:163], v15 offset:16384
    v_mfma_f32_16x16x32_bf16 v[116:119], v[220:223], v[208:211], v[116:119]
    ds_read_b128 v[164:167], v15 offset:18432
    v_mfma_f32_16x16x32_bf16 v[120:123], v[224:227], v[208:211], v[120:123]
    ds_read_b128 v[168:171], v15 offset:20480
    v_mfma_f32_16x16x32_bf16 v[124:127], v[228:231], v[208:211], v[124:127]
    ds_read_b128 v[172:175], v15 offset:22528
    v_mfma_f32_16x16x32_bf16 v[128:131], v[232:235], v[208:211], v[128:131]
    v_mfma_f32_16x16x32_bf16 v[132:135], v[236:239], v[208:211], v[132:135]
    v_mfma_f32_16x16x32_bf16 v[136:139], v[216:219], v[212:215], v[136:139]
    v_mfma_f32_16x16x32_bf16 v[140:143], v[220:223], v[212:215], v[140:143]
    v_mfma_f32_16x16x32_bf16 v[144:147], v[224:227], v[212:215], v[144:147]
    v_mfma_f32_16x16x32_bf16 v[148:151], v[228:231], v[212:215], v[148:151]
    v_mfma_f32_16x16x32_bf16 v[152:155], v[232:235], v[212:215], v[152:155]
    v_mfma_f32_16x16x32_bf16 v[156:159], v[236:239], v[212:215], v[156:159]
    s_waitcnt vmcnt(8) lgkmcnt(0)
    s_barrier
    v_mfma_f32_16x16x32_bf16 v[64:67], v[176:179], v[160:163], v[64:67]
    s_add_u32 m0, s3, 0x0
    ds_read_b64_tr_b16 v[216:217], v19 offset:24576
    buffer_load_dwordx4 v12, s[28:31], s65 offen lds
    v_mfma_f32_16x16x32_bf16 v[68:71], v[180:183], v[160:163], v[68:71]
    s_add_u32 m0, s3, 0x400
    ds_read_b64_tr_b16 v[218:219], v19 offset:25088
    buffer_load_dwordx4 v13, s[28:31], s65 offen lds
    v_mfma_f32_16x16x32_bf16 v[72:75], v[184:187], v[160:163], v[72:75]
    s_add_u32 m0, s3, 0x800
    ds_read_b64_tr_b16 v[220:221], v20 offset:24576
    buffer_load_dwordx4 v14, s[28:31], s65 offen lds
    s_add_u32 s65, s65, 110592
    s_cmp_ge_u32 s65, 2211840
    s_cselect_b32 s65, 0, s65
    v_mfma_f32_16x16x32_bf16 v[76:79], v[188:191], v[160:163], v[76:79]
    s_add_u32 m0, s79, 0x18400
    ds_read_b64_tr_b16 v[222:223], v20 offset:25088
    buffer_load_dwordx4 v11, s[24:27], s64 offen lds
    s_add_u32 s64, s64, 128
    s_cmp_ge_u32 s64, 1280
    s_cselect_b32 s64, 0, s64
    v_mfma_f32_16x16x32_bf16 v[80:83], v[192:195], v[160:163], v[80:83]
    ds_read_b64_tr_b16 v[224:225], v21 offset:24576
    v_mfma_f32_16x16x32_bf16 v[84:87], v[196:199], v[160:163], v[84:87]
    ds_read_b64_tr_b16 v[226:227], v21 offset:25088
    v_mfma_f32_16x16x32_bf16 v[88:91], v[176:179], v[164:167], v[88:91]
    ds_read_b64_tr_b16 v[228:229], v19 offset:36864
    v_mfma_f32_16x16x32_bf16 v[92:95], v[180:183], v[164:167], v[92:95]
    ds_read_b64_tr_b16 v[230:231], v19 offset:37376
    v_mfma_f32_16x16x32_bf16 v[96:99], v[184:187], v[164:167], v[96:99]
    ds_read_b64_tr_b16 v[232:233], v20 offset:36864
    v_mfma_f32_16x16x32_bf16 v[100:103], v[188:191], v[164:167], v[100:103]
    ds_read_b64_tr_b16 v[234:235], v20 offset:37376
    v_mfma_f32_16x16x32_bf16 v[104:107], v[192:195], v[164:167], v[104:107]
    ds_read_b64_tr_b16 v[236:237], v21 offset:36864
    v_mfma_f32_16x16x32_bf16 v[108:111], v[196:199], v[164:167], v[108:111]
    ds_read_b64_tr_b16 v[238:239], v21 offset:37376
    v_mfma_f32_16x16x32_bf16 v[112:115], v[176:179], v[168:171], v[112:115]
    ds_read_b128 v[200:203], v16 offset:16384
    v_mfma_f32_16x16x32_bf16 v[116:119], v[180:183], v[168:171], v[116:119]
    ds_read_b128 v[204:207], v16 offset:18432
    v_mfma_f32_16x16x32_bf16 v[120:123], v[184:187], v[168:171], v[120:123]
    ds_read_b128 v[208:211], v16 offset:20480
    v_mfma_f32_16x16x32_bf16 v[124:127], v[188:191], v[168:171], v[124:127]
    ds_read_b128 v[212:215], v16 offset:22528
    v_mfma_f32_16x16x32_bf16 v[128:131], v[192:195], v[168:171], v[128:131]
    v_mov_b32 v248, 1
    v_mfma_f32_16x16x32_bf16 v[132:135], v[196:199], v[168:171], v[132:135]
    buffer_atomic_add v248, v34, s[52:55], 0 offen
    v_mfma_f32_16x16x32_bf16 v[136:139], v[176:179], v[172:175], v[136:139]
    v_mfma_f32_16x16x32_bf16 v[140:143], v[180:183], v[172:175], v[140:143]
    v_mfma_f32_16x16x32_bf16 v[144:147], v[184:187], v[172:175], v[144:147]
    v_mfma_f32_16x16x32_bf16 v[148:151], v[188:191], v[172:175], v[148:151]
    v_mfma_f32_16x16x32_bf16 v[152:155], v[192:195], v[172:175], v[152:155]
    v_mfma_f32_16x16x32_bf16 v[156:159], v[196:199], v[172:175], v[156:159]
    s_waitcnt vmcnt(8) lgkmcnt(0)
    s_barrier
    v_mfma_f32_16x16x32_bf16 v[64:67], v[216:219], v[200:203], v[64:67]
    s_add_u32 m0, s3, 0x6000
    ds_read_b64_tr_b16 v[176:177], v22 offset:0
    buffer_load_dwordx4 v12, s[28:31], s65 offen lds
    v_mfma_f32_16x16x32_bf16 v[68:71], v[220:223], v[200:203], v[68:71]
    s_add_u32 m0, s3, 0x6400
    ds_read_b64_tr_b16 v[178:179], v22 offset:512
    buffer_load_dwordx4 v13, s[28:31], s65 offen lds
    v_mfma_f32_16x16x32_bf16 v[72:75], v[224:227], v[200:203], v[72:75]
    s_add_u32 m0, s3, 0x6800
    ds_read_b64_tr_b16 v[180:181], v23 offset:0
    buffer_load_dwordx4 v14, s[28:31], s65 offen lds
    s_add_u32 s65, s65, 110592
    s_cmp_ge_u32 s65, 2211840
    s_cselect_b32 s65, 0, s65
    v_mfma_f32_16x16x32_bf16 v[76:79], v[228:231], v[200:203], v[76:79]
    s_add_u32 m0, s79, 0x1c000
    ds_read_b64_tr_b16 v[182:183], v23 offset:512
    buffer_load_dwordx4 v10, s[24:27], s64 offen lds
    v_mfma_f32_16x16x32_bf16 v[80:83], v[232:235], v[200:203], v[80:83]
    ds_read_b64_tr_b16 v[184:185], v24 offset:0
    v_mfma_f32_16x16x32_bf16 v[84:87], v[236:239], v[200:203], v[84:87]
    ds_read_b64_tr_b16 v[186:187], v24 offset:512
    v_mfma_f32_16x16x32_bf16 v[88:91], v[216:219], v[204:207], v[88:91]
    ds_read_b64_tr_b16 v[188:189], v22 offset:12288
    v_mfma_f32_16x16x32_bf16 v[92:95], v[220:223], v[204:207], v[92:95]
    ds_read_b64_tr_b16 v[190:191], v22 offset:12800
    v_mfma_f32_16x16x32_bf16 v[96:99], v[224:227], v[204:207], v[96:99]
    ds_read_b64_tr_b16 v[192:193], v23 offset:12288
    v_mfma_f32_16x16x32_bf16 v[100:103], v[228:231], v[204:207], v[100:103]
    ds_read_b64_tr_b16 v[194:195], v23 offset:12800
    v_mfma_f32_16x16x32_bf16 v[104:107], v[232:235], v[204:207], v[104:107]
    ds_read_b64_tr_b16 v[196:197], v24 offset:12288
    v_mfma_f32_16x16x32_bf16 v[108:111], v[236:239], v[204:207], v[108:111]
    ds_read_b64_tr_b16 v[198:199], v24 offset:12800
    v_mfma_f32_16x16x32_bf16 v[112:115], v[216:219], v[208:211], v[112:115]
    ds_read_b128 v[160:163], v15 offset:32768
    v_mfma_f32_16x16x32_bf16 v[116:119], v[220:223], v[208:211], v[116:119]
    ds_read_b128 v[164:167], v15 offset:34816
    v_mfma_f32_16x16x32_bf16 v[120:123], v[224:227], v[208:211], v[120:123]
    ds_read_b128 v[168:171], v15 offset:36864
    v_mfma_f32_16x16x32_bf16 v[124:127], v[228:231], v[208:211], v[124:127]
    ds_read_b128 v[172:175], v15 offset:38912
    v_mfma_f32_16x16x32_bf16 v[128:131], v[232:235], v[208:211], v[128:131]
    s_lshl_b32 s66, s2, 3
    s_add_u32 s66, s66, s56
    s_lshl_b32 s66, s66, 10
    buffer_load_dwordx4 v[252:255], v3, s[44:47], s66 offen
    buffer_load_dwordx4 v[252:255], v3, s[48:51], s66 offen
    s_add_u32 s66, s66, 0x200000
    buffer_load_dwordx4 v[252:255], v3, s[44:47], s66 offen
    v_mfma_f32_16x16x32_bf16 v[132:135], v[236:239], v[208:211], v[132:135]
    v_mfma_f32_16x16x32_bf16 v[136:139], v[216:219], v[212:215], v[136:139]
    v_mfma_f32_16x16x32_bf16 v[140:143], v[220:223], v[212:215], v[140:143]
    v_mfma_f32_16x16x32_bf16 v[144:147], v[224:227], v[212:215], v[144:147]
    v_mfma_f32_16x16x32_bf16 v[148:151], v[228:231], v[212:215], v[148:151]
    v_mfma_f32_16x16x32_bf16 v[152:155], v[232:235], v[212:215], v[152:155]
    v_mfma_f32_16x16x32_bf16 v[156:159], v[236:239], v[212:215], v[156:159]
    s_waitcnt vmcnt(9) lgkmcnt(0)
    s_barrier
    v_mfma_f32_16x16x32_bf16 v[64:67], v[176:179], v[160:163], v[64:67]
    s_add_u32 m0, s3, 0xc000
    ds_read_b64_tr_b16 v[216:217], v22 offset:24576
    buffer_load_dwordx4 v12, s[28:31], s65 offen lds
    v_mfma_f32_16x16x32_bf16 v[68:71], v[180:183], v[160:163], v[68:71]
    s_add_u32 m0, s3, 0xc400
    ds_read_b64_tr_b16 v[218:219], v22 offset:25088
    buffer_load_dwordx4 v13, s[28:31], s65 offen lds
    v_mfma_f32_16x16x32_bf16 v[72:75], v[184:187], v[160:163], v[72:75]
    s_add_u32 m0, s3, 0xc800
    ds_read_b64_tr_b16 v[220:221], v23 offset:24576
    buffer_load_dwordx4 v14, s[28:31], s65 offen lds
    s_add_u32 s65, s65, 110592
    s_cmp_ge_u32 s65, 2211840
    s_cselect_b32 s65, 0, s65
    v_mfma_f32_16x16x32_bf16 v[76:79], v[188:191], v[160:163], v[76:79]
    s_add_u32 m0, s79, 0x1c400
    ds_read_b64_tr_b16 v[222:223], v23 offset:25088
    buffer_load_dwordx4 v11, s[24:27], s64 offen lds
    s_add_u32 s64, s64, 128
    s_cmp_ge_u32 s64, 1280
    s_cselect_b32 s64, 0, s64
    v_mfma_f32_16x16x32_bf16 v[80:83], v[192:195], v[160:163], v[80:83]
    ds_read_b64_tr_b16 v[224:225], v24 offset:24576
    v_mfma_f32_16x16x32_bf16 v[84:87], v[196:199], v[160:163], v[84:87]
    ds_read_b64_tr_b16 v[226:227], v24 offset:25088
    v_mfma_f32_16x16x32_bf16 v[88:91], v[176:179], v[164:167], v[88:91]
    ds_read_b64_tr_b16 v[228:229], v22 offset:36864
    v_mfma_f32_16x16x32_bf16 v[92:95], v[180:183], v[164:167], v[92:95]
    ds_read_b64_tr_b16 v[230:231], v22 offset:37376
    v_mfma_f32_16x16x32_bf16 v[96:99], v[184:187], v[164:167], v[96:99]
    ds_read_b64_tr_b16 v[232:233], v23 offset:36864
    v_mfma_f32_16x16x32_bf16 v[100:103], v[188:191], v[164:167], v[100:103]
    ds_read_b64_tr_b16 v[234:235], v23 offset:37376
    v_mfma_f32_16x16x32_bf16 v[104:107], v[192:195], v[164:167], v[104:107]
    ds_read_b64_tr_b16 v[236:237], v24 offset:36864
    v_mfma_f32_16x16x32_bf16 v[108:111], v[196:199], v[164:167], v[108:111]
    ds_read_b64_tr_b16 v[238:239], v24 offset:37376
    v_mfma_f32_16x16x32_bf16 v[112:115], v[176:179], v[168:171], v[112:115]
    ds_read_b128 v[200:203], v16 offset:32768
    v_mfma_f32_16x16x32_bf16 v[116:119], v[180:183], v[168:171], v[116:119]
    ds_read_b128 v[204:207], v16 offset:34816
    v_mfma_f32_16x16x32_bf16 v[120:123], v[184:187], v[168:171], v[120:123]
    ds_read_b128 v[208:211], v16 offset:36864
    v_mfma_f32_16x16x32_bf16 v[124:127], v[188:191], v[168:171], v[124:127]
    ds_read_b128 v[212:215], v16 offset:38912
    v_mfma_f32_16x16x32_bf16 v[128:131], v[192:195], v[168:171], v[128:131]
    v_mfma_f32_16x16x32_bf16 v[132:135], v[196:199], v[168:171], v[132:135]
    v_mfma_f32_16x16x32_bf16 v[136:139], v[176:179], v[172:175], v[136:139]
    v_mfma_f32_16x16x32_bf16 v[140:143], v[180:183], v[172:175], v[140:143]
    v_mfma_f32_16x16x32_bf16 v[144:147], v[184:187], v[172:175], v[144:147]
    v_mfma_f32_16x16x32_bf16 v[148:151], v[188:191], v[172:175], v[148:151]
    v_mfma_f32_16x16x32_bf16 v[152:155], v[192:195], v[172:175], v[152:155]
    v_mfma_f32_16x16x32_bf16 v[156:159], v[196:199], v[172:175], v[156:159]
    s_waitcnt vmcnt(8) lgkmcnt(0)
    s_barrier
    v_mfma_f32_16x16x32_bf16 v[64:67], v[216:219], v[200:203], v[64:67]
    s_add_u32 m0, s3, 0x12000
    ds_read_b64_tr_b16 v[176:177], v19 offset:0
    buffer_load_dwordx4 v12, s[28:31], s65 offen lds
    v_mfma_f32_16x16x32_bf16 v[68:71], v[220:223], v[200:203], v[68:71]
    s_add_u32 m0, s3, 0x12400
    ds_read_b64_tr_b16 v[178:179], v19 offset:512
    buffer_load_dwordx4 v13, s[28:31], s65 offen lds
    v_mfma_f32_16x16x32_bf16 v[72:75], v[224:227], v[200:203], v[72:75]
    s_add_u32 m0, s3, 0x12800
    ds_read_b64_tr_b16 v[180:181], v20 offset:0
    buffer_load_dwordx4 v14, s[28:31], s65 offen lds
    s_add_u32 s65, s65, 110592
    s_cmp_ge_u32 s65, 2211840
    s_cselect_b32 s65, 0, s65
    v_mfma_f32_16x16x32_bf16 v[76:79], v[228:231], v[200:203], v[76:79]
    s_add_u32 m0, s79, 0x20000
    ds_read_b64_tr_b16 v[182:183], v20 offset:512
    buffer_load_dwordx4 v10, s[24:27], s64 offen lds
    v_mfma_f32_16x16x32_bf16 v[80:83], v[232:235], v[200:203], v[80:83]
    ds_read_b64_tr_b16 v[184:185], v21 offset:0
    v_mfma_f32_16x16x32_bf16 v[84:87], v[236:239], v[200:203], v[84:87]
    ds_read_b64_tr_b16 v[186:187], v21 offset:512
    v_mfma_f32_16x16x32_bf16 v[88:91], v[216:219], v[204:207], v[88:91]
    ds_read_b64_tr_b16 v[188:189], v19 offset:12288
    v_mfma_f32_16x16x32_bf16 v[92:95], v[220:223], v[204:207], v[92:95]
    ds_read_b64_tr_b16 v[190:191], v19 offset:12800
    v_mfma_f32_16x16x32_bf16 v[96:99], v[224:227], v[204:207], v[96:99]
    ds_read_b64_tr_b16 v[192:193], v20 offset:12288
    v_mfma_f32_16x16x32_bf16 v[100:103], v[228:231], v[204:207], v[100:103]
    ds_read_b64_tr_b16 v[194:195], v20 offset:12800
    v_mfma_f32_16x16x32_bf16 v[104:107], v[232:235], v[204:207], v[104:107]
    ds_read_b64_tr_b16 v[196:197], v21 offset:12288
    v_mfma_f32_16x16x32_bf16 v[108:111], v[236:239], v[204:207], v[108:111]
    ds_read_b64_tr_b16 v[198:199], v21 offset:12800
    v_mfma_f32_16x16x32_bf16 v[112:115], v[216:219], v[208:211], v[112:115]
    ds_read_b128 v[160:163], v15 offset:0
    v_mfma_f32_16x16x32_bf16 v[116:119], v[220:223], v[208:211], v[116:119]
    ds_read_b128 v[164:167], v15 offset:2048
    v_mfma_f32_16x16x32_bf16 v[120:123], v[224:227], v[208:211], v[120:123]
    ds_read_b128 v[168:171], v15 offset:4096
    v_mfma_f32_16x16x32_bf16 v[124:127], v[228:231], v[208:211], v[124:127]
    ds_read_b128 v[172:175], v15 offset:6144
    v_mfma_f32_16x16x32_bf16 v[128:131], v[232:235], v[208:211], v[128:131]
    v_mfma_f32_16x16x32_bf16 v[132:135], v[236:239], v[208:211], v[132:135]
    v_mfma_f32_16x16x32_bf16 v[136:139], v[216:219], v[212:215], v[136:139]
    v_mfma_f32_16x16x32_bf16 v[140:143], v[220:223], v[212:215], v[140:143]
    v_mfma_f32_16x16x32_bf16 v[144:147], v[224:227], v[212:215], v[144:147]
    v_mfma_f32_16x16x32_bf16 v[148:151], v[228:231], v[212:215], v[148:151]
    v_mfma_f32_16x16x32_bf16 v[152:155], v[232:235], v[212:215], v[152:155]
    v_mfma_f32_16x16x32_bf16 v[156:159], v[236:239], v[212:215], v[156:159]
    s_waitcnt vmcnt(9) lgkmcnt(0)
    s_barrier
    v_mfma_f32_16x16x32_bf16 v[64:67], v[176:179], v[160:163], v[64:67]
    s_add_u32 m0, s3, 0x0
    ds_read_b64_tr_b16 v[216:217], v19 offset:24576
    buffer_load_dwordx4 v12, s[28:31], s65 offen lds
    v_mfma_f32_16x16x32_bf16 v[68:71], v[180:183], v[160:163], v[68:71]
    s_add_u32 m0, s3, 0x400
    ds_read_b64_tr_b16 v[218:219], v19 offset:25088
    buffer_load_dwordx4 v13, s[28:31], s65 offen lds
    v_mfma_f32_16x16x32_bf16 v[72:75], v[184:187], v[160:163], v[72:75]
    s_add_u32 m0, s3, 0x800
    ds_read_b64_tr_b16 v[220:221], v20 offset:24576
    buffer_load_dwordx4 v14, s[28:31], s65 offen lds
    s_add_u32 s65, s65, 110592
    s_cmp_ge_u32 s65, 2211840
    s_cselect_b32 s65, 0, s65
    v_mfma_f32_16x16x32_bf16 v[76:79], v[188:191], v[160:163], v[76:79]
    s_add_u32 m0, s79, 0x20400
    ds_read_b64_tr_b16 v[222:223], v20 offset:25088
    buffer_load_dwordx4 v11, s[24:27], s64 offen lds
    s_add_u32 s64, s64, 128
    s_cmp_ge_u32 s64, 1280
    s_cselect_b32 s64, 0, s64
    v_mfma_f32_16x16x32_bf16 v[80:83], v[192:195], v[160:163], v[80:83]
    ds_read_b64_tr_b16 v[224:225], v21 offset:24576
    v_mfma_f32_16x16x32_bf16 v[84:87], v[196:199], v[160:163], v[84:87]
    ds_read_b64_tr_b16 v[226:227], v21 offset:25088
    v_mfma_f32_16x16x32_bf16 v[88:91], v[176:179], v[164:167], v[88:91]
    ds_read_b64_tr_b16 v[228:229], v19 offset:36864
    v_mfma_f32_16x16x32_bf16 v[92:95], v[180:183], v[164:167], v[92:95]
    ds_read_b64_tr_b16 v[230:231], v19 offset:37376
    v_mfma_f32_16x16x32_bf16 v[96:99], v[184:187], v[164:167], v[96:99]
    ds_read_b64_tr_b16 v[232:233], v20 offset:36864
    v_mfma_f32_16x16x32_bf16 v[100:103], v[188:191], v[164:167], v[100:103]
    ds_read_b64_tr_b16 v[234:235], v20 offset:37376
    v_mfma_f32_16x16x32_bf16 v[104:107], v[192:195], v[164:167], v[104:107]
    ds_read_b64_tr_b16 v[236:237], v21 offset:36864
    v_mfma_f32_16x16x32_bf16 v[108:111], v[196:199], v[164:167], v[108:111]
    ds_read_b64_tr_b16 v[238:239], v21 offset:37376
    v_mfma_f32_16x16x32_bf16 v[112:115], v[176:179], v[168:171], v[112:115]
    ds_read_b128 v[200:203], v16 offset:0
    v_mfma_f32_16x16x32_bf16 v[116:119], v[180:183], v[168:171], v[116:119]
    ds_read_b128 v[204:207], v16 offset:2048
    v_mfma_f32_16x16x32_bf16 v[120:123], v[184:187], v[168:171], v[120:123]
    ds_read_b128 v[208:211], v16 offset:4096
    v_mfma_f32_16x16x32_bf16 v[124:127], v[188:191], v[168:171], v[124:127]
    ds_read_b128 v[212:215], v16 offset:6144
    v_mfma_f32_16x16x32_bf16 v[128:131], v[192:195], v[168:171], v[128:131]
    v_mov_b32 v249, 240
    v_mfma_f32_16x16x32_bf16 v[132:135], v[196:199], v[168:171], v[132:135]
    v_mfma_f32_16x16x32_bf16 v[136:139], v[176:179], v[172:175], v[136:139]
    v_mfma_f32_16x16x32_bf16 v[140:143], v[180:183], v[172:175], v[140:143]
    v_mfma_f32_16x16x32_bf16 v[144:147], v[184:187], v[172:175], v[144:147]
    v_mfma_f32_16x16x32_bf16 v[148:151], v[188:191], v[172:175], v[148:151]
    v_mfma_f32_16x16x32_bf16 v[152:155], v[192:195], v[172:175], v[152:155]
    v_mfma_f32_16x16x32_bf16 v[156:159], v[196:199], v[172:175], v[156:159]
    s_waitcnt vmcnt(8) lgkmcnt(0)
    s_barrier
    v_mfma_f32_16x16x32_bf16 v[64:67], v[216:219], v[200:203], v[64:67]
    s_add_u32 m0, s3, 0x6000
    ds_read_b64_tr_b16 v[176:177], v22 offset:0
    buffer_load_dwordx4 v12, s[28:31], s65 offen lds
    v_mfma_f32_16x16x32_bf16 v[68:71], v[220:223], v[200:203], v[68:71]
    s_add_u32 m0, s3, 0x6400
    ds_read_b64_tr_b16 v[178:179], v22 offset:512
    buffer_load_dwordx4 v13, s[28:31], s65 offen lds
    v_mfma_f32_16x16x32_bf16 v[72:75], v[224:227], v[200:203], v[72:75]
    s_add_u32 m0, s3, 0x6800
    ds_read_b64_tr_b16 v[180:181], v23 offset:0
    buffer_load_dwordx4 v14, s[28:31], s65 offen lds
    s_add_u32 s65, s65, 110592
    s_cmp_ge_u32 s65, 2211840
    s_cselect_b32 s65, 0, s65
    v_mfma_f32_16x16x32_bf16 v[76:79], v[228:231], v[200:203], v[76:79]
    s_add_u32 m0, s79, 0x18000
    ds_read_b64_tr_b16 v[182:183], v23 offset:512
    buffer_load_dwordx4 v10, s[24:27], s64 offen lds
    v_mfma_f32_16x16x32_bf16 v[80:83], v[232:235], v[200:203], v[80:83]
    ds_read_b64_tr_b16 v[184:185], v24 offset:0
    v_mfma_f32_16x16x32_bf16 v[84:87], v[236:239], v[200:203], v[84:87]
    ds_read_b64_tr_b16 v[186:187], v24 offset:512
    v_mfma_f32_16x16x32_bf16 v[88:91], v[216:219], v[204:207], v[88:91]
    ds_read_b64_tr_b16 v[188:189], v22 offset:12288
    v_mfma_f32_16x16x32_bf16 v[92:95], v[220:223], v[204:207], v[92:95]
    ds_read_b64_tr_b16 v[190:191], v22 offset:12800
    v_mfma_f32_16x16x32_bf16 v[96:99], v[224:227], v[204:207], v[96:99]
    ds_read_b64_tr_b16 v[192:193], v23 offset:12288
    v_mfma_f32_16x16x32_bf16 v[100:103], v[228:231], v[204:207], v[100:103]
    ds_read_b64_tr_b16 v[194:195], v23 offset:12800
    v_mfma_f32_16x16x32_bf16 v[104:107], v[232:235], v[204:207], v[104:107]
    ds_read_b64_tr_b16 v[196:197], v24 offset:12288
    v_mfma_f32_16x16x32_bf16 v[108:111], v[236:239], v[204:207], v[108:111]
    ds_read_b64_tr_b16 v[198:199], v24 offset:12800
    v_mfma_f32_16x16x32_bf16 v[112:115], v[216:219], v[208:211], v[112:115]
    ds_read_b128 v[160:163], v15 offset:16384
    v_mfma_f32_16x16x32_bf16 v[116:119], v[220:223], v[208:211], v[116:119]
    ds_read_b128 v[164:167], v15 offset:18432
    v_mfma_f32_16x16x32_bf16 v[120:123], v[224:227], v[208:211], v[120:123]
    ds_read_b128 v[168:171], v15 offset:20480
    v_mfma_f32_16x16x32_bf16 v[124:127], v[228:231], v[208:211], v[124:127]
    ds_read_b128 v[172:175], v15 offset:22528
    v_mfma_f32_16x16x32_bf16 v[128:131], v[232:235], v[208:211], v[128:131]
    v_mfma_f32_16x16x32_bf16 v[132:135], v[236:239], v[208:211], v[132:135]
    v_mfma_f32_16x16x32_bf16 v[136:139], v[216:219], v[212:215], v[136:139]
    v_mfma_f32_16x16x32_bf16 v[140:143], v[220:223], v[212:215], v[140:143]
    v_mfma_f32_16x16x32_bf16 v[144:147], v[224:227], v[212:215], v[144:147]
    v_mfma_f32_16x16x32_bf16 v[148:151], v[228:231], v[212:215], v[148:151]
    v_mfma_f32_16x16x32_bf16 v[152:155], v[232:235], v[212:215], v[152:155]
    v_mfma_f32_16x16x32_bf16 v[156:159], v[236:239], v[212:215], v[156:159]
    s_waitcnt vmcnt(9) lgkmcnt(0)
    s_barrier
    v_mfma_f32_16x16x32_bf16 v[64:67], v[176:179], v[160:163], v[64:67]
    s_add_u32 m0, s3, 0xc000
    ds_read_b64_tr_b16 v[216:217], v22 offset:24576
    buffer_load_dwordx4 v12, s[28:31], s65 offen lds
    v_mfma_f32_16x16x32_bf16 v[68:71], v[180:183], v[160:163], v[68:71]
    s_add_u32 m0, s3, 0xc400
    ds_read_b64_tr_b16 v[218:219], v22 offset:25088
    buffer_load_dwordx4 v13, s[28:31], s65 offen lds
    v_mfma_f32_16x16x32_bf16 v[72:75], v[184:187], v[160:163], v[72:75]
    s_add_u32 m0, s3, 0xc800
    ds_read_b64_tr_b16 v[220:221], v23 offset:24576
    buffer_load_dwordx4 v14, s[28:31], s65 offen lds
    s_add_u32 s65, s65, 110592
    s_cmp_ge_u32 s65, 2211840
    s_cselect_b32 s65, 0, s65
    v_mfma_f32_16x16x32_bf16 v[76:79], v[188:191], v[160:163], v[76:79]
    s_add_u32 m0, s79, 0x18400
    ds_read_b64_tr_b16 v[222:223], v23 offset:25088
    buffer_load_dwordx4 v11, s[24:27], s64 offen lds
    s_add_u32 s64, s64, 128
    s_cmp_ge_u32 s64, 1280
    s_cselect_b32 s64, 0, s64
    v_mfma_f32_16x16x32_bf16 v[80:83], v[192:195], v[160:163], v[80:83]
    ds_read_b64_tr_b16 v[224:225], v24 offset:24576
    v_mfma_f32_16x16x32_bf16 v[84:87], v[196:199], v[160:163], v[84:87]
    ds_read_b64_tr_b16 v[226:227], v24 offset:25088
    v_mfma_f32_16x16x32_bf16 v[88:91], v[176:179], v[164:167], v[88:91]
    ds_read_b64_tr_b16 v[228:229], v22 offset:36864
    v_mfma_f32_16x16x32_bf16 v[92:95], v[180:183], v[164:167], v[92:95]
    ds_read_b64_tr_b16 v[230:231], v22 offset:37376
    v_mfma_f32_16x16x32_bf16 v[96:99], v[184:187], v[164:167], v[96:99]
    ds_read_b64_tr_b16 v[232:233], v23 offset:36864
    v_mfma_f32_16x16x32_bf16 v[100:103], v[188:191], v[164:167], v[100:103]
    ds_read_b64_tr_b16 v[234:235], v23 offset:37376
    v_mfma_f32_16x16x32_bf16 v[104:107], v[192:195], v[164:167], v[104:107]
    ds_read_b64_tr_b16 v[236:237], v24 offset:36864
    v_mfma_f32_16x16x32_bf16 v[108:111], v[196:199], v[164:167], v[108:111]
    ds_read_b64_tr_b16 v[238:239], v24 offset:37376
    v_mfma_f32_16x16x32_bf16 v[112:115], v[176:179], v[168:171], v[112:115]
    ds_read_b128 v[200:203], v16 offset:16384
    v_mfma_f32_16x16x32_bf16 v[116:119], v[180:183], v[168:171], v[116:119]
    ds_read_b128 v[204:207], v16 offset:18432
    v_mfma_f32_16x16x32_bf16 v[120:123], v[184:187], v[168:171], v[120:123]
    ds_read_b128 v[208:211], v16 offset:20480
    v_mfma_f32_16x16x32_bf16 v[124:127], v[188:191], v[168:171], v[124:127]
    ds_read_b128 v[212:215], v16 offset:22528
    v_mfma_f32_16x16x32_bf16 v[128:131], v[192:195], v[168:171], v[128:131]
    v_mfma_f32_16x16x32_bf16 v[132:135], v[196:199], v[168:171], v[132:135]
    v_mfma_f32_16x16x32_bf16 v[136:139], v[176:179], v[172:175], v[136:139]
    v_mfma_f32_16x16x32_bf16 v[140:143], v[180:183], v[172:175], v[140:143]
    v_mfma_f32_16x16x32_bf16 v[144:147], v[184:187], v[172:175], v[144:147]
    v_mfma_f32_16x16x32_bf16 v[148:151], v[188:191], v[172:175], v[148:151]
    v_mfma_f32_16x16x32_bf16 v[152:155], v[192:195], v[172:175], v[152:155]
    v_mfma_f32_16x16x32_bf16 v[156:159], v[196:199], v[172:175], v[156:159]
    s_waitcnt vmcnt(8) lgkmcnt(0)
    s_barrier
    v_mfma_f32_16x16x32_bf16 v[64:67], v[216:219], v[200:203], v[64:67]
    s_add_u32 m0, s3, 0x12000
    ds_read_b64_tr_b16 v[176:177], v19 offset:0
    buffer_load_dwordx4 v12, s[28:31], s65 offen lds
    v_mfma_f32_16x16x32_bf16 v[68:71], v[220:223], v[200:203], v[68:71]
    s_add_u32 m0, s3, 0x12400
    ds_read_b64_tr_b16 v[178:179], v19 offset:512
    buffer_load_dwordx4 v13, s[28:31], s65 offen lds
    v_mfma_f32_16x16x32_bf16 v[72:75], v[224:227], v[200:203], v[72:75]
    s_add_u32 m0, s3, 0x12800
    ds_read_b64_tr_b16 v[180:181], v20 offset:0
    buffer_load_dwordx4 v14, s[28:31], s65 offen lds
    s_add_u32 s65, s65, 110592
    s_cmp_ge_u32 s65, 2211840
    s_cselect_b32 s65, 0, s65
    v_mfma_f32_16x16x32_bf16 v[76:79], v[228:231], v[200:203], v[76:79]
    ds_read_b64_tr_b16 v[182:183], v20 offset:512
    v_mfma_f32_16x16x32_bf16 v[80:83], v[232:235], v[200:203], v[80:83]
    ds_read_b64_tr_b16 v[184:185], v21 offset:0
    v_mfma_f32_16x16x32_bf16 v[84:87], v[236:239], v[200:203], v[84:87]
    ds_read_b64_tr_b16 v[186:187], v21 offset:512
    v_mfma_f32_16x16x32_bf16 v[88:91], v[216:219], v[204:207], v[88:91]
    ds_read_b64_tr_b16 v[188:189], v19 offset:12288
    v_mfma_f32_16x16x32_bf16 v[92:95], v[220:223], v[204:207], v[92:95]
    ds_read_b64_tr_b16 v[190:191], v19 offset:12800
    v_mfma_f32_16x16x32_bf16 v[96:99], v[224:227], v[204:207], v[96:99]
    ds_read_b64_tr_b16 v[192:193], v20 offset:12288
    v_mfma_f32_16x16x32_bf16 v[100:103], v[228:231], v[204:207], v[100:103]
    ds_read_b64_tr_b16 v[194:195], v20 offset:12800
    v_mfma_f32_16x16x32_bf16 v[104:107], v[232:235], v[204:207], v[104:107]
    ds_read_b64_tr_b16 v[196:197], v21 offset:12288
    v_mfma_f32_16x16x32_bf16 v[108:111], v[236:239], v[204:207], v[108:111]
    ds_read_b64_tr_b16 v[198:199], v21 offset:12800
    v_mfma_f32_16x16x32_bf16 v[112:115], v[216:219], v[208:211], v[112:115]
    ds_read_b128 v[160:163], v15 offset:32768
    v_mfma_f32_16x16x32_bf16 v[116:119], v[220:223], v[208:211], v[116:119]
    ds_read_b128 v[164:167], v15 offset:34816
    v_mfma_f32_16x16x32_bf16 v[120:123], v[224:227], v[208:211], v[120:123]
    ds_read_b128 v[168:171], v15 offset:36864
    v_mfma_f32_16x16x32_bf16 v[124:127], v[228:231], v[208:211], v[124:127]
    ds_read_b128 v[172:175], v15 offset:38912
    v_mfma_f32_16x16x32_bf16 v[128:131], v[232:235], v[208:211], v[128:131]
    buffer_load_dword v248, v249, s[52:55], 0 offen sc1
    v_mfma_f32_16x16x32_bf16 v[132:135], v[236:239], v[208:211], v[132:135]
    v_mfma_f32_16x16x32_bf16 v[136:139], v[216:219], v[212:215], v[136:139]
    v_mfma_f32_16x16x32_bf16 v[140:143], v[220:223], v[212:215], v[140:143]
    v_mfma_f32_16x16x32_bf16 v[144:147], v[224:227], v[212:215], v[144:147]
    v_mfma_f32_16x16x32_bf16 v[148:151], v[228:231], v[212:215], v[148:151]
    v_mfma_f32_16x16x32_bf16 v[152:155], v[232:235], v[212:215], v[152:155]
    v_mfma_f32_16x16x32_bf16 v[156:159], v[236:239], v[212:215], v[156:159]
    s_waitcnt vmcnt(8) lgkmcnt(0)
    s_barrier
    v_mfma_f32_16x16x32_bf16 v[64:67], v[176:179], v[160:163], v[64:67]
    ds_read_b64_tr_b16 v[216:217], v19 offset:24576
    v_mfma_f32_16x16x32_bf16 v[68:71], v[180:183], v[160:163], v[68:71]
    ds_read_b64_tr_b16 v[218:219], v19 offset:25088
    v_mfma_f32_16x16x32_bf16 v[72:75], v[184:187], v[160:163], v[72:75]
    ds_read_b64_tr_b16 v[220:221], v20 offset:24576
    v_mfma_f32_16x16x32_bf16 v[76:79], v[188:191], v[160:163], v[76:79]
    ds_read_b64_tr_b16 v[222:223], v20 offset:25088
    v_mfma_f32_16x16x32_bf16 v[80:83], v[192:195], v[160:163], v[80:83]
    ds_read_b64_tr_b16 v[224:225], v21 offset:24576
    v_mfma_f32_16x16x32_bf16 v[84:87], v[196:199], v[160:163], v[84:87]
    ds_read_b64_tr_b16 v[226:227], v21 offset:25088
    v_mfma_f32_16x16x32_bf16 v[88:91], v[176:179], v[164:167], v[88:91]
    ds_read_b64_tr_b16 v[228:229], v19 offset:36864
    v_mfma_f32_16x16x32_bf16 v[92:95], v[180:183], v[164:167], v[92:95]
    ds_read_b64_tr_b16 v[230:231], v19 offset:37376
    v_mfma_f32_16x16x32_bf16 v[96:99], v[184:187], v[164:167], v[96:99]
    ds_read_b64_tr_b16 v[232:233], v20 offset:36864
    v_mfma_f32_16x16x32_bf16 v[100:103], v[188:191], v[164:167], v[100:103]
    ds_read_b64_tr_b16 v[234:235], v20 offset:37376
    v_mfma_f32_16x16x32_bf16 v[104:107], v[192:195], v[164:167], v[104:107]
    ds_read_b64_tr_b16 v[236:237], v21 offset:36864
    v_mfma_f32_16x16x32_bf16 v[108:111], v[196:199], v[164:167], v[108:111]
    ds_read_b64_tr_b16 v[238:239], v21 offset:37376
    v_mfma_f32_16x16x32_bf16 v[112:115], v[176:179], v[168:171], v[112:115]
    ds_read_b128 v[200:203], v16 offset:32768
    v_mfma_f32_16x16x32_bf16 v[116:119], v[180:183], v[168:171], v[116:119]
    ds_read_b128 v[204:207], v16 offset:34816
    v_mfma_f32_16x16x32_bf16 v[120:123], v[184:187], v[168:171], v[120:123]
    ds_read_b128 v[208:211], v16 offset:36864
    v_mfma_f32_16x16x32_bf16 v[124:127], v[188:191], v[168:171], v[124:127]
    ds_read_b128 v[212:215], v16 offset:38912
    v_mfma_f32_16x16x32_bf16 v[128:131], v[192:195], v[168:171], v[128:131]
    v_mfma_f32_16x16x32_bf16 v[132:135], v[196:199], v[168:171], v[132:135]
    v_mfma_f32_16x16x32_bf16 v[136:139], v[176:179], v[172:175], v[136:139]
    v_mfma_f32_16x16x32_bf16 v[140:143], v[180:183], v[172:175], v[140:143]
    v_mfma_f32_16x16x32_bf16 v[144:147], v[184:187], v[172:175], v[144:147]
    v_mfma_f32_16x16x32_bf16 v[148:151], v[188:191], v[172:175], v[148:151]
    v_mfma_f32_16x16x32_bf16 v[152:155], v[192:195], v[172:175], v[152:155]
    v_mfma_f32_16x16x32_bf16 v[156:159], v[196:199], v[172:175], v[156:159]
    s_waitcnt vmcnt(0) lgkmcnt(0)
    s_mov_b32 s66, 0
L_poll_ffn:
    v_readfirstlane_b32 s67, v248
    s_add_u32 s66, s66, 1
    s_cmp_ge_u32 s67, 256
    s_cbranch_scc1 L_pollok_ffn
    s_cmp_ge_u32 s66, 0x40000
    s_cbranch_scc1 L_pollok_ffn
    s_sleep 2
    buffer_load_dword v248, v249, s[52:55], 0 offen sc1
    s_waitcnt vmcnt(0)
    s_branch L_poll_ffn
L_pollok_ffn:
    s_barrier
    v_mfma_f32_16x16x32_bf16 v[64:67], v[216:219], v[200:203], v[64:67]
    ds_read_b64_tr_b16 v[176:177], v22 offset:0
    v_mfma_f32_16x16x32_bf16 v[68:71], v[220:223], v[200:203], v[68:71]
    ds_read_b64_tr_b16 v[178:179], v22 offset:512
    v_mfma_f32_16x16x32_bf16 v[72:75], v[224:227], v[200:203], v[72:75]
    ds_read_b64_tr_b16 v[180:181], v23 offset:0
    v_mfma_f32_16x16x32_bf16 v[76:79], v[228:231], v[200:203], v[76:79]
    ds_read_b64_tr_b16 v[182:183], v23 offset:512
    v_mfma_f32_16x16x32_bf16 v[80:83], v[232:235], v[200:203], v[80:83]
    ds_read_b64_tr_b16 v[184:185], v24 offset:0
    v_mfma_f32_16x16x32_bf16 v[84:87], v[236:239], v[200:203], v[84:87]
    ds_read_b64_tr_b16 v[186:187], v24 offset:512
    v_mfma_f32_16x16x32_bf16 v[88:91], v[216:219], v[204:207], v[88:91]
    ds_read_b64_tr_b16 v[188:189], v22 offset:12288
    v_mfma_f32_16x16x32_bf16 v[92:95], v[220:223], v[204:207], v[92:95]
    ds_read_b64_tr_b16 v[190:191], v22 offset:12800
    v_mfma_f32_16x16x32_bf16 v[96:99], v[224:227], v[204:207], v[96:99]
    ds_read_b64_tr_b16 v[192:193], v23 offset:12288
    v_mfma_f32_16x16x32_bf16 v[100:103], v[228:231], v[204:207], v[100:103]
    ds_read_b64_tr_b16 v[194:195], v23 offset:12800
    v_mfma_f32_16x16x32_bf16 v[104:107], v[232:235], v[204:207], v[104:107]
    ds_read_b64_tr_b16 v[196:197], v24 offset:12288
    v_mfma_f32_16x16x32_bf16 v[108:111], v[236:239], v[204:207], v[108:111]
    ds_read_b64_tr_b16 v[198:199], v24 offset:12800
    v_mfma_f32_16x16x32_bf16 v[112:115], v[216:219], v[208:211], v[112:115]
    ds_read_b128 v[160:163], v15 offset:0
    v_mfma_f32_16x16x32_bf16 v[116:119], v[220:223], v[208:211], v[116:119]
    ds_read_b128 v[164:167], v15 offset:2048
    v_mfma_f32_16x16x32_bf16 v[120:123], v[224:227], v[208:211], v[120:123]
    ds_read_b128 v[168:171], v15 offset:4096
    v_mfma_f32_16x16x32_bf16 v[124:127], v[228:231], v[208:211], v[124:127]
    ds_read_b128 v[172:175], v15 offset:6144
    v_mfma_f32_16x16x32_bf16 v[128:131], v[232:235], v[208:211], v[128:131]
    buffer_load_dwordx2 v[36:37], v26, s[36:39], 0 offen offset:0 sc1
    v_mfma_f32_16x16x32_bf16 v[132:135], v[236:239], v[208:211], v[132:135]
    buffer_load_dwordx2 v[38:39], v26, s[36:39], 0 offen offset:256 sc1
    v_mfma_f32_16x16x32_bf16 v[136:139], v[216:219], v[212:215], v[136:139]
    buffer_load_dwordx2 v[40:41], v26, s[36:39], 0 offen offset:512 sc1
    v_mfma_f32_16x16x32_bf16 v[140:143], v[220:223], v[212:215], v[140:143]
    buffer_load_dwordx2 v[42:43], v26, s[36:39], 0 offen offset:768 sc1
    v_mfma_f32_16x16x32_bf16 v[144:147], v[224:227], v[212:215], v[144:147]
    s_mov_b32 m0, 150528
    s_nop 0
    buffer_load_dwordx4 v27, s[36:39], s72 offen sc1 lds
    v_mfma_f32_16x16x32_bf16 v[148:151], v[228:231], v[212:215], v[148:151]
    s_mov_b32 m0, 151552
    s_nop 0
    buffer_load_dwordx4 v27, s[36:39], s73 offen sc1 lds
    v_mfma_f32_16x16x32_bf16 v[152:155], v[232:235], v[212:215], v[152:155]
    v_mfma_f32_16x16x32_bf16 v[156:159], v[236:239], v[212:215], v[156:159]
    s_waitcnt vmcnt(2) lgkmcnt(0)
    s_barrier
    v_mfma_f32_16x16x32_bf16 v[64:67], v[176:179], v[160:163], v[64:67]
    ds_read_b64_tr_b16 v[216:217], v22 offset:24576
    v_mfma_f32_16x16x32_bf16 v[68:71], v[180:183], v[160:163], v[68:71]
    ds_read_b64_tr_b16 v[218:219], v22 offset:25088
    v_mfma_f32_16x16x32_bf16 v[72:75], v[184:187], v[160:163], v[72:75]
    ds_read_b64_tr_b16 v[220:221], v23 offset:24576
    v_mfma_f32_16x16x32_bf16 v[76:79], v[188:191], v[160:163], v[76:79]
    ds_read_b64_tr_b16 v[222:223], v23 offset:25088
    v_mfma_f32_16x16x32_bf16 v[80:83], v[192:195], v[160:163], v[80:83]
    ds_read_b64_tr_b16 v[224:225], v24 offset:24576
    v_mfma_f32_16x16x32_bf16 v[84:87], v[196:199], v[160:163], v[84:87]
    ds_read_b64_tr_b16 v[226:227], v24 offset:25088
    v_mfma_f32_16x16x32_bf16 v[88:91], v[176:179], v[164:167], v[88:91]
    ds_read_b64_tr_b16 v[228:229], v22 offset:36864
    v_mfma_f32_16x16x32_bf16 v[92:95], v[180:183], v[164:167], v[92:95]
    ds_read_b64_tr_b16 v[230:231], v22 offset:37376
    v_mfma_f32_16x16x32_bf16 v[96:99], v[184:187], v[164:167], v[96:99]
    ds_read_b64_tr_b16 v[232:233], v23 offset:36864
    v_mfma_f32_16x16x32_bf16 v[100:103], v[188:191], v[164:167], v[100:103]
    ds_read_b64_tr_b16 v[234:235], v23 offset:37376
    v_mfma_f32_16x16x32_bf16 v[104:107], v[192:195], v[164:167], v[104:107]
    ds_read_b64_tr_b16 v[236:237], v24 offset:36864
    v_mfma_f32_16x16x32_bf16 v[108:111], v[196:199], v[164:167], v[108:111]
    ds_read_b64_tr_b16 v[238:239], v24 offset:37376
    v_mfma_f32_16x16x32_bf16 v[112:115], v[176:179], v[168:171], v[112:115]
    ds_read_b128 v[200:203], v16 offset:0
    v_mfma_f32_16x16x32_bf16 v[116:119], v[180:183], v[168:171], v[116:119]
    ds_read_b128 v[204:207], v16 offset:2048
    v_mfma_f32_16x16x32_bf16 v[120:123], v[184:187], v[168:171], v[120:123]
    ds_read_b128 v[208:211], v16 offset:4096
    v_mfma_f32_16x16x32_bf16 v[124:127], v[188:191], v[168:171], v[124:127]
    ds_read_b128 v[212:215], v16 offset:6144
    v_mfma_f32_16x16x32_bf16 v[128:131], v[192:195], v[168:171], v[128:131]
    v_mfma_f32_16x16x32_bf16 v[132:135], v[196:199], v[168:171], v[132:135]
    v_mfma_f32_16x16x32_bf16 v[136:139], v[176:179], v[172:175], v[136:139]
    v_mfma_f32_16x16x32_bf16 v[140:143], v[180:183], v[172:175], v[140:143]
    v_mfma_f32_16x16x32_bf16 v[144:147], v[184:187], v[172:175], v[144:147]
    v_mfma_f32_16x16x32_bf16 v[148:151], v[188:191], v[172:175], v[148:151]
    v_mfma_f32_16x16x32_bf16 v[152:155], v[192:195], v[172:175], v[152:155]
    v_mfma_f32_16x16x32_bf16 v[156:159], v[196:199], v[172:175], v[156:159]
    s_waitcnt vmcnt(0) lgkmcnt(0)
    s_barrier
    v_mfma_f32_16x16x32_bf16 v[64:67], v[216:219], v[200:203], v[64:67]
    ds_read_b128 v[44:47], v28 offset:0
    v_mfma_f32_16x16x32_bf16 v[68:71], v[220:223], v[200:203], v[68:71]
    ds_read_b128 v[48:51], v28 offset:64
    v_mfma_f32_16x16x32_bf16 v[72:75], v[224:227], v[200:203], v[72:75]
    ds_read_b128 v[52:55], v28 offset:128
    v_mfma_f32_16x16x32_bf16 v[76:79], v[228:231], v[200:203], v[76:79]
    ds_read_b128 v[56:59], v28 offset:1024
    v_mfma_f32_16x16x32_bf16 v[80:83], v[232:235], v[200:203], v[80:83]
    ds_read_b128 v[60:63], v28 offset:1088
    v_mfma_f32_16x16x32_bf16 v[84:87], v[236:239], v[200:203], v[84:87]
    ds_read_b128 v[240:243], v28 offset:1152
    v_mfma_f32_16x16x32_bf16 v[88:91], v[216:219], v[204:207], v[88:91]
    v_mfma_f32_16x16x32_bf16 v[92:95], v[220:223], v[204:207], v[92:95]
    v_mfma_f32_16x16x32_bf16 v[96:99], v[224:227], v[204:207], v[96:99]
    v_mfma_f32_16x16x32_bf16 v[100:103], v[228:231], v[204:207], v[100:103]
    v_mfma_f32_16x16x32_bf16 v[104:107], v[232:235], v[204:207], v[104:107]
    v_mfma_f32_16x16x32_bf16 v[108:111], v[236:239], v[204:207], v[108:111]
    v_mfma_f32_16x16x32_bf16 v[112:115], v[216:219], v[208:211], v[112:115]
    v_mfma_f32_16x16x32_bf16 v[116:119], v[220:223], v[208:211], v[116:119]
    v_mfma_f32_16x16x32_bf16 v[120:123], v[224:227], v[208:211], v[120:123]
    v_mfma_f32_16x16x32_bf16 v[124:127], v[228:231], v[208:211], v[124:127]
    v_mfma_f32_16x16x32_bf16 v[128:131], v[232:235], v[208:211], v[128:131]
    v_mfma_f32_16x16x32_bf16 v[132:135], v[236:239], v[208:211], v[132:135]
    v_mfma_f32_16x16x32_bf16 v[136:139], v[216:219], v[212:215], v[136:139]
    v_mfma_f32_16x16x32_bf16 v[140:143], v[220:223], v[212:215], v[140:143]
    v_mfma_f32_16x16x32_bf16 v[144:147], v[224:227], v[212:215], v[144:147]
    v_mfma_f32_16x16x32_bf16 v[148:151], v[228:231], v[212:215], v[148:151]
    v_mfma_f32_16x16x32_bf16 v[152:155], v[232:235], v[212:215], v[152:155]
    v_mfma_f32_16x16x32_bf16 v[156:159], v[236:239], v[212:215], v[156:159]
    v_rcp_f32 v5, v37
    v_rcp_f32 v8, v39
    v_rcp_f32 v11, v41
    v_rcp_f32 v14, v43
    s_nop 0
    v_mul_f32 v7, v37, v37
    v_mul_f32 v6, v5, v5
    v_mul_f32 v5, 0xc0135761, v5
    v_mul_f32 v6, 0x3d372713, v6
    v_mul_f32 v6, v6, v5
    v_mul_f32 v10, v39, v39
    v_mul_f32 v9, v8, v8
    v_mul_f32 v8, 0xc0135761, v8
    v_mul_f32 v9, 0x3d372713, v9
    v_mul_f32 v9, v9, v8
    v_mul_f32 v13, v41, v41
    v_mul_f32 v12, v11, v11
    v_mul_f32 v11, 0xc0135761, v11
    v_mul_f32 v12, 0x3d372713, v12
    v_mul_f32 v12, v12, v11
    v_mul_f32 v16, v43, v43
    v_mul_f32 v15, v14, v14
    v_mul_f32 v14, 0xc0135761, v14
    v_mul_f32 v15, 0x3d372713, v15
    v_mul_f32 v15, v15, v14
    s_waitcnt lgkmcnt(0)
    v_pk_fma_f32 v[64:65], v[36:37], v[44:45], v[64:65] op_sel:[0,0,0] op_sel_hi:[0,1,1] neg_lo:[1,0,0] neg_hi:[1,0,0]
    v_pk_fma_f32 v[66:67], v[36:37], v[46:47], v[66:67] op_sel:[0,0,0] op_sel_hi:[0,1,1] neg_lo:[1,0,0] neg_hi:[1,0,0]
    v_pk_fma_f32 v[88:89], v[38:39], v[44:45], v[88:89] op_sel:[0,0,0] op_sel_hi:[0,1,1] neg_lo:[1,0,0] neg_hi:[1,0,0]
    v_pk_fma_f32 v[90:91], v[38:39], v[46:47], v[90:91] op_sel:[0,0,0] op_sel_hi:[0,1,1] neg_lo:[1,0,0] neg_hi:[1,0,0]
    v_pk_mul_f32 v[160:161], v[64:65], v[64:65] op_sel:[0,0] op_sel_hi:[1,1]
    v_pk_mul_f32 v[162:163], v[66:67], v[66:67] op_sel:[0,0] op_sel_hi:[1,1]
    v_pk_mul_f32 v[164:165], v[88:89], v[88:89] op_sel:[0,0] op_sel_hi:[1,1]
    v_pk_mul_f32 v[166:167], v[90:91], v[90:91] op_sel:[0,0] op_sel_hi:[1,1]
    v_pk_fma_f32 v[160:161], v[160:161], v[6:7], v[4:5] op_sel:[0,0,1] op_sel_hi:[1,0,1]
    v_pk_fma_f32 v[162:163], v[162:163], v[6:7], v[4:5] op_sel:[0,0,1] op_sel_hi:[1,0,1]
    v_pk_fma_f32 v[164:165], v[164:165], v[8:9], v[8:9] op_sel:[0,1,0] op_sel_hi:[1,1,0]
    v_pk_fma_f32 v[166:167], v[166:167], v[8:9], v[8:9] op_sel:[0,1,0] op_sel_hi:[1,1,0]
    v_pk_mul_f32 v[160:161], v[64:65], v[160:161] op_sel:[0,0] op_sel_hi:[1,1]
    v_pk_mul_f32 v[162:163], v[66:67], v[162:163] op_sel:[0,0] op_sel_hi:[1,1]
    v_pk_mul_f32 v[164:165], v[88:89], v[164:165] op_sel:[0,0] op_sel_hi:[1,1]
    v_pk_mul_f32 v[166:167], v[90:91], v[166:167] op_sel:[0,0] op_sel_hi:[1,1]
    v_exp_f32 v160, v160
    v_exp_f32 v161, v161
    v_exp_f32 v162, v162
    v_exp_f32 v163, v163
    v_exp_f32 v164, v164
    v_exp_f32 v165, v165
    v_exp_f32 v166, v166
    v_exp_f32 v167, v167
    v_pk_fma_f32 v[76:77], v[36:37], v[56:57], v[76:77] op_sel:[0,0,0] op_sel_hi:[0,1,1] neg_lo:[1,0,0] neg_hi:[1,0,0]
    v_pk_fma_f32 v[78:79], v[36:37], v[58:59], v[78:79] op_sel:[0,0,0] op_sel_hi:[0,1,1] neg_lo:[1,0,0] neg_hi:[1,0,0]
    v_pk_fma_f32 v[100:101], v[38:39], v[56:57], v[100:101] op_sel:[0,0,0] op_sel_hi:[0,1,1] neg_lo:[1,0,0] neg_hi:[1,0,0]
    v_pk_fma_f32 v[102:103], v[38:39], v[58:59], v[102:103] op_sel:[0,0,0] op_sel_hi:[0,1,1] neg_lo:[1,0,0] neg_hi:[1,0,0]
    v_pk_mul_f32 v[76:77], v[64:65], v[76:77] op_sel:[0,0] op_sel_hi:[1,1]
    v_pk_mul_f32 v[78:79], v[66:67], v[78:79] op_sel:[0,0] op_sel_hi:[1,1]
    v_pk_mul_f32 v[100:101], v[88:89], v[100:101] op_sel:[0,0] op_sel_hi:[1,1]
    v_pk_mul_f32 v[102:103], v[90:91], v[102:103] op_sel:[0,0] op_sel_hi:[1,1]
    v_pk_fma_f32 v[160:161], v[160:161], v[6:7], v[6:7] op_sel:[0,1,1] op_sel_hi:[1,1,1]
    v_pk_fma_f32 v[162:163], v[162:163], v[6:7], v[6:7] op_sel:[0,1,1] op_sel_hi:[1,1,1]
    v_pk_fma_f32 v[164:165], v[164:165], v[10:11], v[10:11] op_sel:[0,0,0] op_sel_hi:[1,0,0]
    v_pk_fma_f32 v[166:167], v[166:167], v[10:11], v[10:11] op_sel:[0,0,0] op_sel_hi:[1,0,0]
    v_rcp_f32 v160, v160
    v_rcp_f32 v161, v161
    v_rcp_f32 v162, v162
    v_rcp_f32 v163, v163
    v_rcp_f32 v164, v164
    v_rcp_f32 v165, v165
    v_rcp_f32 v166, v166
    v_rcp_f32 v167, v167
    s_nop 0
    v_pk_mul_f32 v[76:77], v[76:77], v[160:161] op_sel:[0,0] op_sel_hi:[1,1]
    v_pk_mul_f32 v[78:79], v[78:79], v[162:163] op_sel:[0,0] op_sel_hi:[1,1]
    v_pk_mul_f32 v[100:101], v[100:101], v[164:165] op_sel:[0,0] op_sel_hi:[1,1]
    v_pk_mul_f32 v[102:103], v[102:103], v[166:167] op_sel:[0,0] op_sel_hi:[1,1]
    v_cvt_pk_bf16_f32 v176, v76, v77
    v_cvt_pk_bf16_f32 v177, v78, v79
    v_cvt_pk_bf16_f32 v178, v100, v101
    v_cvt_pk_bf16_f32 v179, v102, v103
    s_nop 1
    v_permlane16_swap_b32 v176, v178
    v_permlane16_swap_b32 v177, v179
    s_nop 1
    buffer_store_dwordx4 v[176:179], v25, s[32:35], s70 offen offset:0 sc1
    v_pk_fma_f32 v[68:69], v[36:37], v[48:49], v[68:69] op_sel:[0,0,0] op_sel_hi:[0,1,1] neg_lo:[1,0,0] neg_hi:[1,0,0]
    v_pk_fma_f32 v[70:71], v[36:37], v[50:51], v[70:71] op_sel:[0,0,0] op_sel_hi:[0,1,1] neg_lo:[1,0,0] neg_hi:[1,0,0]
    v_pk_fma_f32 v[92:93], v[38:39], v[48:49], v[92:93] op_sel:[0,0,0] op_sel_hi:[0,1,1] neg_lo:[1,0,0] neg_hi:[1,0,0]
    v_pk_fma_f32 v[94:95], v[38:39], v[50:51], v[94:95] op_sel:[0,0,0] op_sel_hi:[0,1,1] neg_lo:[1,0,0] neg_hi:[1,0,0]
    v_pk_mul_f32 v[160:161], v[68:69], v[68:69] op_sel:[0,0] op_sel_hi:[1,1]
    v_pk_mul_f32 v[162:163], v[70:71], v[70:71] op_sel:[0,0] op_sel_hi:[1,1]
    v_pk_mul_f32 v[164:165], v[92:93], v[92:93] op_sel:[0,0] op_sel_hi:[1,1]
    v_pk_mul_f32 v[166:167], v[94:95], v[94:95] op_sel:[0,0] op_sel_hi:[1,1]
    v_pk_fma_f32 v[160:161], v[160:161], v[6:7], v[4:5] op_sel:[0,0,1] op_sel_hi:[1,0,1]
    v_pk_fma_f32 v[162:163], v[162:163], v[6:7], v[4:5] op_sel:[0,0,1] op_sel_hi:[1,0,1]
    v_pk_fma_f32 v[164:165], v[164:165], v[8:9], v[8:9] op_sel:[0,1,0] op_sel_hi:[1,1,0]
    v_pk_fma_f32 v[166:167], v[166:167], v[8:9], v[8:9] op_sel:[0,1,0] op_sel_hi:[1,1,0]
    v_pk_mul_f32 v[160:161], v[68:69], v[160:161] op_sel:[0,0] op_sel_hi:[1,1]
    v_pk_mul_f32 v[162:163], v[70:71], v[162:163] op_sel:[0,0] op_sel_hi:[1,1]
    v_pk_mul_f32 v[164:165], v[92:93], v[164:165] op_sel:[0,0] op_sel_hi:[1,1]
    v_pk_mul_f32 v[166:167], v[94:95], v[166:167] op_sel:[0,0] op_sel_hi:[1,1]
    v_exp_f32 v160, v160
    v_exp_f32 v161, v161
    v_exp_f32 v162, v162
    v_exp_f32 v163, v163
    v_exp_f32 v164, v164
    v_exp_f32 v165, v165
    v_exp_f32 v166, v166
    v_exp_f32 v167, v167
    v_pk_fma_f32 v[80:81], v[36:37], v[60:61], v[80:81] op_sel:[0,0,0] op_sel_hi:[0,1,1] neg_lo:[1,0,0] neg_hi:[1,0,0]
    v_pk_fma_f32 v[82:83], v[36:37], v[62:63], v[82:83] op_sel:[0,0,0] op_sel_hi:[0,1,1] neg_lo:[1,0,0] neg_hi:[1,0,0]
    v_pk_fma_f32 v[104:105], v[38:39], v[60:61], v[104:105] op_sel:[0,0,0] op_sel_hi:[0,1,1] neg_lo:[1,0,0] neg_hi:[1,0,0]
    v_pk_fma_f32 v[106:107], v[38:39], v[62:63], v[106:107] op_sel:[0,0,0] op_sel_hi:[0,1,1] neg_lo:[1,0,0] neg_hi:[1,0,0]
    v_pk_mul_f32 v[80:81], v[68:69], v[80:81] op_sel:[0,0] op_sel_hi:[1,1]
    v_pk_mul_f32 v[82:83], v[70:71], v[82:83] op_sel:[0,0] op_sel_hi:[1,1]
    v_pk_mul_f32 v[104:105], v[92:93], v[104:105] op_sel:[0,0] op_sel_hi:[1,1]
    v_pk_mul_f32 v[106:107], v[94:95], v[106:107] op_sel:[0,0] op_sel_hi:[1,1]
    v_pk_fma_f32 v[160:161], v[160:161], v[6:7], v[6:7] op_sel:[0,1,1] op_sel_hi:[1,1,1]
    v_pk_fma_f32 v[162:163], v[162:163], v[6:7], v[6:7] op_sel:[0,1,1] op_sel_hi:[1,1,1]
    v_pk_fma_f32 v[164:165], v[164:165], v[10:11], v[10:11] op_sel:[0,0,0] op_sel_hi:[1,0,0]
    v_pk_fma_f32 v[166:167], v[166:167], v[10:11], v[10:11] op_sel:[0,0,0] op_sel_hi:[1,0,0]
    v_rcp_f32 v160, v160
    v_rcp_f32 v161, v161
    v_rcp_f32 v162, v162
    v_rcp_f32 v163, v163
    v_rcp_f32 v164, v164
    v_rcp_f32 v165, v165
    v_rcp_f32 v166, v166
    v_rcp_f32 v167, v167
    s_nop 0
    v_pk_mul_f32 v[80:81], v[80:81], v[160:161] op_sel:[0,0] op_sel_hi:[1,1]
    v_pk_mul_f32 v[82:83], v[82:83], v[162:163] op_sel:[0,0] op_sel_hi:[1,1]
    v_pk_mul_f32 v[104:105], v[104:105], v[164:165] op_sel:[0,0] op_sel_hi:[1,1]
    v_pk_mul_f32 v[106:107], v[106:107], v[166:167] op_sel:[0,0] op_sel_hi:[1,1]
    v_cvt_pk_bf16_f32 v180, v80, v81
    v_cvt_pk_bf16_f32 v181, v82, v83
    v_cvt_pk_bf16_f32 v182, v104, v105
    v_cvt_pk_bf16_f32 v183, v106, v107
    s_nop 1
    v_permlane16_swap_b32 v180, v182
    v_permlane16_swap_b32 v181, v183
    s_nop 1
    buffer_store_dwordx4 v[180:183], v25, s[32:35], s70 offen offset:512 sc1
    v_pk_fma_f32 v[72:73], v[36:37], v[52:53], v[72:73] op_sel:[0,0,0] op_sel_hi:[0,1,1] neg_lo:[1,0,0] neg_hi:[1,0,0]
    v_pk_fma_f32 v[74:75], v[36:37], v[54:55], v[74:75] op_sel:[0,0,0] op_sel_hi:[0,1,1] neg_lo:[1,0,0] neg_hi:[1,0,0]
    v_pk_fma_f32 v[96:97], v[38:39], v[52:53], v[96:97] op_sel:[0,0,0] op_sel_hi:[0,1,1] neg_lo:[1,0,0] neg_hi:[1,0,0]
    v_pk_fma_f32 v[98:99], v[38:39], v[54:55], v[98:99] op_sel:[0,0,0] op_sel_hi:[0,1,1] neg_lo:[1,0,0] neg_hi:[1,0,0]
    v_pk_mul_f32 v[160:161], v[72:73], v[72:73] op_sel:[0,0] op_sel_hi:[1,1]
    v_pk_mul_f32 v[162:163], v[74:75], v[74:75] op_sel:[0,0] op_sel_hi:[1,1]
    v_pk_mul_f32 v[164:165], v[96:97], v[96:97] op_sel:[0,0] op_sel_hi:[1,1]
    v_pk_mul_f32 v[166:167], v[98:99], v[98:99] op_sel:[0,0] op_sel_hi:[1,1]
    v_pk_fma_f32 v[160:161], v[160:161], v[6:7], v[4:5] op_sel:[0,0,1] op_sel_hi:[1,0,1]
    v_pk_fma_f32 v[162:163], v[162:163], v[6:7], v[4:5] op_sel:[0,0,1] op_sel_hi:[1,0,1]
    v_pk_fma_f32 v[164:165], v[164:165], v[8:9], v[8:9] op_sel:[0,1,0] op_sel_hi:[1,1,0]
    v_pk_fma_f32 v[166:167], v[166:167], v[8:9], v[8:9] op_sel:[0,1,0] op_sel_hi:[1,1,0]
    v_pk_mul_f32 v[160:161], v[72:73], v[160:161] op_sel:[0,0] op_sel_hi:[1,1]
    v_pk_mul_f32 v[162:163], v[74:75], v[162:163] op_sel:[0,0] op_sel_hi:[1,1]
    v_pk_mul_f32 v[164:165], v[96:97], v[164:165] op_sel:[0,0] op_sel_hi:[1,1]
    v_pk_mul_f32 v[166:167], v[98:99], v[166:167] op_sel:[0,0] op_sel_hi:[1,1]
    v_exp_f32 v160, v160
    v_exp_f32 v161, v161
    v_exp_f32 v162, v162
    v_exp_f32 v163, v163
    v_exp_f32 v164, v164
    v_exp_f32 v165, v165
    v_exp_f32 v166, v166
    v_exp_f32 v167, v167
    v_pk_fma_f32 v[84:85], v[36:37], v[240:241], v[84:85] op_sel:[0,0,0] op_sel_hi:[0,1,1] neg_lo:[1,0,0] neg_hi:[1,0,0]
    v_pk_fma_f32 v[86:87], v[36:37], v[242:243], v[86:87] op_sel:[0,0,0] op_sel_hi:[0,1,1] neg_lo:[1,0,0] neg_hi:[1,0,0]
    v_pk_fma_f32 v[108:109], v[38:39], v[240:241], v[108:109] op_sel:[0,0,0] op_sel_hi:[0,1,1] neg_lo:[1,0,0] neg_hi:[1,0,0]
    v_pk_fma_f32 v[110:111], v[38:39], v[242:243], v[110:111] op_sel:[0,0,0] op_sel_hi:[0,1,1] neg_lo:[1,0,0] neg_hi:[1,0,0]
    v_pk_mul_f32 v[84:85], v[72:73], v[84:85] op_sel:[0,0] op_sel_hi:[1,1]
    v_pk_mul_f32 v[86:87], v[74:75], v[86:87] op_sel:[0,0] op_sel_hi:[1,1]
    v_pk_mul_f32 v[108:109], v[96:97], v[108:109] op_sel:[0,0] op_sel_hi:[1,1]
    v_pk_mul_f32 v[110:111], v[98:99], v[110:111] op_sel:[0,0] op_sel_hi:[1,1]
    v_pk_fma_f32 v[160:161], v[160:161], v[6:7], v[6:7] op_sel:[0,1,1] op_sel_hi:[1,1,1]
    v_pk_fma_f32 v[162:163], v[162:163], v[6:7], v[6:7] op_sel:[0,1,1] op_sel_hi:[1,1,1]
    v_pk_fma_f32 v[164:165], v[164:165], v[10:11], v[10:11] op_sel:[0,0,0] op_sel_hi:[1,0,0]
    v_pk_fma_f32 v[166:167], v[166:167], v[10:11], v[10:11] op_sel:[0,0,0] op_sel_hi:[1,0,0]
    v_rcp_f32 v160, v160
    v_rcp_f32 v161, v161
    v_rcp_f32 v162, v162
    v_rcp_f32 v163, v163
    v_rcp_f32 v164, v164
    v_rcp_f32 v165, v165
    v_rcp_f32 v166, v166
    v_rcp_f32 v167, v167
    s_nop 0
    v_pk_mul_f32 v[84:85], v[84:85], v[160:161] op_sel:[0,0] op_sel_hi:[1,1]
    v_pk_mul_f32 v[86:87], v[86:87], v[162:163] op_sel:[0,0] op_sel_hi:[1,1]
    v_pk_mul_f32 v[108:109], v[108:109], v[164:165] op_sel:[0,0] op_sel_hi:[1,1]
    v_pk_mul_f32 v[110:111], v[110:111], v[166:167] op_sel:[0,0] op_sel_hi:[1,1]
    v_cvt_pk_bf16_f32 v184, v84, v85
    v_cvt_pk_bf16_f32 v185, v86, v87
    v_cvt_pk_bf16_f32 v186, v108, v109
    v_cvt_pk_bf16_f32 v187, v110, v111
    s_nop 1
    v_permlane16_swap_b32 v184, v186
    v_permlane16_swap_b32 v185, v187
    s_nop 1
    buffer_store_dwordx4 v[184:187], v25, s[32:35], s70 offen offset:1024 sc1
    v_pk_fma_f32 v[112:113], v[40:41], v[44:45], v[112:113] op_sel:[0,0,0] op_sel_hi:[0,1,1] neg_lo:[1,0,0] neg_hi:[1,0,0]
    v_pk_fma_f32 v[114:115], v[40:41], v[46:47], v[114:115] op_sel:[0,0,0] op_sel_hi:[0,1,1] neg_lo:[1,0,0] neg_hi:[1,0,0]
    v_pk_fma_f32 v[136:137], v[42:43], v[44:45], v[136:137] op_sel:[0,0,0] op_sel_hi:[0,1,1] neg_lo:[1,0,0] neg_hi:[1,0,0]
    v_pk_fma_f32 v[138:139], v[42:43], v[46:47], v[138:139] op_sel:[0,0,0] op_sel_hi:[0,1,1] neg_lo:[1,0,0] neg_hi:[1,0,0]
    v_pk_mul_f32 v[160:161], v[112:113], v[112:113] op_sel:[0,0] op_sel_hi:[1,1]
    v_pk_mul_f32 v[162:163], v[114:115], v[114:115] op_sel:[0,0] op_sel_hi:[1,1]
    v_pk_mul_f32 v[164:165], v[136:137], v[136:137] op_sel:[0,0] op_sel_hi:[1,1]
    v_pk_mul_f32 v[166:167], v[138:139], v[138:139] op_sel:[0,0] op_sel_hi:[1,1]
    v_pk_fma_f32 v[160:161], v[160:161], v[12:13], v[10:11] op_sel:[0,0,1] op_sel_hi:[1,0,1]
    v_pk_fma_f32 v[162:163], v[162:163], v[12:13], v[10:11] op_sel:[0,0,1] op_sel_hi:[1,0,1]
    v_pk_fma_f32 v[164:165], v[164:165], v[14:15], v[14:15] op_sel:[0,1,0] op_sel_hi:[1,1,0]
    v_pk_fma_f32 v[166:167], v[166:167], v[14:15], v[14:15] op_sel:[0,1,0] op_sel_hi:[1,1,0]
    v_pk_mul_f32 v[160:161], v[112:113], v[160:161] op_sel:[0,0] op_sel_hi:[1,1]
    v_pk_mul_f32 v[162:163], v[114:115], v[162:163] op_sel:[0,0] op_sel_hi:[1,1]
    v_pk_mul_f32 v[164:165], v[136:137], v[164:165] op_sel:[0,0] op_sel_hi:[1,1]
    v_pk_mul_f32 v[166:167], v[138:139], v[166:167] op_sel:[0,0] op_sel_hi:[1,1]
    v_exp_f32 v160, v160
    v_exp_f32 v161, v161
    v_exp_f32 v162, v162
    v_exp_f32 v163, v163
    v_exp_f32 v164, v164
    v_exp_f32 v165, v165
    v_exp_f32 v166, v166
    v_exp_f32 v167, v167
    v_pk_fma_f32 v[124:125], v[40:41], v[56:57], v[124:125] op_sel:[0,0,0] op_sel_hi:[0,1,1] neg_lo:[1,0,0] neg_hi:[1,0,0]
    v_pk_fma_f32 v[126:127], v[40:41], v[58:59], v[126:127] op_sel:[0,0,0] op_sel_hi:[0,1,1] neg_lo:[1,0,0] neg_hi:[1,0,0]
    v_pk_fma_f32 v[148:149], v[42:43], v[56:57], v[148:149] op_sel:[0,0,0] op_sel_hi:[0,1,1] neg_lo:[1,0,0] neg_hi:[1,0,0]
    v_pk_fma_f32 v[150:151], v[42:43], v[58:59], v[150:151] op_sel:[0,0,0] op_sel_hi:[0,1,1] neg_lo:[1,0,0] neg_hi:[1,0,0]
    v_pk_mul_f32 v[124:125], v[112:113], v[124:125] op_sel:[0,0] op_sel_hi:[1,1]
    v_pk_mul_f32 v[126:127], v[114:115], v[126:127] op_sel:[0,0] op_sel_hi:[1,1]
    v_pk_mul_f32 v[148:149], v[136:137], v[148:149] op_sel:[0,0] op_sel_hi:[1,1]
    v_pk_mul_f32 v[150:151], v[138:139], v[150:151] op_sel:[0,0] op_sel_hi:[1,1]
    v_pk_fma_f32 v[160:161], v[160:161], v[12:13], v[12:13] op_sel:[0,1,1] op_sel_hi:[1,1,1]
    v_pk_fma_f32 v[162:163], v[162:163], v[12:13], v[12:13] op_sel:[0,1,1] op_sel_hi:[1,1,1]
    v_pk_fma_f32 v[164:165], v[164:165], v[16:17], v[16:17] op_sel:[0,0,0] op_sel_hi:[1,0,0]
    v_pk_fma_f32 v[166:167], v[166:167], v[16:17], v[16:17] op_sel:[0,0,0] op_sel_hi:[1,0,0]
    v_rcp_f32 v160, v160
    v_rcp_f32 v161, v161
    v_rcp_f32 v162, v162
    v_rcp_f32 v163, v163
    v_rcp_f32 v164, v164
    v_rcp_f32 v165, v165
    v_rcp_f32 v166, v166
    v_rcp_f32 v167, v167
    s_nop 0
    v_pk_mul_f32 v[124:125], v[124:125], v[160:161] op_sel:[0,0] op_sel_hi:[1,1]
    v_pk_mul_f32 v[126:127], v[126:127], v[162:163] op_sel:[0,0] op_sel_hi:[1,1]
    v_pk_mul_f32 v[148:149], v[148:149], v[164:165] op_sel:[0,0] op_sel_hi:[1,1]
    v_pk_mul_f32 v[150:151], v[150:151], v[166:167] op_sel:[0,0] op_sel_hi:[1,1]
    v_cvt_pk_bf16_f32 v176, v124, v125
    v_cvt_pk_bf16_f32 v177, v126, v127
    v_cvt_pk_bf16_f32 v178, v148, v149
    v_cvt_pk_bf16_f32 v179, v150, v151
    s_nop 1
    v_permlane16_swap_b32 v176, v178
    v_permlane16_swap_b32 v177, v179
    s_nop 1
    buffer_store_dwordx4 v[176:179], v25, s[32:35], s71 offen offset:0 sc1
    v_pk_fma_f32 v[116:117], v[40:41], v[48:49], v[116:117] op_sel:[0,0,0] op_sel_hi:[0,1,1] neg_lo:[1,0,0] neg_hi:[1,0,0]
    v_pk_fma_f32 v[118:119], v[40:41], v[50:51], v[118:119] op_sel:[0,0,0] op_sel_hi:[0,1,1] neg_lo:[1,0,0] neg_hi:[1,0,0]
    v_pk_fma_f32 v[140:141], v[42:43], v[48:49], v[140:141] op_sel:[0,0,0] op_sel_hi:[0,1,1] neg_lo:[1,0,0] neg_hi:[1,0,0]
    v_pk_fma_f32 v[142:143], v[42:43], v[50:51], v[142:143] op_sel:[0,0,0] op_sel_hi:[0,1,1] neg_lo:[1,0,0] neg_hi:[1,0,0]
    v_pk_mul_f32 v[160:161], v[116:117], v[116:117] op_sel:[0,0] op_sel_hi:[1,1]
    v_pk_mul_f32 v[162:163], v[118:119], v[118:119] op_sel:[0,0] op_sel_hi:[1,1]
    v_pk_mul_f32 v[164:165], v[140:141], v[140:141] op_sel:[0,0] op_sel_hi:[1,1]
    v_pk_mul_f32 v[166:167], v[142:143], v[142:143] op_sel:[0,0] op_sel_hi:[1,1]
    v_pk_fma_f32 v[160:161], v[160:161], v[12:13], v[10:11] op_sel:[0,0,1] op_sel_hi:[1,0,1]
    v_pk_fma_f32 v[162:163], v[162:163], v[12:13], v[10:11] op_sel:[0,0,1] op_sel_hi:[1,0,1]
    v_pk_fma_f32 v[164:165], v[164:165], v[14:15], v[14:15] op_sel:[0,1,0] op_sel_hi:[1,1,0]
    v_pk_fma_f32 v[166:167], v[166:167], v[14:15], v[14:15] op_sel:[0,1,0] op_sel_hi:[1,1,0]
    v_pk_mul_f32 v[160:161], v[116:117], v[160:161] op_sel:[0,0] op_sel_hi:[1,1]
    v_pk_mul_f32 v[162:163], v[118:119], v[162:163] op_sel:[0,0] op_sel_hi:[1,1]
    v_pk_mul_f32 v[164:165], v[140:141], v[164:165] op_sel:[0,0] op_sel_hi:[1,1]
    v_pk_mul_f32 v[166:167], v[142:143], v[166:167] op_sel:[0,0] op_sel_hi:[1,1]
    v_exp_f32 v160, v160
    v_exp_f32 v161, v161
    v_exp_f32 v162, v162
    v_exp_f32 v163, v163
    v_exp_f32 v164, v164
    v_exp_f32 v165, v165
    v_exp_f32 v166, v166
    v_exp_f32 v167, v167
    v_pk_fma_f32 v[128:129], v[40:41], v[60:61], v[128:129] op_sel:[0,0,0] op_sel_hi:[0,1,1] neg_lo:[1,0,0] neg_hi:[1,0,0]
    v_pk_fma_f32 v[130:131], v[40:41], v[62:63], v[130:131] op_sel:[0,0,0] op_sel_hi:[0,1,1] neg_lo:[1,0,0] neg_hi:[1,0,0]
    v_pk_fma_f32 v[152:153], v[42:43], v[60:61], v[152:153] op_sel:[0,0,0] op_sel_hi:[0,1,1] neg_lo:[1,0,0] neg_hi:[1,0,0]
    v_pk_fma_f32 v[154:155], v[42:43], v[62:63], v[154:155] op_sel:[0,0,0] op_sel_hi:[0,1,1] neg_lo:[1,0,0] neg_hi:[1,0,0]
    v_pk_mul_f32 v[128:129], v[116:117], v[128:129] op_sel:[0,0] op_sel_hi:[1,1]
    v_pk_mul_f32 v[130:131], v[118:119], v[130:131] op_sel:[0,0] op_sel_hi:[1,1]
    v_pk_mul_f32 v[152:153], v[140:141], v[152:153] op_sel:[0,0] op_sel_hi:[1,1]
    v_pk_mul_f32 v[154:155], v[142:143], v[154:155] op_sel:[0,0] op_sel_hi:[1,1]
    v_pk_fma_f32 v[160:161], v[160:161], v[12:13], v[12:13] op_sel:[0,1,1] op_sel_hi:[1,1,1]
    v_pk_fma_f32 v[162:163], v[162:163], v[12:13], v[12:13] op_sel:[0,1,1] op_sel_hi:[1,1,1]
    v_pk_fma_f32 v[164:165], v[164:165], v[16:17], v[16:17] op_sel:[0,0,0] op_sel_hi:[1,0,0]
    v_pk_fma_f32 v[166:167], v[166:167], v[16:17], v[16:17] op_sel:[0,0,0] op_sel_hi:[1,0,0]
    v_rcp_f32 v160, v160
    v_rcp_f32 v161, v161
    v_rcp_f32 v162, v162
    v_rcp_f32 v163, v163
    v_rcp_f32 v164, v164
    v_rcp_f32 v165, v165
    v_rcp_f32 v166, v166
    v_rcp_f32 v167, v167
    s_nop 0
    v_pk_mul_f32 v[128:129], v[128:129], v[160:161] op_sel:[0,0] op_sel_hi:[1,1]
    v_pk_mul_f32 v[130:131], v[130:131], v[162:163] op_sel:[0,0] op_sel_hi:[1,1]
    v_pk_mul_f32 v[152:153], v[152:153], v[164:165] op_sel:[0,0] op_sel_hi:[1,1]
    v_pk_mul_f32 v[154:155], v[154:155], v[166:167] op_sel:[0,0] op_sel_hi:[1,1]
    v_cvt_pk_bf16_f32 v180, v128, v129
    v_cvt_pk_bf16_f32 v181, v130, v131
    v_cvt_pk_bf16_f32 v182, v152, v153
    v_cvt_pk_bf16_f32 v183, v154, v155
    s_nop 1
    v_permlane16_swap_b32 v180, v182
    v_permlane16_swap_b32 v181, v183
    s_nop 1
    buffer_store_dwordx4 v[180:183], v25, s[32:35], s71 offen offset:512 sc1
    v_pk_fma_f32 v[120:121], v[40:41], v[52:53], v[120:121] op_sel:[0,0,0] op_sel_hi:[0,1,1] neg_lo:[1,0,0] neg_hi:[1,0,0]
    v_pk_fma_f32 v[122:123], v[40:41], v[54:55], v[122:123] op_sel:[0,0,0] op_sel_hi:[0,1,1] neg_lo:[1,0,0] neg_hi:[1,0,0]
    v_pk_fma_f32 v[144:145], v[42:43], v[52:53], v[144:145] op_sel:[0,0,0] op_sel_hi:[0,1,1] neg_lo:[1,0,0] neg_hi:[1,0,0]
    v_pk_fma_f32 v[146:147], v[42:43], v[54:55], v[146:147] op_sel:[0,0,0] op_sel_hi:[0,1,1] neg_lo:[1,0,0] neg_hi:[1,0,0]
    v_pk_mul_f32 v[160:161], v[120:121], v[120:121] op_sel:[0,0] op_sel_hi:[1,1]
    v_pk_mul_f32 v[162:163], v[122:123], v[122:123] op_sel:[0,0] op_sel_hi:[1,1]
    v_pk_mul_f32 v[164:165], v[144:145], v[144:145] op_sel:[0,0] op_sel_hi:[1,1]
    v_pk_mul_f32 v[166:167], v[146:147], v[146:147] op_sel:[0,0] op_sel_hi:[1,1]
    v_pk_fma_f32 v[160:161], v[160:161], v[12:13], v[10:11] op_sel:[0,0,1] op_sel_hi:[1,0,1]
    v_pk_fma_f32 v[162:163], v[162:163], v[12:13], v[10:11] op_sel:[0,0,1] op_sel_hi:[1,0,1]
    v_pk_fma_f32 v[164:165], v[164:165], v[14:15], v[14:15] op_sel:[0,1,0] op_sel_hi:[1,1,0]
    v_pk_fma_f32 v[166:167], v[166:167], v[14:15], v[14:15] op_sel:[0,1,0] op_sel_hi:[1,1,0]
    v_pk_mul_f32 v[160:161], v[120:121], v[160:161] op_sel:[0,0] op_sel_hi:[1,1]
    v_pk_mul_f32 v[162:163], v[122:123], v[162:163] op_sel:[0,0] op_sel_hi:[1,1]
    v_pk_mul_f32 v[164:165], v[144:145], v[164:165] op_sel:[0,0] op_sel_hi:[1,1]
    v_pk_mul_f32 v[166:167], v[146:147], v[166:167] op_sel:[0,0] op_sel_hi:[1,1]
    v_exp_f32 v160, v160
    v_exp_f32 v161, v161
    v_exp_f32 v162, v162
    v_exp_f32 v163, v163
    v_exp_f32 v164, v164
    v_exp_f32 v165, v165
    v_exp_f32 v166, v166
    v_exp_f32 v167, v167
    v_pk_fma_f32 v[132:133], v[40:41], v[240:241], v[132:133] op_sel:[0,0,0] op_sel_hi:[0,1,1] neg_lo:[1,0,0] neg_hi:[1,0,0]
    v_pk_fma_f32 v[134:135], v[40:41], v[242:243], v[134:135] op_sel:[0,0,0] op_sel_hi:[0,1,1] neg_lo:[1,0,0] neg_hi:[1,0,0]
    v_pk_fma_f32 v[156:157], v[42:43], v[240:241], v[156:157] op_sel:[0,0,0] op_sel_hi:[0,1,1] neg_lo:[1,0,0] neg_hi:[1,0,0]
    v_pk_fma_f32 v[158:159], v[42:43], v[242:243], v[158:159] op_sel:[0,0,0] op_sel_hi:[0,1,1] neg_lo:[1,0,0] neg_hi:[1,0,0]
    v_pk_mul_f32 v[132:133], v[120:121], v[132:133] op_sel:[0,0] op_sel_hi:[1,1]
    v_pk_mul_f32 v[134:135], v[122:123], v[134:135] op_sel:[0,0] op_sel_hi:[1,1]
    v_pk_mul_f32 v[156:157], v[144:145], v[156:157] op_sel:[0,0] op_sel_hi:[1,1]
    v_pk_mul_f32 v[158:159], v[146:147], v[158:159] op_sel:[0,0] op_sel_hi:[1,1]
    v_pk_fma_f32 v[160:161], v[160:161], v[12:13], v[12:13] op_sel:[0,1,1] op_sel_hi:[1,1,1]
    v_pk_fma_f32 v[162:163], v[162:163], v[12:13], v[12:13] op_sel:[0,1,1] op_sel_hi:[1,1,1]
    v_pk_fma_f32 v[164:165], v[164:165], v[16:17], v[16:17] op_sel:[0,0,0] op_sel_hi:[1,0,0]
    v_pk_fma_f32 v[166:167], v[166:167], v[16:17], v[16:17] op_sel:[0,0,0] op_sel_hi:[1,0,0]
    v_rcp_f32 v160, v160
    v_rcp_f32 v161, v161
    v_rcp_f32 v162, v162
    v_rcp_f32 v163, v163
    v_rcp_f32 v164, v164
    v_rcp_f32 v165, v165
    v_rcp_f32 v166, v166
    v_rcp_f32 v167, v167
    s_nop 0
    v_pk_mul_f32 v[132:133], v[132:133], v[160:161] op_sel:[0,0] op_sel_hi:[1,1]
    v_pk_mul_f32 v[134:135], v[134:135], v[162:163] op_sel:[0,0] op_sel_hi:[1,1]
    v_pk_mul_f32 v[156:157], v[156:157], v[164:165] op_sel:[0,0] op_sel_hi:[1,1]
    v_pk_mul_f32 v[158:159], v[158:159], v[166:167] op_sel:[0,0] op_sel_hi:[1,1]
    v_cvt_pk_bf16_f32 v184, v132, v133
    v_cvt_pk_bf16_f32 v185, v134, v135
    v_cvt_pk_bf16_f32 v186, v156, v157
    v_cvt_pk_bf16_f32 v187, v158, v159
    s_nop 1
    v_permlane16_swap_b32 v184, v186
    v_permlane16_swap_b32 v185, v187
    s_nop 1
    buffer_store_dwordx4 v[184:187], v25, s[32:35], s71 offen offset:1024 sc1
    s_and_b32 s64, s2, 7
    s_lshr_b32 s65, s2, 3
    s_cmp_ge_u32 s64, 2
    s_cselect_b32 s66, 12, 31
    s_cselect_b32 s67, 12, 99
    s_cmp_eq_u32 s65, s67
    s_cselect_b32 s68, 1, 0
    s_cmp_eq_u32 s65, 31
    s_cselect_b32 s65, s66, s65
    s_min_u32 s66, s64, 2
    s_mul_i32 s64, s64, 31
    s_add_u32 s64, s64, s66
    s_add_u32 s65, s64, s65
    s_mul_i32 s64, s65, 205
    s_lshr_b32 s64, s64, 11
    s_mul_i32 s66, s64, 10
    s_sub_u32 s65, s65, s66
    s_mul_i32 s66, s64, 5
    s_mov_b32 s67, 5
    s_cmp_gt_u32 s64, 2
    s_addc_u32 s66, s66, 0
    s_cmp_eq_u32 s64, 2
    s_addc_u32 s67, s67, 0
    s_cmp_gt_u32 s64, 5
    s_addc_u32 s66, s66, 0
    s_cmp_eq_u32 s64, 5
    s_addc_u32 s67, s67, 0
    s_cmp_gt_u32 s64, 8
    s_addc_u32 s66, s66, 0
    s_cmp_eq_u32 s64, 8
    s_addc_u32 s67, s67, 0
    v_bfe_u32 v17, v2, 1, 2
    v_bfe_u32 v18, v2, 4, 1
    v_xor_b32 v17, v17, v18
    v_and_b32 v18, 1, v2
    v_lshlrev_b32 v17, 5, v17
    v_lshl_add_u32 v17, v18, 4, v17
    s_and_b32 s3, s56, 1
    s_lshl_b32 s3, s3, 6
    v_xor_b32 v17, s3, v17
    v_lshrrev_b32 v18, 3, v2
    v_mul_u32_u24 v18, 1280, v18
    s_mul_i32 s3, s56, 10240
    s_lshl_b32 s64, s65, 7
    s_add_u32 s3, s3, s64
    v_add3_u32 v20, v17, v18, s3
    s_lshl_b32 s65, s56, 10
    s_mov_b32 s64, 0
    s_add_u32 m0, s65, 0x18000
    s_nop 0
    buffer_load_dwordx4 v20, s[44:47], s64 offen lds
    s_add_u32 s64, s64, 81920
    s_add_u32 m0, s65, 0x1a000
    s_nop 0
    buffer_load_dwordx4 v20, s[44:47], s64 offen lds
    s_add_u32 s64, s64, 81920
    s_add_u32 m0, s65, 0x1c000
    s_nop 0
    buffer_load_dwordx4 v20, s[44:47], s64 offen lds
    s_add_u32 s64, s64, 81920
    s_add_u32 m0, s65, 0x1e000
    s_nop 0
    buffer_load_dwordx4 v20, s[44:47], s64 offen lds
    s_add_u32 s64, s64, 81920
    s_add_u32 m0, s65, 0x20000
    s_nop 0
    buffer_load_dwordx4 v20, s[44:47], s64 offen lds
    s_add_u32 s64, s64, 81920
    s_add_u32 m0, s65, 0x22000
    s_nop 0
    buffer_load_dwordx4 v20, s[44:47], s64 offen lds
    s_add_u32 s64, s64, 81920
    s_lshl_b32 s3, s2, 7
    s_add_u32 s3, s3, 65536
    v_mov_b32 v1, 0x40000000
    v_mov_b32 v5, s3
    v_cmp_eq_u32 vcc, 0, v0
    v_mov_b32 v6, 1
    s_waitcnt vmcnt(0)
    s_barrier
    v_cndmask_b32 v1, v1, v5, vcc
    buffer_store_dword v6, v1, s[36:39], 0 offen sc1
    s_branch L_phase2
L_k1_att:
    s_mov_b32 s62, s58
    s_mov_b32 s28, s6
    s_mov_b32 s29, s7
    s_mov_b32 s30, 0x258000
    s_mov_b32 s31, 0x00020000
    s_add_u32 s66, s62, s57
    s_cmp_ge_u32 s66, 10
    s_cselect_b32 s67, 10, 0
    s_sub_u32 s66, s66, s67
    s_cmp_ge_u32 s66, 10
    s_cselect_b32 s67, 10, 0
    s_sub_u32 s66, s66, s67
    s_and_b32 s66, s66, 14
    s_lshl_b32 s64, s66, 7
    s_mul_i32 s65, s66, 245760
    s_mul_i32 s70, s57, 160
    v_mul_u32_u24 v16, 3840, v7
    v_add_u32 v16, s70, v16
    s_lshr_b32 s66, s56, 1
    s_lshl_b32 s66, s66, 2
    v_mov_b32 v17, 1120
    v_add_u32 v1, s66, v8
    v_min_u32 v1, 14, v1
    v_lshlrev_b32 v13, 5, v1
    v_lshl_add_u32 v13, v9, 4, v13
    v_cmp_le_u32 vcc, 5, v1
    v_add_u32 v13, v13, v16
    s_and_b32 s67, s56, 1
    v_cndmask_b32 v18, 0, v17, vcc
    v_cmp_le_u32 vcc, 10, v1
    v_add_u32 v13, v13, v18
    s_lshl_b32 s67, s67, 1
    v_cndmask_b32 v18, 0, v17, vcc
    s_add_u32 s67, s67, 0
    s_mul_i32 s67, s67, 30720
    v_add3_u32 v13, v13, v18, s67
    v_xor_b32 v1, 2, v8
    v_add_u32 v1, s66, v1
    v_min_u32 v1, 14, v1
    v_lshlrev_b32 v14, 5, v1
    v_lshl_add_u32 v14, v9, 4, v14
    v_cmp_le_u32 vcc, 5, v1
    v_add_u32 v14, v14, v16
    s_and_b32 s67, s56, 1
    v_cndmask_b32 v18, 0, v17, vcc
    v_cmp_le_u32 vcc, 10, v1
    v_add_u32 v14, v14, v18
    s_lshl_b32 s67, s67, 1
    v_cndmask_b32 v18, 0, v17, vcc
    s_add_u32 s67, s67, 1
    s_mul_i32 s67, s67, 30720
    v_add3_u32 v14, v14, v18, s67
    s_and_b32 s66, s56, 1
    s_lshl_b32 s66, s66, 6
    v_xor_b32 v1, s66, v10
    s_mul_i32 s66, s62, 20
    s_add_u32 s66, s66, s56
    s_max_u32 s67, s66, 2
    s_sub_u32 s67, s67, 2
    s_min_u32 s67, s67, 255
    s_mul_i32 s67, s67, 10240
    v_add_u32 v10, s67, v1
    s_add_u32 s67, s66, 6
    s_min_u32 s68, s67, 255
    s_mul_i32 s68, s68, 10240
    v_add_u32 v11, s68, v1
    s_add_u32 s67, s66, 14
    s_min_u32 s67, s67, 255
    s_mul_i32 s67, s67, 10240
    s_cmp_lt_u32 s56, 6
    s_cselect_b32 s68, s67, s68
    s_mov_b32 s78, 8192
    s_cselect_b32 s78, 16384, s78
    v_add_u32 v12, s68, v1
    s_lshl_b32 s79, s56, 10
    s_add_u32 s78, s78, s79
    s_lshl_b32 s3, s56, 11
    s_mul_i32 s66, s59, 12288
    s_add_u32 s66, s66, 65536
    v_xor_b32 v16, 64, v15
    v_add_u32 v16, s66, v16
    v_add_u32 v15, s66, v15
    s_lshl_b32 s66, s60, 12
    v_xor_b32 v17, 0, v6
    v_lshl_add_u32 v17, v17, 5, v5
    v_add_u32 v17, s66, v17
    v_xor_b32 v18, 1, v6
    v_lshl_add_u32 v18, v18, 5, v5
    v_add_u32 v18, s66, v18
    v_xor_b32 v19, 2, v6
    v_lshl_add_u32 v19, v19, 5, v5
    v_add_u32 v19, s66, v19
    v_xor_b32 v20, 3, v6
    v_lshl_add_u32 v20, v20, 5, v5
    v_add_u32 v20, s66, v20
    s_cmp_eq_u32 s59, 1
    s_cbranch_scc1 L_att_wm1
    s_add_u32 m0, s3, 0x0
    s_nop 0
    buffer_load_dwordx4 v13, s[28:31], s65 offen lds
    s_add_u32 m0, s3, 0x400
    s_nop 0
    buffer_load_dwordx4 v14, s[28:31], s65 offen lds
    s_add_u32 s65, s65, 122880
    s_cmp_ge_u32 s65, 2457600
    s_cselect_b32 s65, 0, s65
    s_add_u32 m0, s79, 0x10000
    s_nop 0
    buffer_load_dwordx4 v10, s[24:27], s64 offen lds
    s_add_u32 m0, s79, 0x12000
    s_nop 0
    buffer_load_dwordx4 v11, s[24:27], s64 offen lds
    s_add_u32 m0, s78, 0x10000
    s_nop 0
    buffer_load_dwordx4 v12, s[24:27], s64 offen lds
    s_add_u32 s64, s64, 128
    s_cmp_ge_u32 s64, 1280
    s_cselect_b32 s64, 0, s64
    s_add_u32 m0, s3, 0x4000
    s_nop 0
    buffer_load_dwordx4 v13, s[28:31], s65 offen lds
    s_add_u32 m0, s3, 0x4400
    s_nop 0
    buffer_load_dwordx4 v14, s[28:31], s65 offen lds
    s_add_u32 s65, s65, 122880
    s_cmp_ge_u32 s65, 2457600
    s_cselect_b32 s65, 0, s65
    s_add_u32 m0, s79, 0x15800
    s_nop 0
    buffer_load_dwordx4 v10, s[24:27], s64 offen lds
    s_add_u32 m0, s79, 0x17800
    s_nop 0
    buffer_load_dwordx4 v11, s[24:27], s64 offen lds
    s_add_u32 m0, s78, 0x15800
    s_nop 0
    buffer_load_dwordx4 v12, s[24:27], s64 offen lds
    s_add_u32 s64, s64, 128
    s_cmp_ge_u32 s64, 1280
    s_cselect_b32 s64, 0, s64
    buffer_load_dwordx4 v[36:39], v30, s[24:27], 0 offen
    buffer_load_dwordx4 v[40:43], v30, s[24:27], 0 offen offset:640
    buffer_load_dwordx4 v[48:51], v31, s[40:43], s77 offen
    v_and_b32 v1, 15, v2
    s_mul_i32 s66, s59, 96
    v_add_u32 v5, s66, v1
    v_mul_u32_u24 v5, 168, v5
    v_lshl_add_u32 v5, v4, 3, v5
    s_lshl_b32 s66, s60, 2
    s_add_u32 s66, s66, 0
    s_min_u32 s66, s66, 14
    s_cmp_ge_u32 s66, 5
    s_cselect_b32 s67, 5, 0
    s_cselect_b32 s68, 0, 64512
    s_cselect_b32 s69, 1024, 0
    s_cmp_ge_u32 s66, 10
    s_cselect_b32 s67, 10, s67
    s_cselect_b32 s68, 32256, s68
    s_cselect_b32 s69, 2048, s69
    s_sub_u32 s66, s66, s67
    s_lshl_b32 s67, s66, 5
    s_add_u32 s67, s67, s68
    v_add_u32 v21, s67, v5
    s_lshl_b32 s66, s66, 6
    s_add_u32 s66, s66, s69
    s_add_u32 s66, s66, 150528
    v_writelane_b32 v25, s66, 0
    s_lshl_b32 s66, s60, 2
    s_add_u32 s66, s66, 1
    s_min_u32 s66, s66, 14
    s_cmp_ge_u32 s66, 5
    s_cselect_b32 s67, 5, 0
    s_cselect_b32 s68, 0, 64512
    s_cselect_b32 s69, 1024, 0
    s_cmp_ge_u32 s66, 10
    s_cselect_b32 s67, 10, s67
    s_cselect_b32 s68, 32256, s68
    s_cselect_b32 s69, 2048, s69
    s_sub_u32 s66, s66, s67
    s_lshl_b32 s67, s66, 5
    s_add_u32 s67, s67, s68
    v_add_u32 v22, s67, v5
    s_lshl_b32 s66, s66, 6
    s_add_u32 s66, s66, s69
    s_add_u32 s66, s66, 150528
    v_writelane_b32 v25, s66, 1
    s_lshl_b32 s66, s60, 2
    s_add_u32 s66, s66, 2
    s_min_u32 s66, s66, 14
    s_cmp_ge_u32 s66, 5
    s_cselect_b32 s67, 5, 0
    s_cselect_b32 s68, 0, 64512
    s_cselect_b32 s69, 1024, 0
    s_cmp_ge_u32 s66, 10
    s_cselect_b32 s67, 10, s67
    s_cselect_b32 s68, 32256, s68
    s_cselect_b32 s69, 2048, s69
    s_sub_u32 s66, s66, s67
    s_lshl_b32 s67, s66, 5
    s_add_u32 s67, s67, s68
    v_add_u32 v23, s67, v5
    s_lshl_b32 s66, s66, 6
    s_add_u32 s66, s66, s69
    s_add_u32 s66, s66, 150528
    v_writelane_b32 v25, s66, 2
    s_lshl_b32 s66, s60, 2
    s_add_u32 s66, s66, 3
    s_min_u32 s66, s66, 14
    s_cmp_ge_u32 s66, 5
    s_cselect_b32 s67, 5, 0
    s_cselect_b32 s68, 0, 64512
    s_cselect_b32 s69, 1024, 0
    s_cmp_ge_u32 s66, 10
    s_cselect_b32 s67, 10, s67
    s_cselect_b32 s68, 32256, s68
    s_cselect_b32 s69, 2048, s69
    s_sub_u32 s66, s66, s67
    s_lshl_b32 s67, s66, 5
    s_add_u32 s67, s67, s68
    v_add_u32 v24, s67, v5
    s_lshl_b32 s66, s66, 6
    s_add_u32 s66, s66, s69
    s_add_u32 s66, s66, 150528
    v_writelane_b32 v25, s66, 3
    v_lshrrev_b32 v26, 4, v2
    v_lshlrev_b32 v6, 2, v26
    v_sub_u32 v6, v1, v6
    v_add_u32 v7, 16, v6
    v_alignbit_b32 v7, v7, v7, 1
    v_cmp_ge_u32 s[4:5], 7, v7
    v_add_u32 v7, 15, v6
    v_alignbit_b32 v7, v7, v7, 1
    v_cmp_ge_u32 s[6:7], 7, v7
    v_add_u32 v7, 14, v6
    v_alignbit_b32 v7, v7, v7, 1
    v_cmp_ge_u32 s[8:9], 7, v7
    v_add_u32 v7, 13, v6
    v_alignbit_b32 v7, v7, v7, 1
    v_cmp_ge_u32 s[10:11], 7, v7
    v_add_u32 v7, 0, v6
    v_alignbit_b32 v7, v7, v7, 1
    v_cmp_ge_u32 s[12:13], 7, v7
    v_add_u32 v7, -1, v6
    v_alignbit_b32 v7, v7, v7, 1
    v_cmp_ge_u32 s[14:15], 7, v7
    v_add_u32 v7, -2, v6
    v_alignbit_b32 v7, v7, v7, 1
    v_cmp_ge_u32 s[16:17], 7, v7
    v_add_u32 v7, -3, v6
    v_alignbit_b32 v7, v7, v7, 1
    v_cmp_ge_u32 s[18:19], 7, v7
    s_waitcnt vmcnt(5)
    s_barrier
    ds_read_b64_tr_b16 v[184:185], v17 offset:0
    ds_read_b64_tr_b16 v[186:187], v17 offset:512
    ds_read_b64_tr_b16 v[188:189], v18 offset:0
    ds_read_b64_tr_b16 v[190:191], v18 offset:512
    ds_read_b64_tr_b16 v[192:193], v19 offset:0
    ds_read_b64_tr_b16 v[194:195], v19 offset:512
    ds_read_b64_tr_b16 v[196:197], v20 offset:0
    ds_read_b64_tr_b16 v[198:199], v20 offset:512
    ds_read_b128 v[160:163], v15 offset:0
    ds_read_b128 v[164:167], v15 offset:2048
    ds_read_b128 v[168:171], v15 offset:4096
    ds_read_b128 v[172:175], v15 offset:6144
    ds_read_b128 v[176:179], v15 offset:8192
    ds_read_b128 v[180:183], v15 offset:10240
    s_waitcnt vmcnt(3) lgkmcnt(0)
    s_barrier
    v_mfma_f32_16x16x32_bf16 v[64:67], v[184:187], v[160:163], 0
    s_add_u32 m0, s3, 0x8000
    ds_read_b64_tr_b16 v[224:225], v17 offset:16384
    buffer_load_dwordx4 v13, s[28:31], s65 offen lds
    v_mfma_f32_16x16x32_bf16 v[68:71], v[188:191], v[160:163], 0
    s_add_u32 m0, s3, 0x8400
    ds_read_b64_tr_b16 v[226:227], v17 offset:16896
    buffer_load_dwordx4 v14, s[28:31], s65 offen lds
    s_add_u32 s65, s65, 122880
    s_cmp_ge_u32 s65, 2457600
    s_cselect_b32 s65, 0, s65
    v_mfma_f32_16x16x32_bf16 v[72:75], v[192:195], v[160:163], 0
    s_add_u32 m0, s3, 0xc000
    ds_read_b64_tr_b16 v[228:229], v18 offset:16384
    buffer_load_dwordx4 v13, s[28:31], s65 offen lds
    v_mfma_f32_16x16x32_bf16 v[76:79], v[196:199], v[160:163], 0
    s_add_u32 m0, s3, 0xc400
    ds_read_b64_tr_b16 v[230:231], v18 offset:16896
    buffer_load_dwordx4 v14, s[28:31], s65 offen lds
    s_add_u32 s65, s65, 122880
    s_cmp_ge_u32 s65, 2457600
    s_cselect_b32 s65, 0, s65
    v_mfma_f32_16x16x32_bf16 v[80:83], v[184:187], v[164:167], 0
    s_add_u32 m0, s79, 0x1b000
    ds_read_b64_tr_b16 v[232:233], v19 offset:16384
    buffer_load_dwordx4 v10, s[24:27], s64 offen lds
    v_mfma_f32_16x16x32_bf16 v[84:87], v[188:191], v[164:167], 0
    s_add_u32 m0, s79, 0x1d000
    ds_read_b64_tr_b16 v[234:235], v19 offset:16896
    buffer_load_dwordx4 v11, s[24:27], s64 offen lds
    v_mfma_f32_16x16x32_bf16 v[88:91], v[192:195], v[164:167], 0
    ds_read_b64_tr_b16 v[236:237], v20 offset:16384
    v_mfma_f32_16x16x32_bf16 v[92:95], v[196:199], v[164:167], 0
    ds_read_b64_tr_b16 v[238:239], v20 offset:16896
    v_mfma_f32_16x16x32_bf16 v[96:99], v[184:187], v[168:171], 0
    ds_read_b128 v[200:203], v16 offset:0
    v_mfma_f32_16x16x32_bf16 v[100:103], v[188:191], v[168:171], 0
    ds_read_b128 v[204:207], v16 offset:2048
    v_mfma_f32_16x16x32_bf16 v[104:107], v[192:195], v[168:171], 0
    ds_read_b128 v[208:211], v16 offset:4096
    v_mfma_f32_16x16x32_bf16 v[108:111], v[196:199], v[168:171], 0
    ds_read_b128 v[212:215], v16 offset:6144
    v_mfma_f32_16x16x32_bf16 v[112:115], v[184:187], v[172:175], 0
    ds_read_b128 v[216:219], v16 offset:8192
    v_mfma_f32_16x16x32_bf16 v[116:119], v[188:191], v[172:175], 0
    ds_read_b128 v[220:223], v16 offset:10240
    v_mfma_f32_16x16x32_bf16 v[120:123], v[192:195], v[172:175], 0
    buffer_load_dwordx4 v[52:55], v31, s[40:43], s76 offen
    v_mfma_f32_16x16x32_bf16 v[124:127], v[196:199], v[172:175], 0
    buffer_load_dwordx4 v[44:47], v31, s[40:43], 0 offen
    v_mfma_f32_16x16x32_bf16 v[128:131], v[184:187], v[176:179], 0
    buffer_load_dwordx4 v[56:59], v31, s[40:43], s75 offen
    v_mfma_f32_16x16x32_bf16 v[132:135], v[188:191], v[176:179], 0
    buffer_load_dwordx4 v[60:63], v31, s[40:43], s74 offen
    v_mfma_f32_16x16x32_bf16 v[136:139], v[192:195], v[176:179], 0
    v_mfma_f32_16x16x32_bf16 v[140:143], v[196:199], v[176:179], 0
    v_mfma_f32_16x16x32_bf16 v[144:147], v[184:187], v[180:183], 0
    v_mfma_f32_16x16x32_bf16 v[148:151], v[188:191], v[180:183], 0
    v_mfma_f32_16x16x32_bf16 v[152:155], v[192:195], v[180:183], 0
    v_mfma_f32_16x16x32_bf16 v[156:159], v[196:199], v[180:183], 0
    s_waitcnt vmcnt(4) lgkmcnt(0)
    s_barrier
    v_mfma_f32_16x16x32_bf16 v[64:67], v[224:227], v[200:203], v[64:67]
    s_add_u32 m0, s3, 0x0
    ds_read_b64_tr_b16 v[184:185], v17 offset:32768
    buffer_load_dwordx4 v13, s[28:31], s65 offen lds
    v_mfma_f32_16x16x32_bf16 v[68:71], v[228:231], v[200:203], v[68:71]
    s_add_u32 m0, s3, 0x400
    ds_read_b64_tr_b16 v[186:187], v17 offset:33280
    buffer_load_dwordx4 v14, s[28:31], s65 offen lds
    s_add_u32 s65, s65, 122880
    s_cmp_ge_u32 s65, 2457600
    s_cselect_b32 s65, 0, s65
    v_mfma_f32_16x16x32_bf16 v[72:75], v[232:235], v[200:203], v[72:75]
    s_add_u32 m0, s3, 0x4000
    ds_read_b64_tr_b16 v[188:189], v18 offset:32768
    buffer_load_dwordx4 v13, s[28:31], s65 offen lds
    v_mfma_f32_16x16x32_bf16 v[76:79], v[236:239], v[200:203], v[76:79]
    s_add_u32 m0, s3, 0x4400
    ds_read_b64_tr_b16 v[190:191], v18 offset:33280
    buffer_load_dwordx4 v14, s[28:31], s65 offen lds
    s_add_u32 s65, s65, 122880
    s_cmp_ge_u32 s65, 2457600
    s_cselect_b32 s65, 0, s65
    v_mfma_f32_16x16x32_bf16 v[80:83], v[224:227], v[204:207], v[80:83]
    s_add_u32 m0, s78, 0x1b000
    ds_read_b64_tr_b16 v[192:193], v19 offset:32768
    buffer_load_dwordx4 v12, s[24:27], s64 offen lds
    s_add_u32 s64, s64, 128
    s_cmp_ge_u32 s64, 1280
    s_cselect_b32 s64, 0, s64
    v_mfma_f32_16x16x32_bf16 v[84:87], v[228:231], v[204:207], v[84:87]
    ds_read_b64_tr_b16 v[194:195], v19 offset:33280
    v_mfma_f32_16x16x32_bf16 v[88:91], v[232:235], v[204:207], v[88:91]
    ds_read_b64_tr_b16 v[196:197], v20 offset:32768
    v_mfma_f32_16x16x32_bf16 v[92:95], v[236:239], v[204:207], v[92:95]
    ds_read_b64_tr_b16 v[198:199], v20 offset:33280
    v_mfma_f32_16x16x32_bf16 v[96:99], v[224:227], v[208:211], v[96:99]
    ds_read_b128 v[160:163], v15 offset:22528
    v_mfma_f32_16x16x32_bf16 v[100:103], v[228:231], v[208:211], v[100:103]
    ds_read_b128 v[164:167], v15 offset:24576
    v_mfma_f32_16x16x32_bf16 v[104:107], v[232:235], v[208:211], v[104:107]
    ds_read_b128 v[168:171], v15 offset:26624
    v_mfma_f32_16x16x32_bf16 v[108:111], v[236:239], v[208:211], v[108:111]
    ds_read_b128 v[172:175], v15 offset:28672
    v_mfma_f32_16x16x32_bf16 v[112:115], v[224:227], v[212:215], v[112:115]
    ds_read_b128 v[176:179], v15 offset:30720
    v_mfma_f32_16x16x32_bf16 v[116:119], v[228:231], v[212:215], v[116:119]
    ds_read_b128 v[180:183], v15 offset:32768
    v_mfma_f32_16x16x32_bf16 v[120:123], v[232:235], v[212:215], v[120:123]
    v_mfma_f32_16x16x32_bf16 v[124:127], v[236:239], v[212:215], v[124:127]
    v_mfma_f32_16x16x32_bf16 v[128:131], v[224:227], v[216:219], v[128:131]
    v_mfma_f32_16x16x32_bf16 v[132:135], v[228:231], v[216:219], v[132:135]
    v_mfma_f32_16x16x32_bf16 v[136:139], v[232:235], v[216:219], v[136:139]
    v_mfma_f32_16x16x32_bf16 v[140:143], v[236:239], v[216:219], v[140:143]
    v_mfma_f32_16x16x32_bf16 v[144:147], v[224:227], v[220:223], v[144:147]
    v_mfma_f32_16x16x32_bf16 v[148:151], v[228:231], v[220:223], v[148:151]
    v_mfma_f32_16x16x32_bf16 v[152:155], v[232:235], v[220:223], v[152:155]
    v_mfma_f32_16x16x32_bf16 v[156:159], v[236:239], v[220:223], v[156:159]
    s_waitcnt vmcnt(0) lgkmcnt(0)
    s_barrier
    v_mfma_f32_16x16x32_bf16 v[64:67], v[184:187], v[160:163], v[64:67]
    s_add_u32 m0, s3, 0x8000
    ds_read_b64_tr_b16 v[224:225], v17 offset:49152
    buffer_load_dwordx4 v13, s[28:31], s65 offen lds
    s_add_u32 m0, s3, 0x8400
    ds_read_b64_tr_b16 v[226:227], v17 offset:49664
    buffer_load_dwordx4 v14, s[28:31], s65 offen lds
    s_add_u32 s65, s65, 122880
    s_cmp_ge_u32 s65, 2457600
    s_cselect_b32 s65, 0, s65
    s_add_u32 m0, s79, 0x10000
    ds_read_b64_tr_b16 v[228:229], v18 offset:49152
    buffer_load_dwordx4 v10, s[24:27], s64 offen lds
    v_mfma_f32_16x16x32_bf16 v[68:71], v[188:191], v[160:163], v[68:71]
    s_add_u32 m0, s79, 0x12000
    ds_read_b64_tr_b16 v[230:231], v18 offset:49664
    buffer_load_dwordx4 v11, s[24:27], s64 offen lds
    s_add_u32 m0, s78, 0x10000
    ds_read_b64_tr_b16 v[232:233], v19 offset:49152
    buffer_load_dwordx4 v12, s[24:27], s64 offen lds
    s_add_u32 s64, s64, 128
    s_cmp_ge_u32 s64, 1280
    s_cselect_b32 s64, 0, s64
    ds_read_b64_tr_b16 v[234:235], v19 offset:49664
    v_mfma_f32_16x16x32_bf16 v[72:75], v[192:195], v[160:163], v[72:75]
    ds_read_b64_tr_b16 v[236:237], v20 offset:49152
    ds_read_b64_tr_b16 v[238:239], v20 offset:49664
    ds_read_b128 v[200:203], v16 offset:22528
    v_mfma_f32_16x16x32_bf16 v[76:79], v[196:199], v[160:163], v[76:79]
    ds_read_b128 v[204:207], v16 offset:24576
    ds_read_b128 v[208:211], v16 offset:26624
    ds_read_b128 v[212:215], v16 offset:28672
    v_mfma_f32_16x16x32_bf16 v[80:83], v[184:187], v[164:167], v[80:83]
    ds_read_b128 v[216:219], v16 offset:30720
    ds_read_b128 v[220:223], v16 offset:32768
    v_mfma_f32_16x16x32_bf16 v[244:247], v[44:47], v[240:243], 0
    v_mfma_f32_16x16x32_bf16 v[84:87], v[188:191], v[164:167], v[84:87]
    v_mfma_f32_16x16x32_bf16 v[244:247], v[48:51], v[240:243], v[244:247]
    v_mfma_f32_16x16x32_bf16 v[244:247], v[52:55], v[240:243], v[244:247]
    v_mfma_f32_16x16x32_bf16 v[244:247], v[56:59], v[240:243], v[244:247]
    v_mfma_f32_16x16x32_bf16 v[88:91], v[192:195], v[164:167], v[88:91]
    v_mfma_f32_16x16x32_bf16 v[244:247], v[60:63], v[240:243], v[244:247]
    v_mov_b32 v252, 0x3f803f80
    v_dot2_f32_bf16 v248, v36, v252, 0
    v_mfma_f32_16x16x32_bf16 v[92:95], v[196:199], v[164:167], v[92:95]
    v_dot2_f32_bf16 v250, v36, v36, 0
    v_dot2_f32_bf16 v249, v37, v252, 0
    v_dot2_f32_bf16 v251, v37, v37, 0
    v_mfma_f32_16x16x32_bf16 v[96:99], v[184:187], v[168:171], v[96:99]
    v_dot2_f32_bf16 v248, v38, v252, v248
    v_dot2_f32_bf16 v250, v38, v38, v250
    v_dot2_f32_bf16 v249, v39, v252, v249
    v_mfma_f32_16x16x32_bf16 v[100:103], v[188:191], v[168:171], v[100:103]
    v_dot2_f32_bf16 v251, v39, v39, v251
    v_dot2_f32_bf16 v248, v40, v252, v248
    v_dot2_f32_bf16 v250, v40, v40, v250
    v_mfma_f32_16x16x32_bf16 v[104:107], v[192:195], v[168:171], v[104:107]
    v_dot2_f32_bf16 v249, v41, v252, v249
    v_dot2_f32_bf16 v251, v41, v41, v251
    v_dot2_f32_bf16 v248, v42, v252, v248
    v_mfma_f32_16x16x32_bf16 v[108:111], v[196:199], v[168:171], v[108:111]
    v_dot2_f32_bf16 v250, v42, v42, v250
    v_dot2_f32_bf16 v249, v43, v252, v249
    v_dot2_f32_bf16 v251, v43, v43, v251
    v_mfma_f32_16x16x32_bf16 v[112:115], v[184:187], v[172:175], v[112:115]
    s_nop 2
    v_add_f32 v248, v248, v249
    v_add_f32 v250, v250, v251
    v_mfma_f32_16x16x32_bf16 v[116:119], v[188:191], v[172:175], v[116:119]
    s_nop 1
    v_add_f32_dpp v248, v248, v248 row_ror:8 row_mask:0xf bank_mask:0xf
    v_mfma_f32_16x16x32_bf16 v[120:123], v[192:195], v[172:175], v[120:123]
    v_add_f32_dpp v250, v250, v250 row_ror:8 row_mask:0xf bank_mask:0xf
    s_nop 1
    v_mfma_f32_16x16x32_bf16 v[124:127], v[196:199], v[172:175], v[124:127]
    v_add_f32_dpp v248, v248, v248 row_ror:4 row_mask:0xf bank_mask:0xf
    v_add_f32_dpp v250, v250, v250 row_ror:4 row_mask:0xf bank_mask:0xf
    v_mfma_f32_16x16x32_bf16 v[128:131], v[184:187], v[176:179], v[128:131]
    s_nop 1
    v_add_f32_dpp v248, v248, v248 row_ror:2 row_mask:0xf bank_mask:0xf
    v_mfma_f32_16x16x32_bf16 v[132:135], v[188:191], v[176:179], v[132:135]
    v_add_f32_dpp v250, v250, v250 row_ror:2 row_mask:0xf bank_mask:0xf
    s_nop 1
    v_mfma_f32_16x16x32_bf16 v[136:139], v[192:195], v[176:179], v[136:139]
    v_add_f32_dpp v248, v248, v248 row_ror:1 row_mask:0xf bank_mask:0xf
    v_add_f32_dpp v250, v250, v250 row_ror:1 row_mask:0xf bank_mask:0xf
    v_mfma_f32_16x16x32_bf16 v[140:143], v[196:199], v[176:179], v[140:143]
    v_mov_b32 v249, v248
    v_mov_b32 v251, v250
    v_mfma_f32_16x16x32_bf16 v[144:147], v[184:187], v[180:183], v[144:147]
    v_mov_b32 v44, v244
    v_mov_b32 v45, v245
    v_mfma_f32_16x16x32_bf16 v[148:151], v[188:191], v[180:183], v[148:151]
    v_mov_b32 v46, v246
    v_mov_b32 v47, v247
    v_mfma_f32_16x16x32_bf16 v[152:155], v[192:195], v[180:183], v[152:155]
    s_nop 1
    v_permlane16_swap_b32 v248, v249
    v_mfma_f32_16x16x32_bf16 v[156:159], v[196:199], v[180:183], v[156:159]
    v_permlane16_swap_b32 v250, v251
    v_permlane16_swap_b32 v244, v44
    s_waitcnt vmcnt(5) lgkmcnt(0)
    s_barrier
    v_mfma_f32_16x16x32_bf16 v[64:67], v[224:227], v[200:203], v[64:67]
    s_add_u32 m0, s3, 0xc000
    ds_read_b64_tr_b16 v[184:185], v17 offset:0
    buffer_load_dwordx4 v13, s[28:31], s65 offen lds
    s_add_u32 m0, s3, 0xc400
    ds_read_b64_tr_b16 v[186:187], v17 offset:512
    buffer_load_dwordx4 v14, s[28:31], s65 offen lds
    s_add_u32 s65, s65, 122880
    s_cmp_ge_u32 s65, 2457600
    s_cselect_b32 s65, 0, s65
    s_add_u32 m0, s79, 0x15800
    ds_read_b64_tr_b16 v[188:189], v18 offset:0
    buffer_load_dwordx4 v10, s[24:27], s64 offen lds
    v_mfma_f32_16x16x32_bf16 v[68:71], v[228:231], v[200:203], v[68:71]
    s_add_u32 m0, s79, 0x17800
    ds_read_b64_tr_b16 v[190:191], v18 offset:512
    buffer_load_dwordx4 v11, s[24:27], s64 offen lds
    ds_read_b64_tr_b16 v[192:193], v19 offset:0
    ds_read_b64_tr_b16 v[194:195], v19 offset:512
    v_mfma_f32_16x16x32_bf16 v[72:75], v[232:235], v[200:203], v[72:75]
    ds_read_b64_tr_b16 v[196:197], v20 offset:0
    ds_read_b64_tr_b16 v[198:199], v20 offset:512
    ds_read_b128 v[160:163], v15 offset:45056
    v_mfma_f32_16x16x32_bf16 v[76:79], v[236:239], v[200:203], v[76:79]
    ds_read_b128 v[164:167], v15 offset:47104
    ds_read_b128 v[168:171], v15 offset:49152
    ds_read_b128 v[172:175], v15 offset:51200
    v_mfma_f32_16x16x32_bf16 v[80:83], v[224:227], v[204:207], v[80:83]
    ds_read_b128 v[176:179], v15 offset:53248
    ds_read_b128 v[180:183], v15 offset:55296
    v_permlane16_swap_b32 v245, v45
    v_mfma_f32_16x16x32_bf16 v[84:87], v[228:231], v[204:207], v[84:87]
    v_permlane16_swap_b32 v246, v46
    v_permlane16_swap_b32 v247, v47
    s_nop 1
    v_mfma_f32_16x16x32_bf16 v[88:91], v[232:235], v[204:207], v[88:91]
    v_add_f32 v248, v248, v249
    v_add_f32 v250, v250, v251
    v_add_f32 v244, v244, v44
    v_mfma_f32_16x16x32_bf16 v[92:95], v[236:239], v[204:207], v[92:95]
    v_add_f32 v245, v245, v45
    v_add_f32 v246, v246, v46
    v_add_f32 v247, v247, v47
    v_mfma_f32_16x16x32_bf16 v[96:99], v[224:227], v[208:211], v[96:99]
    v_mov_b32 v249, v248
    v_mov_b32 v251, v250
    v_mov_b32 v44, v244
    v_mfma_f32_16x16x32_bf16 v[100:103], v[228:231], v[208:211], v[100:103]
    v_mov_b32 v45, v245
    v_mov_b32 v46, v246
    v_mov_b32 v47, v247
    v_mfma_f32_16x16x32_bf16 v[104:107], v[232:235], v[208:211], v[104:107]
    s_nop 1
    v_permlane32_swap_b32 v248, v249
    v_permlane32_swap_b32 v250, v251
    v_mfma_f32_16x16x32_bf16 v[108:111], v[236:239], v[208:211], v[108:111]
    v_permlane32_swap_b32 v244, v44
    v_permlane32_swap_b32 v245, v45
    v_permlane32_swap_b32 v246, v46
    v_mfma_f32_16x16x32_bf16 v[112:115], v[224:227], v[212:215], v[112:115]
    v_permlane32_swap_b32 v247, v47
    s_nop 1
    v_add_f32 v248, v248, v249
    v_mfma_f32_16x16x32_bf16 v[116:119], v[228:231], v[212:215], v[116:119]
    v_add_f32 v250, v250, v251
    v_add_f32 v244, v244, v44
    v_mfma_f32_16x16x32_bf16 v[120:123], v[232:235], v[212:215], v[120:123]
    v_add_f32 v245, v245, v45
    v_add_f32 v246, v246, v46
    v_mfma_f32_16x16x32_bf16 v[124:127], v[236:239], v[212:215], v[124:127]
    v_add_f32 v247, v247, v47
    ds_write_b128 v35, v[244:247]
    v_mfma_f32_16x16x32_bf16 v[128:131], v[224:227], v[216:219], v[128:131]
    v_mul_f32 v248, 0x3acccccd, v248
    v_mul_f32 v250, 0x3acccccd, v250
    v_mfma_f32_16x16x32_bf16 v[132:135], v[228:231], v[216:219], v[132:135]
    v_fma_f32 v250, -v248, v248, v250
    v_max_f32 v250, 0, v250
    v_mfma_f32_16x16x32_bf16 v[136:139], v[232:235], v[216:219], v[136:139]
    v_cvt_pk_bf16_f32 v249, v248, v250
    v_lshlrev_b32 v252, 16, v249
    v_mfma_f32_16x16x32_bf16 v[140:143], v[236:239], v[216:219], v[140:143]
    v_and_b32 v253, 0xffff0000, v249
    v_add_f32 v253, 0x3727c5ac, v253
    v_mfma_f32_16x16x32_bf16 v[144:147], v[224:227], v[220:223], v[144:147]
    v_cvt_pk_bf16_f32 v253, v253, v253
    v_lshlrev_b32 v253, 16, v253
    v_mfma_f32_16x16x32_bf16 v[148:151], v[228:231], v[220:223], v[148:151]
    v_sqrt_f32 v253, v253
    s_nop 0
    v_mfma_f32_16x16x32_bf16 v[152:155], v[232:235], v[220:223], v[152:155]
    v_cvt_pk_bf16_f32 v253, v253, v253
    v_lshlrev_b32 v253, 16, v253
    v_mfma_f32_16x16x32_bf16 v[156:159], v[236:239], v[220:223], v[156:159]
    s_lshl_b32 s66, s56, 3
    s_add_u32 s66, s66, 150016
    v_mov_b32 v248, s66
    ds_write_b64 v248, v[252:253] offset:0
    s_waitcnt vmcnt(9) lgkmcnt(0)
    s_barrier
    v_mfma_f32_16x16x32_bf16 v[64:67], v[184:187], v[160:163], v[64:67]
    s_add_u32 m0, s3, 0x0
    ds_read_b64_tr_b16 v[224:225], v17 offset:16384
    buffer_load_dwordx4 v13, s[28:31], s65 offen lds
    s_add_u32 m0, s3, 0x400
    ds_read_b64_tr_b16 v[226:227], v17 offset:16896
    buffer_load_dwordx4 v14, s[28:31], s65 offen lds
    s_add_u32 s65, s65, 122880
    s_cmp_ge_u32 s65, 2457600
    s_cselect_b32 s65, 0, s65
    v_mfma_f32_16x16x32_bf16 v[68:71], v[188:191], v[160:163], v[68:71]
    s_add_u32 m0, s78, 0x15800
    ds_read_b64_tr_b16 v[228:229], v18 offset:16384
    buffer_load_dwordx4 v12, s[24:27], s64 offen lds
    s_add_u32 s64, s64, 128
    s_cmp_ge_u32 s64, 1280
    s_cselect_b32 s64, 0, s64
    ds_read_b64_tr_b16 v[230:231], v18 offset:16896
    v_mfma_f32_16x16x32_bf16 v[72:75], v[192:195], v[160:163], v[72:75]
    ds_read_b64_tr_b16 v[232:233], v19 offset:16384
    v_mfma_f32_16x16x32_bf16 v[76:79], v[196:199], v[160:163], v[76:79]
    ds_read_b64_tr_b16 v[234:235], v19 offset:16896
    v_mfma_f32_16x16x32_bf16 v[80:83], v[184:187], v[164:167], v[80:83]
    ds_read_b64_tr_b16 v[236:237], v20 offset:16384
    v_mfma_f32_16x16x32_bf16 v[84:87], v[188:191], v[164:167], v[84:87]
    ds_read_b64_tr_b16 v[238:239], v20 offset:16896
    v_mfma_f32_16x16x32_bf16 v[88:91], v[192:195], v[164:167], v[88:91]
    ds_read_b128 v[200:203], v16 offset:45056
    v_mfma_f32_16x16x32_bf16 v[92:95], v[196:199], v[164:167], v[92:95]
    ds_read_b128 v[204:207], v16 offset:47104
    v_mfma_f32_16x16x32_bf16 v[96:99], v[184:187], v[168:171], v[96:99]
    ds_read_b128 v[208:211], v16 offset:49152
    v_mfma_f32_16x16x32_bf16 v[100:103], v[188:191], v[168:171], v[100:103]
    ds_read_b128 v[212:215], v16 offset:51200
    v_mfma_f32_16x16x32_bf16 v[104:107], v[192:195], v[168:171], v[104:107]
    ds_read_b128 v[216:219], v16 offset:53248
    v_mfma_f32_16x16x32_bf16 v[108:111], v[196:199], v[168:171], v[108:111]
    ds_read_b128 v[220:223], v16 offset:55296
    v_mfma_f32_16x16x32_bf16 v[112:115], v[184:187], v[172:175], v[112:115]
    ds_read_b32 v44, v29 offset:0
    v_mfma_f32_16x16x32_bf16 v[116:119], v[188:191], v[172:175], v[116:119]
    ds_read_b32 v45, v29 offset:128
    v_mfma_f32_16x16x32_bf16 v[120:123], v[192:195], v[172:175], v[120:123]
    ds_read_b32 v46, v29 offset:256
    v_mfma_f32_16x16x32_bf16 v[124:127], v[196:199], v[172:175], v[124:127]
    ds_read_b32 v47, v29 offset:384
    v_mfma_f32_16x16x32_bf16 v[128:131], v[184:187], v[176:179], v[128:131]
    ds_read_b32 v48, v29 offset:512
    v_mfma_f32_16x16x32_bf16 v[132:135], v[188:191], v[176:179], v[132:135]
    ds_read_b32 v49, v29 offset:640
    v_mfma_f32_16x16x32_bf16 v[136:139], v[192:195], v[176:179], v[136:139]
    ds_read_b32 v50, v29 offset:768
    v_mfma_f32_16x16x32_bf16 v[140:143], v[196:199], v[176:179], v[140:143]
    ds_read_b32 v51, v29 offset:896
    v_mfma_f32_16x16x32_bf16 v[144:147], v[184:187], v[180:183], v[144:147]
    v_and_b32 v248, 7, v2
    v_mfma_f32_16x16x32_bf16 v[148:151], v[188:191], v[180:183], v[148:151]
    v_lshlrev_b32 v248, 3, v248
    v_mfma_f32_16x16x32_bf16 v[152:155], v[192:195], v[180:183], v[152:155]
    v_add_u32 v248, 150016, v248
    v_mfma_f32_16x16x32_bf16 v[156:159], v[196:199], v[180:183], v[156:159]
    ds_read_b64 v[250:251], v248
    s_waitcnt vmcnt(7) lgkmcnt(0)
    s_barrier
    v_mfma_f32_16x16x32_bf16 v[64:67], v[224:227], v[200:203], v[64:67]
    s_add_u32 m0, s3, 0x4000
    ds_read_b64_tr_b16 v[184:185], v17 offset:32768
    buffer_load_dwordx4 v13, s[28:31], s65 offen lds
    v_mfma_f32_16x16x32_bf16 v[68:71], v[228:231], v[200:203], v[68:71]
    s_add_u32 m0, s3, 0x4400
    ds_read_b64_tr_b16 v[186:187], v17 offset:33280
    buffer_load_dwordx4 v14, s[28:31], s65 offen lds
    s_add_u32 s65, s65, 122880
    s_cmp_ge_u32 s65, 2457600
    s_cselect_b32 s65, 0, s65
    v_mfma_f32_16x16x32_bf16 v[72:75], v[232:235], v[200:203], v[72:75]
    s_add_u32 m0, s79, 0x1b000
    ds_read_b64_tr_b16 v[188:189], v18 offset:32768
    buffer_load_dwordx4 v10, s[24:27], s64 offen lds
    v_mfma_f32_16x16x32_bf16 v[76:79], v[236:239], v[200:203], v[76:79]
    s_add_u32 m0, s79, 0x1d000
    ds_read_b64_tr_b16 v[190:191], v18 offset:33280
    buffer_load_dwordx4 v11, s[24:27], s64 offen lds
    v_mfma_f32_16x16x32_bf16 v[80:83], v[224:227], v[204:207], v[80:83]
    ds_read_b64_tr_b16 v[192:193], v19 offset:32768
    v_mfma_f32_16x16x32_bf16 v[84:87], v[228:231], v[204:207], v[84:87]
    ds_read_b64_tr_b16 v[194:195], v19 offset:33280
    v_mfma_f32_16x16x32_bf16 v[88:91], v[232:235], v[204:207], v[88:91]
    ds_read_b64_tr_b16 v[196:197], v20 offset:32768
    v_mfma_f32_16x16x32_bf16 v[92:95], v[236:239], v[204:207], v[92:95]
    ds_read_b64_tr_b16 v[198:199], v20 offset:33280
    v_mfma_f32_16x16x32_bf16 v[96:99], v[224:227], v[208:211], v[96:99]
    ds_read_b128 v[160:163], v15 offset:0
    v_mfma_f32_16x16x32_bf16 v[100:103], v[228:231], v[208:211], v[100:103]
    ds_read_b128 v[164:167], v15 offset:2048
    v_mfma_f32_16x16x32_bf16 v[104:107], v[232:235], v[208:211], v[104:107]
    ds_read_b128 v[168:171], v15 offset:4096
    v_mfma_f32_16x16x32_bf16 v[108:111], v[236:239], v[208:211], v[108:111]
    ds_read_b128 v[172:175], v15 offset:6144
    v_mfma_f32_16x16x32_bf16 v[112:115], v[224:227], v[212:215], v[112:115]
    ds_read_b128 v[176:179], v15 offset:8192
    v_mfma_f32_16x16x32_bf16 v[116:119], v[228:231], v[212:215], v[116:119]
    ds_read_b128 v[180:183], v15 offset:10240
    v_mfma_f32_16x16x32_bf16 v[120:123], v[232:235], v[212:215], v[120:123]
    v_add_f32 v44, v44, v45
    v_mfma_f32_16x16x32_bf16 v[124:127], v[236:239], v[212:215], v[124:127]
    v_add_f32 v46, v46, v47
    v_mfma_f32_16x16x32_bf16 v[128:131], v[224:227], v[216:219], v[128:131]
    v_add_f32 v48, v48, v49
    v_mfma_f32_16x16x32_bf16 v[132:135], v[228:231], v[216:219], v[132:135]
    v_add_f32 v50, v50, v51
    v_mfma_f32_16x16x32_bf16 v[136:139], v[232:235], v[216:219], v[136:139]
    v_add_f32 v44, v44, v46
    v_mfma_f32_16x16x32_bf16 v[140:143], v[236:239], v[216:219], v[140:143]
    v_add_f32 v48, v48, v50
    v_mfma_f32_16x16x32_bf16 v[144:147], v[224:227], v[220:223], v[144:147]
    v_add_f32 v44, v44, v48
    v_mfma_f32_16x16x32_bf16 v[148:151], v[228:231], v[220:223], v[148:151]
    buffer_store_dword v44, v33, s[36:39], 0 offen sc1
    v_mfma_f32_16x16x32_bf16 v[152:155], v[232:235], v[220:223], v[152:155]
    buffer_store_dwordx2 v[250:251], v32, s[36:39], 0 offen sc1
    v_mfma_f32_16x16x32_bf16 v[156:159], v[236:239], v[220:223], v[156:159]
    s_waitcnt vmcnt(9) lgkmcnt(0)
    s_barrier
    v_mfma_f32_16x16x32_bf16 v[64:67], v[184:187], v[160:163], v[64:67]
    s_add_u32 m0, s3, 0x8000
    ds_read_b64_tr_b16 v[224:225], v17 offset:49152
    buffer_load_dwordx4 v13, s[28:31], s65 offen lds
    v_mfma_f32_16x16x32_bf16 v[68:71], v[188:191], v[160:163], v[68:71]
    s_add_u32 m0, s3, 0x8400
    ds_read_b64_tr_b16 v[226:227], v17 offset:49664
    buffer_load_dwordx4 v14, s[28:31], s65 offen lds
    s_add_u32 s65, s65, 122880
    s_cmp_ge_u32 s65, 2457600
    s_cselect_b32 s65, 0, s65
    v_mfma_f32_16x16x32_bf16 v[72:75], v[192:195], v[160:163], v[72:75]
    s_add_u32 m0, s78, 0x1b000
    ds_read_b64_tr_b16 v[228:229], v18 offset:49152
    buffer_load_dwordx4 v12, s[24:27], s64 offen lds
    s_add_u32 s64, s64, 128
    s_cmp_ge_u32 s64, 1280
    s_cselect_b32 s64, 0, s64
    v_mfma_f32_16x16x32_bf16 v[76:79], v[196:199], v[160:163], v[76:79]
    ds_read_b64_tr_b16 v[230:231], v18 offset:49664
    v_mfma_f32_16x16x32_bf16 v[80:83], v[184:187], v[164:167], v[80:83]
    ds_read_b64_tr_b16 v[232:233], v19 offset:49152
    v_mfma_f32_16x16x32_bf16 v[84:87], v[188:191], v[164:167], v[84:87]
    ds_read_b64_tr_b16 v[234:235], v19 offset:49664
    v_mfma_f32_16x16x32_bf16 v[88:91], v[192:195], v[164:167], v[88:91]
    ds_read_b64_tr_b16 v[236:237], v20 offset:49152
    v_mfma_f32_16x16x32_bf16 v[92:95], v[196:199], v[164:167], v[92:95]
    ds_read_b64_tr_b16 v[238:239], v20 offset:49664
    v_mfma_f32_16x16x32_bf16 v[96:99], v[184:187], v[168:171], v[96:99]
    ds_read_b128 v[200:203], v16 offset:0
    v_mfma_f32_16x16x32_bf16 v[100:103], v[188:191], v[168:171], v[100:103]
    ds_read_b128 v[204:207], v16 offset:2048
    v_mfma_f32_16x16x32_bf16 v[104:107], v[192:195], v[168:171], v[104:107]
    ds_read_b128 v[208:211], v16 offset:4096
    v_mfma_f32_16x16x32_bf16 v[108:111], v[196:199], v[168:171], v[108:111]
    ds_read_b128 v[212:215], v16 offset:6144
    v_mfma_f32_16x16x32_bf16 v[112:115], v[184:187], v[172:175], v[112:115]
    ds_read_b128 v[216:219], v16 offset:8192
    v_mfma_f32_16x16x32_bf16 v[116:119], v[188:191], v[172:175], v[116:119]
    ds_read_b128 v[220:223], v16 offset:10240
    v_mfma_f32_16x16x32_bf16 v[120:123], v[192:195], v[172:175], v[120:123]
    v_mfma_f32_16x16x32_bf16 v[124:127], v[196:199], v[172:175], v[124:127]
    v_mfma_f32_16x16x32_bf16 v[128:131], v[184:187], v[176:179], v[128:131]
    v_mfma_f32_16x16x32_bf16 v[132:135], v[188:191], v[176:179], v[132:135]
    v_mfma_f32_16x16x32_bf16 v[136:139], v[192:195], v[176:179], v[136:139]
    v_mfma_f32_16x16x32_bf16 v[140:143], v[196:199], v[176:179], v[140:143]
    v_mfma_f32_16x16x32_bf16 v[144:147], v[184:187], v[180:183], v[144:147]
    v_mfma_f32_16x16x32_bf16 v[148:151], v[188:191], v[180:183], v[148:151]
    v_mfma_f32_16x16x32_bf16 v[152:155], v[192:195], v[180:183], v[152:155]
    v_mfma_f32_16x16x32_bf16 v[156:159], v[196:199], v[180:183], v[156:159]
    s_waitcnt vmcnt(7) lgkmcnt(0)
    s_barrier
    v_mfma_f32_16x16x32_bf16 v[64:67], v[224:227], v[200:203], v[64:67]
    s_add_u32 m0, s3, 0xc000
    ds_read_b64_tr_b16 v[184:185], v17 offset:0
    buffer_load_dwordx4 v13, s[28:31], s65 offen lds
    v_mfma_f32_16x16x32_bf16 v[68:71], v[228:231], v[200:203], v[68:71]
    s_add_u32 m0, s3, 0xc400
    ds_read_b64_tr_b16 v[186:187], v17 offset:512
    buffer_load_dwordx4 v14, s[28:31], s65 offen lds
    s_add_u32 s65, s65, 122880
    s_cmp_ge_u32 s65, 2457600
    s_cselect_b32 s65, 0, s65
    v_mfma_f32_16x16x32_bf16 v[72:75], v[232:235], v[200:203], v[72:75]
    s_add_u32 m0, s79, 0x10000
    ds_read_b64_tr_b16 v[188:189], v18 offset:0
    buffer_load_dwordx4 v10, s[24:27], s64 offen lds
    v_mfma_f32_16x16x32_bf16 v[76:79], v[236:239], v[200:203], v[76:79]
    s_add_u32 m0, s79, 0x12000
    ds_read_b64_tr_b16 v[190:191], v18 offset:512
    buffer_load_dwordx4 v11, s[24:27], s64 offen lds
    v_mfma_f32_16x16x32_bf16 v[80:83], v[224:227], v[204:207], v[80:83]
    ds_read_b64_tr_b16 v[192:193], v19 offset:0
    v_mfma_f32_16x16x32_bf16 v[84:87], v[228:231], v[204:207], v[84:87]
    ds_read_b64_tr_b16 v[194:195], v19 offset:512
    v_mfma_f32_16x16x32_bf16 v[88:91], v[232:235], v[204:207], v[88:91]
    ds_read_b64_tr_b16 v[196:197], v20 offset:0
    v_mfma_f32_16x16x32_bf16 v[92:95], v[236:239], v[204:207], v[92:95]
    ds_read_b64_tr_b16 v[198:199], v20 offset:512
    v_mfma_f32_16x16x32_bf16 v[96:99], v[224:227], v[208:211], v[96:99]
    ds_read_b128 v[160:163], v15 offset:22528
    v_mfma_f32_16x16x32_bf16 v[100:103], v[228:231], v[208:211], v[100:103]
    ds_read_b128 v[164:167], v15 offset:24576
    v_mfma_f32_16x16x32_bf16 v[104:107], v[232:235], v[208:211], v[104:107]
    ds_read_b128 v[168:171], v15 offset:26624
    v_mfma_f32_16x16x32_bf16 v[108:111], v[236:239], v[208:211], v[108:111]
    ds_read_b128 v[172:175], v15 offset:28672
    v_mfma_f32_16x16x32_bf16 v[112:115], v[224:227], v[212:215], v[112:115]
    ds_read_b128 v[176:179], v15 offset:30720
    v_mfma_f32_16x16x32_bf16 v[116:119], v[228:231], v[212:215], v[116:119]
    ds_read_b128 v[180:183], v15 offset:32768
    v_mfma_f32_16x16x32_bf16 v[120:123], v[232:235], v[212:215], v[120:123]
    v_mfma_f32_16x16x32_bf16 v[124:127], v[236:239], v[212:215], v[124:127]
    v_mfma_f32_16x16x32_bf16 v[128:131], v[224:227], v[216:219], v[128:131]
    v_mfma_f32_16x16x32_bf16 v[132:135], v[228:231], v[216:219], v[132:135]
    v_mfma_f32_16x16x32_bf16 v[136:139], v[232:235], v[216:219], v[136:139]
    v_mfma_f32_16x16x32_bf16 v[140:143], v[236:239], v[216:219], v[140:143]
    v_mfma_f32_16x16x32_bf16 v[144:147], v[224:227], v[220:223], v[144:147]
    v_mfma_f32_16x16x32_bf16 v[148:151], v[228:231], v[220:223], v[148:151]
    v_mfma_f32_16x16x32_bf16 v[152:155], v[232:235], v[220:223], v[152:155]
    v_mfma_f32_16x16x32_bf16 v[156:159], v[236:239], v[220:223], v[156:159]
    s_waitcnt vmcnt(7) lgkmcnt(0)
    s_barrier
    v_mfma_f32_16x16x32_bf16 v[64:67], v[184:187], v[160:163], v[64:67]
    s_add_u32 m0, s3, 0x0
    ds_read_b64_tr_b16 v[224:225], v17 offset:16384
    buffer_load_dwordx4 v13, s[28:31], s65 offen lds
    v_mfma_f32_16x16x32_bf16 v[68:71], v[188:191], v[160:163], v[68:71]
    s_add_u32 m0, s3, 0x400
    ds_read_b64_tr_b16 v[226:227], v17 offset:16896
    buffer_load_dwordx4 v14, s[28:31], s65 offen lds
    s_add_u32 s65, s65, 122880
    s_cmp_ge_u32 s65, 2457600
    s_cselect_b32 s65, 0, s65
    v_mfma_f32_16x16x32_bf16 v[72:75], v[192:195], v[160:163], v[72:75]
    s_add_u32 m0, s78, 0x10000
    ds_read_b64_tr_b16 v[228:229], v18 offset:16384
    buffer_load_dwordx4 v12, s[24:27], s64 offen lds
    s_add_u32 s64, s64, 128
    s_cmp_ge_u32 s64, 1280
    s_cselect_b32 s64, 0, s64
    v_mfma_f32_16x16x32_bf16 v[76:79], v[196:199], v[160:163], v[76:79]
    ds_read_b64_tr_b16 v[230:231], v18 offset:16896
    v_mfma_f32_16x16x32_bf16 v[80:83], v[184:187], v[164:167], v[80:83]
    ds_read_b64_tr_b16 v[232:233], v19 offset:16384
    v_mfma_f32_16x16x32_bf16 v[84:87], v[188:191], v[164:167], v[84:87]
    ds_read_b64_tr_b16 v[234:235], v19 offset:16896
    v_mfma_f32_16x16x32_bf16 v[88:91], v[192:195], v[164:167], v[88:91]
    ds_read_b64_tr_b16 v[236:237], v20 offset:16384
    v_mfma_f32_16x16x32_bf16 v[92:95], v[196:199], v[164:167], v[92:95]
    ds_read_b64_tr_b16 v[238:239], v20 offset:16896
    v_mfma_f32_16x16x32_bf16 v[96:99], v[184:187], v[168:171], v[96:99]
    ds_read_b128 v[200:203], v16 offset:22528
    v_mfma_f32_16x16x32_bf16 v[100:103], v[188:191], v[168:171], v[100:103]
    ds_read_b128 v[204:207], v16 offset:24576
    v_mfma_f32_16x16x32_bf16 v[104:107], v[192:195], v[168:171], v[104:107]
    ds_read_b128 v[208:211], v16 offset:26624
    v_mfma_f32_16x16x32_bf16 v[108:111], v[196:199], v[168:171], v[108:111]
    ds_read_b128 v[212:215], v16 offset:28672
    v_mfma_f32_16x16x32_bf16 v[112:115], v[184:187], v[172:175], v[112:115]
    ds_read_b128 v[216:219], v16 offset:30720
    v_mfma_f32_16x16x32_bf16 v[116:119], v[188:191], v[172:175], v[116:119]
    ds_read_b128 v[220:223], v16 offset:32768
    v_mfma_f32_16x16x32_bf16 v[120:123], v[192:195], v[172:175], v[120:123]
    v_mov_b32 v248, 1
    v_mfma_f32_16x16x32_bf16 v[124:127], v[196:199], v[172:175], v[124:127]
    buffer_atomic_add v248, v34, s[52:55], 0 offen
    v_mfma_f32_16x16x32_bf16 v[128:131], v[184:187], v[176:179], v[128:131]
    v_mfma_f32_16x16x32_bf16 v[132:135], v[188:191], v[176:179], v[132:135]
    v_mfma_f32_16x16x32_bf16 v[136:139], v[192:195], v[176:179], v[136:139]
    v_mfma_f32_16x16x32_bf16 v[140:143], v[196:199], v[176:179], v[140:143]
    v_mfma_f32_16x16x32_bf16 v[144:147], v[184:187], v[180:183], v[144:147]
    v_mfma_f32_16x16x32_bf16 v[148:151], v[188:191], v[180:183], v[148:151]
    v_mfma_f32_16x16x32_bf16 v[152:155], v[192:195], v[180:183], v[152:155]
    v_mfma_f32_16x16x32_bf16 v[156:159], v[196:199], v[180:183], v[156:159]
    s_waitcnt vmcnt(7) lgkmcnt(0)
    s_barrier
    v_mfma_f32_16x16x32_bf16 v[64:67], v[224:227], v[200:203], v[64:67]
    s_add_u32 m0, s3, 0x4000
    ds_read_b64_tr_b16 v[184:185], v17 offset:32768
    buffer_load_dwordx4 v13, s[28:31], s65 offen lds
    v_mfma_f32_16x16x32_bf16 v[68:71], v[228:231], v[200:203], v[68:71]
    s_add_u32 m0, s3, 0x4400
    ds_read_b64_tr_b16 v[186:187], v17 offset:33280
    buffer_load_dwordx4 v14, s[28:31], s65 offen lds
    s_add_u32 s65, s65, 122880
    s_cmp_ge_u32 s65, 2457600
    s_cselect_b32 s65, 0, s65
    v_mfma_f32_16x16x32_bf16 v[72:75], v[232:235], v[200:203], v[72:75]
    s_add_u32 m0, s79, 0x15800
    ds_read_b64_tr_b16 v[188:189], v18 offset:32768
    buffer_load_dwordx4 v10, s[24:27], s64 offen lds
    v_mfma_f32_16x16x32_bf16 v[76:79], v[236:239], v[200:203], v[76:79]
    s_add_u32 m0, s79, 0x17800
    ds_read_b64_tr_b16 v[190:191], v18 offset:33280
    buffer_load_dwordx4 v11, s[24:27], s64 offen lds
    v_mfma_f32_16x16x32_bf16 v[80:83], v[224:227], v[204:207], v[80:83]
    ds_read_b64_tr_b16 v[192:193], v19 offset:32768
    v_mfma_f32_16x16x32_bf16 v[84:87], v[228:231], v[204:207], v[84:87]
    ds_read_b64_tr_b16 v[194:195], v19 offset:33280
    v_mfma_f32_16x16x32_bf16 v[88:91], v[232:235], v[204:207], v[88:91]
    ds_read_b64_tr_b16 v[196:197], v20 offset:32768
    v_mfma_f32_16x16x32_bf16 v[92:95], v[236:239], v[204:207], v[92:95]
    ds_read_b64_tr_b16 v[198:199], v20 offset:33280
    v_mfma_f32_16x16x32_bf16 v[96:99], v[224:227], v[208:211], v[96:99]
    ds_read_b128 v[160:163], v15 offset:45056
    v_mfma_f32_16x16x32_bf16 v[100:103], v[228:231], v[208:211], v[100:103]
    ds_read_b128 v[164:167], v15 offset:47104
    v_mfma_f32_16x16x32_bf16 v[104:107], v[232:235], v[208:211], v[104:107]
    ds_read_b128 v[168:171], v15 offset:49152
    v_mfma_f32_16x16x32_bf16 v[108:111], v[236:239], v[208:211], v[108:111]
    ds_read_b128 v[172:175], v15 offset:51200
    v_mfma_f32_16x16x32_bf16 v[112:115], v[224:227], v[212:215], v[112:115]
    ds_read_b128 v[176:179], v15 offset:53248
    v_mfma_f32_16x16x32_bf16 v[116:119], v[228:231], v[212:215], v[116:119]
    ds_read_b128 v[180:183], v15 offset:55296
    v_mfma_f32_16x16x32_bf16 v[120:123], v[232:235], v[212:215], v[120:123]
    s_lshl_b32 s66, s2, 3
    s_add_u32 s66, s66, s56
    s_lshl_b32 s66, s66, 10
    buffer_load_dwordx4 v[252:255], v3, s[44:47], s66 offen
    buffer_load_dwordx4 v[252:255], v3, s[48:51], s66 offen
    s_add_u32 s66, s66, 0x200000
    buffer_load_dwordx4 v[252:255], v3, s[44:47], s66 offen
    v_mfma_f32_16x16x32_bf16 v[124:127], v[236:239], v[212:215], v[124:127]
    v_mfma_f32_16x16x32_bf16 v[128:131], v[224:227], v[216:219], v[128:131]
    v_mfma_f32_16x16x32_bf16 v[132:135], v[228:231], v[216:219], v[132:135]
    v_mfma_f32_16x16x32_bf16 v[136:139], v[232:235], v[216:219], v[136:139]
    v_mfma_f32_16x16x32_bf16 v[140:143], v[236:239], v[216:219], v[140:143]
    v_mfma_f32_16x16x32_bf16 v[144:147], v[224:227], v[220:223], v[144:147]
    v_mfma_f32_16x16x32_bf16 v[148:151], v[228:231], v[220:223], v[148:151]
    v_mfma_f32_16x16x32_bf16 v[152:155], v[232:235], v[220:223], v[152:155]
    v_mfma_f32_16x16x32_bf16 v[156:159], v[236:239], v[220:223], v[156:159]
    s_waitcnt vmcnt(9) lgkmcnt(0)
    s_barrier
    v_mfma_f32_16x16x32_bf16 v[64:67], v[184:187], v[160:163], v[64:67]
    s_add_u32 m0, s3, 0x8000
    ds_read_b64_tr_b16 v[224:225], v17 offset:49152
    buffer_load_dwordx4 v13, s[28:31], s65 offen lds
    v_mfma_f32_16x16x32_bf16 v[68:71], v[188:191], v[160:163], v[68:71]
    s_add_u32 m0, s3, 0x8400
    ds_read_b64_tr_b16 v[226:227], v17 offset:49664
    buffer_load_dwordx4 v14, s[28:31], s65 offen lds
    s_add_u32 s65, s65, 122880
    s_cmp_ge_u32 s65, 2457600
    s_cselect_b32 s65, 0, s65
    v_mfma_f32_16x16x32_bf16 v[72:75], v[192:195], v[160:163], v[72:75]
    s_add_u32 m0, s78, 0x15800
    ds_read_b64_tr_b16 v[228:229], v18 offset:49152
    buffer_load_dwordx4 v12, s[24:27], s64 offen lds
    s_add_u32 s64, s64, 128
    s_cmp_ge_u32 s64, 1280
    s_cselect_b32 s64, 0, s64
    v_mfma_f32_16x16x32_bf16 v[76:79], v[196:199], v[160:163], v[76:79]
    ds_read_b64_tr_b16 v[230:231], v18 offset:49664
    v_mfma_f32_16x16x32_bf16 v[80:83], v[184:187], v[164:167], v[80:83]
    ds_read_b64_tr_b16 v[232:233], v19 offset:49152
    v_mfma_f32_16x16x32_bf16 v[84:87], v[188:191], v[164:167], v[84:87]
    ds_read_b64_tr_b16 v[234:235], v19 offset:49664
    v_mfma_f32_16x16x32_bf16 v[88:91], v[192:195], v[164:167], v[88:91]
    ds_read_b64_tr_b16 v[236:237], v20 offset:49152
    v_mfma_f32_16x16x32_bf16 v[92:95], v[196:199], v[164:167], v[92:95]
    ds_read_b64_tr_b16 v[238:239], v20 offset:49664
    v_mfma_f32_16x16x32_bf16 v[96:99], v[184:187], v[168:171], v[96:99]
    ds_read_b128 v[200:203], v16 offset:45056
    v_mfma_f32_16x16x32_bf16 v[100:103], v[188:191], v[168:171], v[100:103]
    ds_read_b128 v[204:207], v16 offset:47104
    v_mfma_f32_16x16x32_bf16 v[104:107], v[192:195], v[168:171], v[104:107]
    ds_read_b128 v[208:211], v16 offset:49152
    v_mfma_f32_16x16x32_bf16 v[108:111], v[196:199], v[168:171], v[108:111]
    ds_read_b128 v[212:215], v16 offset:51200
    v_mfma_f32_16x16x32_bf16 v[112:115], v[184:187], v[172:175], v[112:115]
    ds_read_b128 v[216:219], v16 offset:53248
    v_mfma_f32_16x16x32_bf16 v[116:119], v[188:191], v[172:175], v[116:119]
    ds_read_b128 v[220:223], v16 offset:55296
    v_mfma_f32_16x16x32_bf16 v[120:123], v[192:195], v[172:175], v[120:123]
    v_mfma_f32_16x16x32_bf16 v[124:127], v[196:199], v[172:175], v[124:127]
    v_mfma_f32_16x16x32_bf16 v[128:131], v[184:187], v[176:179], v[128:131]
    v_mfma_f32_16x16x32_bf16 v[132:135], v[188:191], v[176:179], v[132:135]
    v_mfma_f32_16x16x32_bf16 v[136:139], v[192:195], v[176:179], v[136:139]
    v_mfma_f32_16x16x32_bf16 v[140:143], v[196:199], v[176:179], v[140:143]
    v_mfma_f32_16x16x32_bf16 v[144:147], v[184:187], v[180:183], v[144:147]
    v_mfma_f32_16x16x32_bf16 v[148:151], v[188:191], v[180:183], v[148:151]
    v_mfma_f32_16x16x32_bf16 v[152:155], v[192:195], v[180:183], v[152:155]
    v_mfma_f32_16x16x32_bf16 v[156:159], v[196:199], v[180:183], v[156:159]
    s_waitcnt vmcnt(7) lgkmcnt(0)
    s_barrier
    v_mfma_f32_16x16x32_bf16 v[64:67], v[224:227], v[200:203], v[64:67]
    s_add_u32 m0, s3, 0xc000
    ds_read_b64_tr_b16 v[184:185], v17 offset:0
    buffer_load_dwordx4 v13, s[28:31], s65 offen lds
    v_mfma_f32_16x16x32_bf16 v[68:71], v[228:231], v[200:203], v[68:71]
    s_add_u32 m0, s3, 0xc400
    ds_read_b64_tr_b16 v[186:187], v17 offset:512
    buffer_load_dwordx4 v14, s[28:31], s65 offen lds
    s_add_u32 s65, s65, 122880
    s_cmp_ge_u32 s65, 2457600
    s_cselect_b32 s65, 0, s65
    v_mfma_f32_16x16x32_bf16 v[72:75], v[232:235], v[200:203], v[72:75]
    s_add_u32 m0, s79, 0x1b000
    ds_read_b64_tr_b16 v[188:189], v18 offset:0
    buffer_load_dwordx4 v10, s[24:27], s64 offen lds
    v_mfma_f32_16x16x32_bf16 v[76:79], v[236:239], v[200:203], v[76:79]
    s_add_u32 m0, s79, 0x1d000
    ds_read_b64_tr_b16 v[190:191], v18 offset:512
    buffer_load_dwordx4 v11, s[24:27], s64 offen lds
    v_mfma_f32_16x16x32_bf16 v[80:83], v[224:227], v[204:207], v[80:83]
    ds_read_b64_tr_b16 v[192:193], v19 offset:0
    v_mfma_f32_16x16x32_bf16 v[84:87], v[228:231], v[204:207], v[84:87]
    ds_read_b64_tr_b16 v[194:195], v19 offset:512
    v_mfma_f32_16x16x32_bf16 v[88:91], v[232:235], v[204:207], v[88:91]
    ds_read_b64_tr_b16 v[196:197], v20 offset:0
    v_mfma_f32_16x16x32_bf16 v[92:95], v[236:239], v[204:207], v[92:95]
    ds_read_b64_tr_b16 v[198:199], v20 offset:512
    v_mfma_f32_16x16x32_bf16 v[96:99], v[224:227], v[208:211], v[96:99]
    ds_read_b128 v[160:163], v15 offset:0
    v_mfma_f32_16x16x32_bf16 v[100:103], v[228:231], v[208:211], v[100:103]
    ds_read_b128 v[164:167], v15 offset:2048
    v_mfma_f32_16x16x32_bf16 v[104:107], v[232:235], v[208:211], v[104:107]
    ds_read_b128 v[168:171], v15 offset:4096
    v_mfma_f32_16x16x32_bf16 v[108:111], v[236:239], v[208:211], v[108:111]
    ds_read_b128 v[172:175], v15 offset:6144
    v_mfma_f32_16x16x32_bf16 v[112:115], v[224:227], v[212:215], v[112:115]
    ds_read_b128 v[176:179], v15 offset:8192
    v_mfma_f32_16x16x32_bf16 v[116:119], v[228:231], v[212:215], v[116:119]
    ds_read_b128 v[180:183], v15 offset:10240
    v_mfma_f32_16x16x32_bf16 v[120:123], v[232:235], v[212:215], v[120:123]
    v_mfma_f32_16x16x32_bf16 v[124:127], v[236:239], v[212:215], v[124:127]
    v_mfma_f32_16x16x32_bf16 v[128:131], v[224:227], v[216:219], v[128:131]
    v_mfma_f32_16x16x32_bf16 v[132:135], v[228:231], v[216:219], v[132:135]
    v_mfma_f32_16x16x32_bf16 v[136:139], v[232:235], v[216:219], v[136:139]
    v_mfma_f32_16x16x32_bf16 v[140:143], v[236:239], v[216:219], v[140:143]
    v_mfma_f32_16x16x32_bf16 v[144:147], v[224:227], v[220:223], v[144:147]
    v_mfma_f32_16x16x32_bf16 v[148:151], v[228:231], v[220:223], v[148:151]
    v_mfma_f32_16x16x32_bf16 v[152:155], v[232:235], v[220:223], v[152:155]
    v_mfma_f32_16x16x32_bf16 v[156:159], v[236:239], v[220:223], v[156:159]
    s_waitcnt vmcnt(9) lgkmcnt(0)
    s_barrier
    v_mfma_f32_16x16x32_bf16 v[64:67], v[184:187], v[160:163], v[64:67]
    s_add_u32 m0, s3, 0x0
    ds_read_b64_tr_b16 v[224:225], v17 offset:16384
    buffer_load_dwordx4 v13, s[28:31], s65 offen lds
    s_add_u32 m0, s3, 0x400
    ds_read_b64_tr_b16 v[226:227], v17 offset:16896
    buffer_load_dwordx4 v14, s[28:31], s65 offen lds
    s_add_u32 s65, s65, 122880
    s_cmp_ge_u32 s65, 2457600
    s_cselect_b32 s65, 0, s65
    s_add_u32 m0, s78, 0x1b000
    ds_read_b64_tr_b16 v[228:229], v18 offset:16384
    buffer_load_dwordx4 v12, s[24:27], s64 offen lds
    s_add_u32 s64, s64, 128
    s_cmp_ge_u32 s64, 1280
    s_cselect_b32 s64, 0, s64
    v_mfma_f32_16x16x32_bf16 v[68:71], v[188:191], v[160:163], v[68:71]
    ds_read_b64_tr_b16 v[230:231], v18 offset:16896
    ds_read_b64_tr_b16 v[232:233], v19 offset:16384
    ds_read_b64_tr_b16 v[234:235], v19 offset:16896
    v_mfma_f32_16x16x32_bf16 v[72:75], v[192:195], v[160:163], v[72:75]
    ds_read_b64_tr_b16 v[236:237], v20 offset:16384
    ds_read_b64_tr_b16 v[238:239], v20 offset:16896
    ds_read_b128 v[200:203], v16 offset:0
    v_mfma_f32_16x16x32_bf16 v[76:79], v[196:199], v[160:163], v[76:79]
    ds_read_b128 v[204:207], v16 offset:2048
    ds_read_b128 v[208:211], v16 offset:4096
    ds_read_b128 v[212:215], v16 offset:6144
    v_mfma_f32_16x16x32_bf16 v[80:83], v[184:187], v[164:167], v[80:83]
    ds_read_b128 v[216:219], v16 offset:8192
    ds_read_b128 v[220:223], v16 offset:10240
    v_mfma_f32_16x16x32_bf16 v[84:87], v[188:191], v[164:167], v[84:87]
    v_lshlrev_b32 v6, 4, v4
    s_mul_i32 s66, s59, 96
    v_mfma_f32_16x16x32_bf16 v[88:91], v[192:195], v[164:167], v[88:91]
    s_mul_i32 s67, s62, 160
    s_add_u32 s66, s66, s67
    v_mfma_f32_16x16x32_bf16 v[92:95], v[196:199], v[164:167], v[92:95]
    s_sub_u32 s66, s66, 16
    s_lshl_b32 s66, s66, 4
    v_mfma_f32_16x16x32_bf16 v[96:99], v[184:187], v[168:171], v[96:99]
    v_and_b32 v63, 7, v2
    v_lshl_add_u32 v63, v63, 3, s66
    v_mfma_f32_16x16x32_bf16 v[100:103], v[188:191], v[168:171], v[100:103]
    v_bfe_u32 v7, v2, 3, 1
    v_lshl_add_u32 v63, v7, 7, v63
    v_mfma_f32_16x16x32_bf16 v[104:107], v[192:195], v[168:171], v[104:107]
    v_readlane_b32 s67, v25, 0
    s_nop 1
    v_add_u32 v52, s67, v6
    v_readlane_b32 s67, v25, 1
    s_nop 1
    v_add_u32 v53, s67, v6
    v_mfma_f32_16x16x32_bf16 v[108:111], v[196:199], v[168:171], v[108:111]
    v_readlane_b32 s67, v25, 2
    s_nop 1
    v_add_u32 v54, s67, v6
    v_readlane_b32 s67, v25, 3
    s_nop 1
    v_add_u32 v55, s67, v6
    v_mfma_f32_16x16x32_bf16 v[112:115], v[184:187], v[172:175], v[112:115]
    v_and_b32 v1, 15, v2
    s_mul_i32 s66, s59, 13440
    v_mfma_f32_16x16x32_bf16 v[116:119], v[188:191], v[172:175], v[116:119]
    s_mul_i32 s67, s60, 40
    s_add_u32 s66, s66, s67
    v_mfma_f32_16x16x32_bf16 v[120:123], v[192:195], v[172:175], v[120:123]
    v_mul_u32_u24 v5, 168, v1
    v_add_u32 v5, s66, v5
    v_mfma_f32_16x16x32_bf16 v[124:127], v[196:199], v[172:175], v[124:127]
    v_lshlrev_b32 v6, 4, v26
    v_cmp_gt_u32 s[76:77], 3, v26
    v_mfma_f32_16x16x32_bf16 v[128:131], v[184:187], v[176:179], v[128:131]
    v_cmp_gt_u32 s[74:75], 2, v26
    s_nop 1
    v_mfma_f32_16x16x32_bf16 v[132:135], v[188:191], v[176:179], v[132:135]
    v_cndmask_b32 v6, 0, v6, s[76:77]
    v_add_u32 v56, v5, v6
    v_mfma_f32_16x16x32_bf16 v[136:139], v[192:195], v[176:179], v[136:139]
    v_add_u32 v58, 67200, v56
    v_min_u32 v57, 191, v0
    v_mfma_f32_16x16x32_bf16 v[140:143], v[196:199], v[176:179], v[140:143]
    v_mul_u32_u24 v57, 168, v57
    v_add_u32 v57, 160, v57
    v_mfma_f32_16x16x32_bf16 v[144:147], v[184:187], v[180:183], v[144:147]
    v_lshrrev_b32 v60, 2, v2
    v_mul_u32_u24 v60, 168, v60
    v_mfma_f32_16x16x32_bf16 v[148:151], v[188:191], v[180:183], v[148:151]
    v_and_b32 v6, 3, v2
    v_lshl_add_u32 v60, v6, 3, v60
    v_mfma_f32_16x16x32_bf16 v[152:155], v[192:195], v[180:183], v[152:155]
    s_add_u32 s66, s66, 32256
    v_add_u32 v60, s66, v60
    v_mfma_f32_16x16x32_bf16 v[156:159], v[196:199], v[180:183], v[156:159]
    s_mul_i32 s66, s60, 5
    s_mul_i32 s67, s59, 12800
    s_waitcnt vmcnt(7) lgkmcnt(0)
    s_barrier
    v_mfma_f32_16x16x32_bf16 v[64:67], v[224:227], v[200:203], v[64:67]
    s_add_u32 m0, s3, 0x4000
    ds_read_b64_tr_b16 v[184:185], v17 offset:32768
    buffer_load_dwordx4 v13, s[28:31], s65 offen lds
    s_add_u32 m0, s3, 0x4400
    ds_read_b64_tr_b16 v[186:187], v17 offset:33280
    buffer_load_dwordx4 v14, s[28:31], s65 offen lds
    s_add_u32 s65, s65, 122880
    s_cmp_ge_u32 s65, 2457600
    s_cselect_b32 s65, 0, s65
    s_add_u32 m0, s79, 0x10000
    ds_read_b64_tr_b16 v[188:189], v18 offset:32768
    buffer_load_dwordx4 v10, s[24:27], s64 offen lds
    v_mfma_f32_16x16x32_bf16 v[68:71], v[228:231], v[200:203], v[68:71]
    s_add_u32 m0, s79, 0x12000
    ds_read_b64_tr_b16 v[190:191], v18 offset:33280
    buffer_load_dwordx4 v11, s[24:27], s64 offen lds
    ds_read_b64_tr_b16 v[192:193], v19 offset:32768
    ds_read_b64_tr_b16 v[194:195], v19 offset:33280
    v_mfma_f32_16x16x32_bf16 v[72:75], v[232:235], v[200:203], v[72:75]
    ds_read_b64_tr_b16 v[196:197], v20 offset:32768
    ds_read_b64_tr_b16 v[198:199], v20 offset:33280
    ds_read_b128 v[160:163], v15 offset:22528
    v_mfma_f32_16x16x32_bf16 v[76:79], v[236:239], v[200:203], v[76:79]
    ds_read_b128 v[164:167], v15 offset:24576
    ds_read_b128 v[168:171], v15 offset:26624
    ds_read_b128 v[172:175], v15 offset:28672
    v_mfma_f32_16x16x32_bf16 v[80:83], v[224:227], v[204:207], v[80:83]
    ds_read_b128 v[176:179], v15 offset:30720
    ds_read_b128 v[180:183], v15 offset:32768
    v_mfma_f32_16x16x32_bf16 v[84:87], v[228:231], v[204:207], v[84:87]
    s_add_u32 s67, s67, 122880
    v_add_u32 v6, s66, v26
    v_mfma_f32_16x16x32_bf16 v[88:91], v[232:235], v[204:207], v[88:91]
    v_lshrrev_b32 v7, 1, v6
    v_lshlrev_b32 v7, 8, v7
    v_mfma_f32_16x16x32_bf16 v[92:95], v[236:239], v[204:207], v[92:95]
    v_and_b32 v6, 1, v6
    v_lshl_add_u32 v7, v6, 3, v7
    v_mfma_f32_16x16x32_bf16 v[96:99], v[224:227], v[208:211], v[96:99]
    v_lshl_add_u32 v7, v1, 4, v7
    v_add_u32 v61, s67, v7
    v_mfma_f32_16x16x32_bf16 v[100:103], v[228:231], v[208:211], v[100:103]
    v_add_u32 v6, s66, v26
    v_add_u32 v6, 4, v6
    v_mfma_f32_16x16x32_bf16 v[104:107], v[232:235], v[208:211], v[104:107]
    v_lshrrev_b32 v7, 1, v6
    v_lshlrev_b32 v7, 8, v7
    v_mfma_f32_16x16x32_bf16 v[108:111], v[236:239], v[208:211], v[108:111]
    v_and_b32 v6, 1, v6
    v_lshl_add_u32 v7, v6, 3, v7
    v_mfma_f32_16x16x32_bf16 v[112:115], v[224:227], v[212:215], v[112:115]
    v_lshl_add_u32 v7, v1, 4, v7
    v_add_u32 v62, s67, v7
    v_mfma_f32_16x16x32_bf16 v[116:119], v[228:231], v[212:215], v[116:119]
    v_cmp_gt_u32 vcc, 16, v2
    v_mov_b32 v6, 83840
    v_mfma_f32_16x16x32_bf16 v[120:123], v[232:235], v[212:215], v[120:123]
    s_nop 1
    v_cndmask_b32 v62, v6, v62, vcc
    v_mfma_f32_16x16x32_bf16 v[124:127], v[236:239], v[212:215], v[124:127]
    v_mov_b32 v6, 0x40000000
    s_mov_b32 s67, 26215
    v_mfma_f32_16x16x32_bf16 v[128:131], v[224:227], v[216:219], v[128:131]
    s_mov_b32 s68, 74240
    s_lshl_b32 s66, s56, 10
    v_mfma_f32_16x16x32_bf16 v[132:135], v[228:231], v[216:219], v[132:135]
    s_add_u32 s66, s66, 0
    v_add_u32 v7, s66, v3
    v_mfma_f32_16x16x32_bf16 v[136:139], v[232:235], v[216:219], v[136:139]
    v_mul_lo_u32 v5, v7, s67
    v_lshrrev_b32 v5, 26, v5
    v_mfma_f32_16x16x32_bf16 v[140:143], v[236:239], v[216:219], v[140:143]
    v_mul_lo_u32 v5, v5, s68
    v_cmp_gt_u32 vcc, 25600, v7
    v_mfma_f32_16x16x32_bf16 v[144:147], v[224:227], v[220:223], v[144:147]
    v_add_u32 v5, v5, v7
    s_nop 0
    v_mfma_f32_16x16x32_bf16 v[148:151], v[228:231], v[220:223], v[148:151]
    v_cndmask_b32 v48, v6, v5, vcc
    s_lshl_b32 s66, s56, 10
    v_mfma_f32_16x16x32_bf16 v[152:155], v[232:235], v[220:223], v[152:155]
    s_add_u32 s66, s66, 8192
    v_add_u32 v7, s66, v3
    v_mfma_f32_16x16x32_bf16 v[156:159], v[236:239], v[220:223], v[156:159]
    v_mul_lo_u32 v5, v7, s67
    v_lshrrev_b32 v5, 26, v5
    s_waitcnt vmcnt(9) lgkmcnt(0)
    s_barrier
    v_mfma_f32_16x16x32_bf16 v[64:67], v[184:187], v[160:163], v[64:67]
    s_add_u32 m0, s3, 0x8000
    ds_read_b64_tr_b16 v[224:225], v17 offset:49152
    buffer_load_dwordx4 v13, s[28:31], s65 offen lds
    s_add_u32 m0, s3, 0x8400
    ds_read_b64_tr_b16 v[226:227], v17 offset:49664
    buffer_load_dwordx4 v14, s[28:31], s65 offen lds
    s_add_u32 s65, s65, 122880
    s_cmp_ge_u32 s65, 2457600
    s_cselect_b32 s65, 0, s65
    s_add_u32 m0, s78, 0x10000
    ds_read_b64_tr_b16 v[228:229], v18 offset:49152
    buffer_load_dwordx4 v12, s[24:27], s64 offen lds
    s_add_u32 s64, s64, 128
    s_cmp_ge_u32 s64, 1280
    s_cselect_b32 s64, 0, s64
    v_mfma_f32_16x16x32_bf16 v[68:71], v[188:191], v[160:163], v[68:71]
    ds_read_b64_tr_b16 v[230:231], v18 offset:49664
    ds_read_b64_tr_b16 v[232:233], v19 offset:49152
    ds_read_b64_tr_b16 v[234:235], v19 offset:49664
    v_mfma_f32_16x16x32_bf16 v[72:75], v[192:195], v[160:163], v[72:75]
    ds_read_b64_tr_b16 v[236:237], v20 offset:49152
    ds_read_b64_tr_b16 v[238:239], v20 offset:49664
    v_mfma_f32_16x16x32_bf16 v[76:79], v[196:199], v[160:163], v[76:79]
    ds_read_b128 v[200:203], v16 offset:22528
    ds_read_b128 v[204:207], v16 offset:24576
    v_mfma_f32_16x16x32_bf16 v[80:83], v[184:187], v[164:167], v[80:83]
    ds_read_b128 v[208:211], v16 offset:26624
    ds_read_b128 v[212:215], v16 offset:28672
    v_mfma_f32_16x16x32_bf16 v[84:87], v[188:191], v[164:167], v[84:87]
    ds_read_b128 v[216:219], v16 offset:30720
    ds_read_b128 v[220:223], v16 offset:32768
    v_mfma_f32_16x16x32_bf16 v[88:91], v[192:195], v[164:167], v[88:91]
    v_mul_lo_u32 v5, v5, s68
    v_cmp_gt_u32 vcc, 25600, v7
    v_mfma_f32_16x16x32_bf16 v[92:95], v[196:199], v[164:167], v[92:95]
    v_add_u32 v5, v5, v7
    s_nop 0
    v_mfma_f32_16x16x32_bf16 v[96:99], v[184:187], v[168:171], v[96:99]
    v_cndmask_b32 v49, v6, v5, vcc
    s_lshl_b32 s66, s56, 10
    v_mfma_f32_16x16x32_bf16 v[100:103], v[188:191], v[168:171], v[100:103]
    s_add_u32 s66, s66, 16384
    v_add_u32 v7, s66, v3
    v_mfma_f32_16x16x32_bf16 v[104:107], v[192:195], v[168:171], v[104:107]
    v_mul_lo_u32 v5, v7, s67
    v_lshrrev_b32 v5, 26, v5
    v_mfma_f32_16x16x32_bf16 v[108:111], v[196:199], v[168:171], v[108:111]
    v_mul_lo_u32 v5, v5, s68
    v_cmp_gt_u32 vcc, 25600, v7
    v_mfma_f32_16x16x32_bf16 v[112:115], v[184:187], v[172:175], v[112:115]
    v_add_u32 v5, v5, v7
    s_nop 0
    v_mfma_f32_16x16x32_bf16 v[116:119], v[188:191], v[172:175], v[116:119]
    v_cndmask_b32 v50, v6, v5, vcc
    s_lshl_b32 s66, s56, 10
    v_mfma_f32_16x16x32_bf16 v[120:123], v[192:195], v[172:175], v[120:123]
    s_add_u32 s66, s66, 24576
    v_add_u32 v7, s66, v3
    v_mfma_f32_16x16x32_bf16 v[124:127], v[196:199], v[172:175], v[124:127]
    v_mul_lo_u32 v5, v7, s67
    v_lshrrev_b32 v5, 26, v5
    v_mfma_f32_16x16x32_bf16 v[128:131], v[184:187], v[176:179], v[128:131]
    v_mul_lo_u32 v5, v5, s68
    v_cmp_gt_u32 vcc, 25600, v7
    v_mfma_f32_16x16x32_bf16 v[132:135], v[188:191], v[176:179], v[132:135]
    v_add_u32 v5, v5, v7
    s_nop 0
    v_mfma_f32_16x16x32_bf16 v[136:139], v[192:195], v[176:179], v[136:139]
    v_cndmask_b32 v51, v6, v5, vcc
    v_cmp_gt_u32 vcc, 20, v2
    v_mfma_f32_16x16x32_bf16 v[140:143], v[196:199], v[176:179], v[140:143]
    s_nop 1
    v_cndmask_b32 v27, v6, v3, vcc
    v_mfma_f32_16x16x32_bf16 v[144:147], v[184:187], v[180:183], v[144:147]
    s_mul_i32 s69, s62, 768000
    s_mul_i32 s67, s57, 2560
    v_mfma_f32_16x16x32_bf16 v[148:151], v[188:191], v[180:183], v[148:151]
    s_add_u32 s69, s69, s67
    s_mul_i32 s70, s57, 320
    v_mfma_f32_16x16x32_bf16 v[152:155], v[192:195], v[180:183], v[152:155]
    s_add_u32 s70, s70, 32768
    s_add_u32 s71, s70, 2560
    v_mfma_f32_16x16x32_bf16 v[156:159], v[196:199], v[180:183], v[156:159]
    s_add_u32 s72, s70, 5120
    v_mov_b32 v249, 240
    s_waitcnt vmcnt(7) lgkmcnt(0)
    s_barrier
    v_mfma_f32_16x16x32_bf16 v[64:67], v[224:227], v[200:203], v[64:67]
    s_add_u32 m0, s3, 0xc000
    ds_read_b64_tr_b16 v[184:185], v17 offset:0
    buffer_load_dwordx4 v13, s[28:31], s65 offen lds
    v_mfma_f32_16x16x32_bf16 v[68:71], v[228:231], v[200:203], v[68:71]
    s_add_u32 m0, s3, 0xc400
    ds_read_b64_tr_b16 v[186:187], v17 offset:512
    buffer_load_dwordx4 v14, s[28:31], s65 offen lds
    s_add_u32 s65, s65, 122880
    s_cmp_ge_u32 s65, 2457600
    s_cselect_b32 s65, 0, s65
    v_mfma_f32_16x16x32_bf16 v[72:75], v[232:235], v[200:203], v[72:75]
    ds_read_b64_tr_b16 v[188:189], v18 offset:0
    v_mfma_f32_16x16x32_bf16 v[76:79], v[236:239], v[200:203], v[76:79]
    ds_read_b64_tr_b16 v[190:191], v18 offset:512
    v_mfma_f32_16x16x32_bf16 v[80:83], v[224:227], v[204:207], v[80:83]
    ds_read_b64_tr_b16 v[192:193], v19 offset:0
    v_mfma_f32_16x16x32_bf16 v[84:87], v[228:231], v[204:207], v[84:87]
    ds_read_b64_tr_b16 v[194:195], v19 offset:512
    v_mfma_f32_16x16x32_bf16 v[88:91], v[232:235], v[204:207], v[88:91]
    ds_read_b64_tr_b16 v[196:197], v20 offset:0
    v_mfma_f32_16x16x32_bf16 v[92:95], v[236:239], v[204:207], v[92:95]
    ds_read_b64_tr_b16 v[198:199], v20 offset:512
    v_mfma_f32_16x16x32_bf16 v[96:99], v[224:227], v[208:211], v[96:99]
    ds_read_b128 v[160:163], v15 offset:45056
    v_mfma_f32_16x16x32_bf16 v[100:103], v[228:231], v[208:211], v[100:103]
    ds_read_b128 v[164:167], v15 offset:47104
    v_mfma_f32_16x16x32_bf16 v[104:107], v[232:235], v[208:211], v[104:107]
    ds_read_b128 v[168:171], v15 offset:49152
    v_mfma_f32_16x16x32_bf16 v[108:111], v[236:239], v[208:211], v[108:111]
    ds_read_b128 v[172:175], v15 offset:51200
    v_mfma_f32_16x16x32_bf16 v[112:115], v[224:227], v[212:215], v[112:115]
    ds_read_b128 v[176:179], v15 offset:53248
    v_mfma_f32_16x16x32_bf16 v[116:119], v[228:231], v[212:215], v[116:119]
    ds_read_b128 v[180:183], v15 offset:55296
    v_mfma_f32_16x16x32_bf16 v[120:123], v[232:235], v[212:215], v[120:123]
    buffer_load_dword v248, v249, s[52:55], 0 offen sc1
    v_mfma_f32_16x16x32_bf16 v[124:127], v[236:239], v[212:215], v[124:127]
    v_mfma_f32_16x16x32_bf16 v[128:131], v[224:227], v[216:219], v[128:131]
    v_mfma_f32_16x16x32_bf16 v[132:135], v[228:231], v[216:219], v[132:135]
    v_mfma_f32_16x16x32_bf16 v[136:139], v[232:235], v[216:219], v[136:139]
    v_mfma_f32_16x16x32_bf16 v[140:143], v[236:239], v[216:219], v[140:143]
    v_mfma_f32_16x16x32_bf16 v[144:147], v[224:227], v[220:223], v[144:147]
    v_mfma_f32_16x16x32_bf16 v[148:151], v[228:231], v[220:223], v[148:151]
    v_mfma_f32_16x16x32_bf16 v[152:155], v[232:235], v[220:223], v[152:155]
    v_mfma_f32_16x16x32_bf16 v[156:159], v[236:239], v[220:223], v[156:159]
    s_waitcnt vmcnt(7) lgkmcnt(0)
    s_barrier
    v_mfma_f32_16x16x32_bf16 v[64:67], v[184:187], v[160:163], v[64:67]
    ds_read_b64_tr_b16 v[224:225], v17 offset:16384
    v_mfma_f32_16x16x32_bf16 v[68:71], v[188:191], v[160:163], v[68:71]
    ds_read_b64_tr_b16 v[226:227], v17 offset:16896
    v_mfma_f32_16x16x32_bf16 v[72:75], v[192:195], v[160:163], v[72:75]
    ds_read_b64_tr_b16 v[228:229], v18 offset:16384
    v_mfma_f32_16x16x32_bf16 v[76:79], v[196:199], v[160:163], v[76:79]
    ds_read_b64_tr_b16 v[230:231], v18 offset:16896
    v_mfma_f32_16x16x32_bf16 v[80:83], v[184:187], v[164:167], v[80:83]
    ds_read_b64_tr_b16 v[232:233], v19 offset:16384
    v_mfma_f32_16x16x32_bf16 v[84:87], v[188:191], v[164:167], v[84:87]
    ds_read_b64_tr_b16 v[234:235], v19 offset:16896
    v_mfma_f32_16x16x32_bf16 v[88:91], v[192:195], v[164:167], v[88:91]
    ds_read_b64_tr_b16 v[236:237], v20 offset:16384
    v_mfma_f32_16x16x32_bf16 v[92:95], v[196:199], v[164:167], v[92:95]
    ds_read_b64_tr_b16 v[238:239], v20 offset:16896
    v_mfma_f32_16x16x32_bf16 v[96:99], v[184:187], v[168:171], v[96:99]
    ds_read_b128 v[200:203], v16 offset:45056
    v_mfma_f32_16x16x32_bf16 v[100:103], v[188:191], v[168:171], v[100:103]
    ds_read_b128 v[204:207], v16 offset:47104
    v_mfma_f32_16x16x32_bf16 v[104:107], v[192:195], v[168:171], v[104:107]
    ds_read_b128 v[208:211], v16 offset:49152
    v_mfma_f32_16x16x32_bf16 v[108:111], v[196:199], v[168:171], v[108:111]
    ds_read_b128 v[212:215], v16 offset:51200
    v_mfma_f32_16x16x32_bf16 v[112:115], v[184:187], v[172:175], v[112:115]
    ds_read_b128 v[216:219], v16 offset:53248
    v_mfma_f32_16x16x32_bf16 v[116:119], v[188:191], v[172:175], v[116:119]
    ds_read_b128 v[220:223], v16 offset:55296
    v_mfma_f32_16x16x32_bf16 v[120:123], v[192:195], v[172:175], v[120:123]
    v_mfma_f32_16x16x32_bf16 v[124:127], v[196:199], v[172:175], v[124:127]
    v_mfma_f32_16x16x32_bf16 v[128:131], v[184:187], v[176:179], v[128:131]
    v_mfma_f32_16x16x32_bf16 v[132:135], v[188:191], v[176:179], v[132:135]
    v_mfma_f32_16x16x32_bf16 v[136:139], v[192:195], v[176:179], v[136:139]
    v_mfma_f32_16x16x32_bf16 v[140:143], v[196:199], v[176:179], v[140:143]
    v_mfma_f32_16x16x32_bf16 v[144:147], v[184:187], v[180:183], v[144:147]
    v_mfma_f32_16x16x32_bf16 v[148:151], v[188:191], v[180:183], v[148:151]
    v_mfma_f32_16x16x32_bf16 v[152:155], v[192:195], v[180:183], v[152:155]
    v_mfma_f32_16x16x32_bf16 v[156:159], v[196:199], v[180:183], v[156:159]
    s_waitcnt vmcnt(0) lgkmcnt(0)
    s_mov_b32 s66, 0
L_poll_att:
    v_readfirstlane_b32 s67, v248
    s_add_u32 s66, s66, 1
    s_cmp_ge_u32 s67, 256
    s_cbranch_scc1 L_pollok_att
    s_cmp_ge_u32 s66, 0x40000
    s_cbranch_scc1 L_pollok_att
    s_sleep 2
    buffer_load_dword v248, v249, s[52:55], 0 offen sc1
    s_waitcnt vmcnt(0)
    s_branch L_poll_att
L_pollok_att:
    s_barrier
    v_mfma_f32_16x16x32_bf16 v[64:67], v[224:227], v[200:203], v[64:67]
    ds_read_b64_tr_b16 v[184:185], v17 offset:32768
    v_mfma_f32_16x16x32_bf16 v[68:71], v[228:231], v[200:203], v[68:71]
    ds_read_b64_tr_b16 v[186:187], v17 offset:33280
    v_mfma_f32_16x16x32_bf16 v[72:75], v[232:235], v[200:203], v[72:75]
    ds_read_b64_tr_b16 v[188:189], v18 offset:32768
    v_mfma_f32_16x16x32_bf16 v[76:79], v[236:239], v[200:203], v[76:79]
    ds_read_b64_tr_b16 v[190:191], v18 offset:33280
    v_mfma_f32_16x16x32_bf16 v[80:83], v[224:227], v[204:207], v[80:83]
    ds_read_b64_tr_b16 v[192:193], v19 offset:32768
    v_mfma_f32_16x16x32_bf16 v[84:87], v[228:231], v[204:207], v[84:87]
    ds_read_b64_tr_b16 v[194:195], v19 offset:33280
    v_mfma_f32_16x16x32_bf16 v[88:91], v[232:235], v[204:207], v[88:91]
    ds_read_b64_tr_b16 v[196:197], v20 offset:32768
    v_mfma_f32_16x16x32_bf16 v[92:95], v[236:239], v[204:207], v[92:95]
    ds_read_b64_tr_b16 v[198:199], v20 offset:33280
    v_mfma_f32_16x16x32_bf16 v[96:99], v[224:227], v[208:211], v[96:99]
    ds_read_b128 v[160:163], v15 offset:0
    v_mfma_f32_16x16x32_bf16 v[100:103], v[228:231], v[208:211], v[100:103]
    ds_read_b128 v[164:167], v15 offset:2048
    v_mfma_f32_16x16x32_bf16 v[104:107], v[232:235], v[208:211], v[104:107]
    ds_read_b128 v[168:171], v15 offset:4096
    v_mfma_f32_16x16x32_bf16 v[108:111], v[236:239], v[208:211], v[108:111]
    ds_read_b128 v[172:175], v15 offset:6144
    v_mfma_f32_16x16x32_bf16 v[112:115], v[224:227], v[212:215], v[112:115]
    ds_read_b128 v[176:179], v15 offset:8192
    v_mfma_f32_16x16x32_bf16 v[116:119], v[228:231], v[212:215], v[116:119]
    ds_read_b128 v[180:183], v15 offset:10240
    v_mfma_f32_16x16x32_bf16 v[120:123], v[232:235], v[212:215], v[120:123]
    v_add_u32 v1, 256, v63
    v_mfma_f32_16x16x32_bf16 v[124:127], v[236:239], v[212:215], v[124:127]
    buffer_load_dwordx2 v[36:37], v63, s[36:39], 0 offen sc1
    v_mfma_f32_16x16x32_bf16 v[128:131], v[224:227], v[216:219], v[128:131]
    buffer_load_dwordx2 v[38:39], v1, s[36:39], 0 offen offset:0 sc1
    v_mfma_f32_16x16x32_bf16 v[132:135], v[228:231], v[216:219], v[132:135]
    buffer_load_dwordx2 v[40:41], v1, s[36:39], 0 offen offset:256 sc1
    v_mfma_f32_16x16x32_bf16 v[136:139], v[232:235], v[216:219], v[136:139]
    buffer_load_dwordx2 v[42:43], v1, s[36:39], 0 offen offset:512 sc1
    v_mfma_f32_16x16x32_bf16 v[140:143], v[236:239], v[216:219], v[140:143]
    buffer_load_dwordx2 v[44:45], v1, s[36:39], 0 offen offset:768 sc1
    v_mfma_f32_16x16x32_bf16 v[144:147], v[224:227], v[220:223], v[144:147]
    buffer_load_dwordx2 v[46:47], v1, s[36:39], 0 offen offset:1024 sc1
    v_mfma_f32_16x16x32_bf16 v[148:151], v[228:231], v[220:223], v[148:151]
    s_mov_b32 m0, 150528
    s_nop 0
    buffer_load_dwordx4 v27, s[36:39], s70 offen sc1 lds
    v_mfma_f32_16x16x32_bf16 v[152:155], v[232:235], v[220:223], v[152:155]
    s_mov_b32 m0, 151552
    s_nop 0
    buffer_load_dwordx4 v27, s[36:39], s71 offen sc1 lds
    v_mfma_f32_16x16x32_bf16 v[156:159], v[236:239], v[220:223], v[156:159]
    s_mov_b32 m0, 152576
    s_nop 0
    buffer_load_dwordx4 v27, s[36:39], s72 offen sc1 lds
    s_waitcnt vmcnt(3) lgkmcnt(0)
    s_barrier
    v_mfma_f32_16x16x32_bf16 v[64:67], v[184:187], v[160:163], v[64:67]
    ds_read_b64_tr_b16 v[224:225], v17 offset:49152
    v_mfma_f32_16x16x32_bf16 v[68:71], v[188:191], v[160:163], v[68:71]
    ds_read_b64_tr_b16 v[226:227], v17 offset:49664
    v_mfma_f32_16x16x32_bf16 v[72:75], v[192:195], v[160:163], v[72:75]
    ds_read_b64_tr_b16 v[228:229], v18 offset:49152
    v_mfma_f32_16x16x32_bf16 v[76:79], v[196:199], v[160:163], v[76:79]
    ds_read_b64_tr_b16 v[230:231], v18 offset:49664
    v_mfma_f32_16x16x32_bf16 v[80:83], v[184:187], v[164:167], v[80:83]
    ds_read_b64_tr_b16 v[232:233], v19 offset:49152
    v_mfma_f32_16x16x32_bf16 v[84:87], v[188:191], v[164:167], v[84:87]
    ds_read_b64_tr_b16 v[234:235], v19 offset:49664
    v_mfma_f32_16x16x32_bf16 v[88:91], v[192:195], v[164:167], v[88:91]
    ds_read_b64_tr_b16 v[236:237], v20 offset:49152
    v_mfma_f32_16x16x32_bf16 v[92:95], v[196:199], v[164:167], v[92:95]
    ds_read_b64_tr_b16 v[238:239], v20 offset:49664
    v_mfma_f32_16x16x32_bf16 v[96:99], v[184:187], v[168:171], v[96:99]
    ds_read_b128 v[200:203], v16 offset:0
    v_mfma_f32_16x16x32_bf16 v[100:103], v[188:191], v[168:171], v[100:103]
    ds_read_b128 v[204:207], v16 offset:2048
    v_mfma_f32_16x16x32_bf16 v[104:107], v[192:195], v[168:171], v[104:107]
    ds_read_b128 v[208:211], v16 offset:4096
    v_mfma_f32_16x16x32_bf16 v[108:111], v[196:199], v[168:171], v[108:111]
    ds_read_b128 v[212:215], v16 offset:6144
    v_mfma_f32_16x16x32_bf16 v[112:115], v[184:187], v[172:175], v[112:115]
    ds_read_b128 v[216:219], v16 offset:8192
    v_mfma_f32_16x16x32_bf16 v[116:119], v[188:191], v[172:175], v[116:119]
    ds_read_b128 v[220:223], v16 offset:10240
    v_mfma_f32_16x16x32_bf16 v[120:123], v[192:195], v[172:175], v[120:123]
    v_mfma_f32_16x16x32_bf16 v[124:127], v[196:199], v[172:175], v[124:127]
    v_mfma_f32_16x16x32_bf16 v[128:131], v[184:187], v[176:179], v[128:131]
    v_mfma_f32_16x16x32_bf16 v[132:135], v[188:191], v[176:179], v[132:135]
    v_mfma_f32_16x16x32_bf16 v[136:139], v[192:195], v[176:179], v[136:139]
    v_mfma_f32_16x16x32_bf16 v[140:143], v[196:199], v[176:179], v[140:143]
    v_mfma_f32_16x16x32_bf16 v[144:147], v[184:187], v[180:183], v[144:147]
    v_mfma_f32_16x16x32_bf16 v[148:151], v[188:191], v[180:183], v[148:151]
    v_mfma_f32_16x16x32_bf16 v[152:155], v[192:195], v[180:183], v[152:155]
    v_mfma_f32_16x16x32_bf16 v[156:159], v[196:199], v[180:183], v[156:159]
    s_waitcnt vmcnt(0) lgkmcnt(0)
    s_barrier
    v_mfma_f32_16x16x32_bf16 v[64:67], v[224:227], v[200:203], v[64:67]
    ds_read_b128 v[240:243], v52
    v_mfma_f32_16x16x32_bf16 v[68:71], v[228:231], v[200:203], v[68:71]
    ds_read_b128 v[244:247], v53
    v_mfma_f32_16x16x32_bf16 v[72:75], v[232:235], v[200:203], v[72:75]
    ds_read_b128 v[248:251], v54
    v_mfma_f32_16x16x32_bf16 v[76:79], v[236:239], v[200:203], v[76:79]
    ds_read_b128 v[252:255], v55
    v_mfma_f32_16x16x32_bf16 v[80:83], v[224:227], v[204:207], v[80:83]
    v_mfma_f32_16x16x32_bf16 v[84:87], v[228:231], v[204:207], v[84:87]
    v_mfma_f32_16x16x32_bf16 v[88:91], v[232:235], v[204:207], v[88:91]
    v_mfma_f32_16x16x32_bf16 v[92:95], v[236:239], v[204:207], v[92:95]
    v_mfma_f32_16x16x32_bf16 v[96:99], v[224:227], v[208:211], v[96:99]
    v_mfma_f32_16x16x32_bf16 v[100:103], v[228:231], v[208:211], v[100:103]
    v_mfma_f32_16x16x32_bf16 v[104:107], v[232:235], v[208:211], v[104:107]
    v_mfma_f32_16x16x32_bf16 v[108:111], v[236:239], v[208:211], v[108:111]
    v_mfma_f32_16x16x32_bf16 v[112:115], v[224:227], v[212:215], v[112:115]
    v_mfma_f32_16x16x32_bf16 v[116:119], v[228:231], v[212:215], v[116:119]
    v_mfma_f32_16x16x32_bf16 v[120:123], v[232:235], v[212:215], v[120:123]
    v_mfma_f32_16x16x32_bf16 v[124:127], v[236:239], v[212:215], v[124:127]
    v_mfma_f32_16x16x32_bf16 v[128:131], v[224:227], v[216:219], v[128:131]
    v_mfma_f32_16x16x32_bf16 v[132:135], v[228:231], v[216:219], v[132:135]
    v_mfma_f32_16x16x32_bf16 v[136:139], v[232:235], v[216:219], v[136:139]
    v_mfma_f32_16x16x32_bf16 v[140:143], v[236:239], v[216:219], v[140:143]
    v_mfma_f32_16x16x32_bf16 v[144:147], v[224:227], v[220:223], v[144:147]
    v_mfma_f32_16x16x32_bf16 v[148:151], v[228:231], v[220:223], v[148:151]
    v_mfma_f32_16x16x32_bf16 v[152:155], v[232:235], v[220:223], v[152:155]
    v_mfma_f32_16x16x32_bf16 v[156:159], v[236:239], v[220:223], v[156:159]
    s_branch L_att_epi
L_att_wm1:
    s_add_u32 m0, s3, 0x0
    s_nop 0
    buffer_load_dwordx4 v13, s[28:31], s65 offen lds
    s_add_u32 m0, s3, 0x400
    s_nop 0
    buffer_load_dwordx4 v14, s[28:31], s65 offen lds
    s_add_u32 s65, s65, 122880
    s_cmp_ge_u32 s65, 2457600
    s_cselect_b32 s65, 0, s65
    s_add_u32 m0, s79, 0x10000
    s_nop 0
    buffer_load_dwordx4 v10, s[24:27], s64 offen lds
    s_add_u32 m0, s79, 0x12000
    s_nop 0
    buffer_load_dwordx4 v11, s[24:27], s64 offen lds
    s_add_u32 m0, s78, 0x10000
    s_nop 0
    buffer_load_dwordx4 v12, s[24:27], s64 offen lds
    s_add_u32 s64, s64, 128
    s_cmp_ge_u32 s64, 1280
    s_cselect_b32 s64, 0, s64
    s_add_u32 m0, s3, 0x4000
    s_nop 0
    buffer_load_dwordx4 v13, s[28:31], s65 offen lds
    s_add_u32 m0, s3, 0x4400
    s_nop 0
    buffer_load_dwordx4 v14, s[28:31], s65 offen lds
    s_add_u32 s65, s65, 122880
    s_cmp_ge_u32 s65, 2457600
    s_cselect_b32 s65, 0, s65
    s_add_u32 m0, s79, 0x15800
    s_nop 0
    buffer_load_dwordx4 v10, s[24:27], s64 offen lds
    s_add_u32 m0, s79, 0x17800
    s_nop 0
    buffer_load_dwordx4 v11, s[24:27], s64 offen lds
    s_add_u32 m0, s78, 0x15800
    s_nop 0
    buffer_load_dwordx4 v12, s[24:27], s64 offen lds
    s_add_u32 s64, s64, 128
    s_cmp_ge_u32 s64, 1280
    s_cselect_b32 s64, 0, s64
    buffer_load_dwordx4 v[36:39], v30, s[24:27], 0 offen
    buffer_load_dwordx4 v[40:43], v30, s[24:27], 0 offen offset:640
    buffer_load_dwordx4 v[48:51], v31, s[40:43], s77 offen
    v_and_b32 v1, 15, v2
    s_mul_i32 s66, s59, 96
    v_add_u32 v5, s66, v1
    v_mul_u32_u24 v5, 168, v5
    v_lshl_add_u32 v5, v4, 3, v5
    s_lshl_b32 s66, s60, 2
    s_add_u32 s66, s66, 0
    s_min_u32 s66, s66, 14
    s_cmp_ge_u32 s66, 5
    s_cselect_b32 s67, 5, 0
    s_cselect_b32 s68, 0, 64512
    s_cselect_b32 s69, 1024, 0
    s_cmp_ge_u32 s66, 10
    s_cselect_b32 s67, 10, s67
    s_cselect_b32 s68, 32256, s68
    s_cselect_b32 s69, 2048, s69
    s_sub_u32 s66, s66, s67
    s_lshl_b32 s67, s66, 5
    s_add_u32 s67, s67, s68
    v_add_u32 v21, s67, v5
    s_lshl_b32 s66, s66, 6
    s_add_u32 s66, s66, s69
    s_add_u32 s66, s66, 150528
    v_writelane_b32 v25, s66, 0
    s_lshl_b32 s66, s60, 2
    s_add_u32 s66, s66, 1
    s_min_u32 s66, s66, 14
    s_cmp_ge_u32 s66, 5
    s_cselect_b32 s67, 5, 0
    s_cselect_b32 s68, 0, 64512
    s_cselect_b32 s69, 1024, 0
    s_cmp_ge_u32 s66, 10
    s_cselect_b32 s67, 10, s67
    s_cselect_b32 s68, 32256, s68
    s_cselect_b32 s69, 2048, s69
    s_sub_u32 s66, s66, s67
    s_lshl_b32 s67, s66, 5
    s_add_u32 s67, s67, s68
    v_add_u32 v22, s67, v5
    s_lshl_b32 s66, s66, 6
    s_add_u32 s66, s66, s69
    s_add_u32 s66, s66, 150528
    v_writelane_b32 v25, s66, 1
    s_lshl_b32 s66, s60, 2
    s_add_u32 s66, s66, 2
    s_min_u32 s66, s66, 14
    s_cmp_ge_u32 s66, 5
    s_cselect_b32 s67, 5, 0
    s_cselect_b32 s68, 0, 64512
    s_cselect_b32 s69, 1024, 0
    s_cmp_ge_u32 s66, 10
    s_cselect_b32 s67, 10, s67
    s_cselect_b32 s68, 32256, s68
    s_cselect_b32 s69, 2048, s69
    s_sub_u32 s66, s66, s67
    s_lshl_b32 s67, s66, 5
    s_add_u32 s67, s67, s68
    v_add_u32 v23, s67, v5
    s_lshl_b32 s66, s66, 6
    s_add_u32 s66, s66, s69
    s_add_u32 s66, s66, 150528
    v_writelane_b32 v25, s66, 2
    s_lshl_b32 s66, s60, 2
    s_add_u32 s66, s66, 3
    s_min_u32 s66, s66, 14
    s_cmp_ge_u32 s66, 5
    s_cselect_b32 s67, 5, 0
    s_cselect_b32 s68, 0, 64512
    s_cselect_b32 s69, 1024, 0
    s_cmp_ge_u32 s66, 10
    s_cselect_b32 s67, 10, s67
    s_cselect_b32 s68, 32256, s68
    s_cselect_b32 s69, 2048, s69
    s_sub_u32 s66, s66, s67
    s_lshl_b32 s67, s66, 5
    s_add_u32 s67, s67, s68
    v_add_u32 v24, s67, v5
    s_lshl_b32 s66, s66, 6
    s_add_u32 s66, s66, s69
    s_add_u32 s66, s66, 150528
    v_writelane_b32 v25, s66, 3
    v_lshrrev_b32 v26, 4, v2
    v_lshlrev_b32 v6, 2, v26
    v_sub_u32 v6, v1, v6
    v_add_u32 v7, 16, v6
    v_alignbit_b32 v7, v7, v7, 1
    v_cmp_ge_u32 s[4:5], 7, v7
    v_add_u32 v7, 15, v6
    v_alignbit_b32 v7, v7, v7, 1
    v_cmp_ge_u32 s[6:7], 7, v7
    v_add_u32 v7, 14, v6
    v_alignbit_b32 v7, v7, v7, 1
    v_cmp_ge_u32 s[8:9], 7, v7
    v_add_u32 v7, 13, v6
    v_alignbit_b32 v7, v7, v7, 1
    v_cmp_ge_u32 s[10:11], 7, v7
    v_add_u32 v7, 0, v6
    v_alignbit_b32 v7, v7, v7, 1
    v_cmp_ge_u32 s[12:13], 7, v7
    v_add_u32 v7, -1, v6
    v_alignbit_b32 v7, v7, v7, 1
    v_cmp_ge_u32 s[14:15], 7, v7
    v_add_u32 v7, -2, v6
    v_alignbit_b32 v7, v7, v7, 1
    v_cmp_ge_u32 s[16:17], 7, v7
    v_add_u32 v7, -3, v6
    v_alignbit_b32 v7, v7, v7, 1
    v_cmp_ge_u32 s[18:19], 7, v7
    s_waitcnt vmcnt(5)
    s_barrier
    ds_read_b64_tr_b16 v[184:185], v17 offset:0
    ds_read_b64_tr_b16 v[186:187], v17 offset:512
    ds_read_b64_tr_b16 v[188:189], v18 offset:0
    ds_read_b64_tr_b16 v[190:191], v18 offset:512
    ds_read_b64_tr_b16 v[192:193], v19 offset:0
    ds_read_b64_tr_b16 v[194:195], v19 offset:512
    ds_read_b64_tr_b16 v[196:197], v20 offset:0
    ds_read_b64_tr_b16 v[198:199], v20 offset:512
    ds_read_b128 v[160:163], v15 offset:0
    ds_read_b128 v[164:167], v15 offset:2048
    ds_read_b128 v[168:171], v15 offset:4096
    ds_read_b128 v[172:175], v15 offset:6144
    ds_read_b128 v[176:179], v15 offset:8192
    s_waitcnt vmcnt(3) lgkmcnt(0)
    s_barrier
    v_mfma_f32_16x16x32_bf16 v[64:67], v[184:187], v[160:163], 0
    s_add_u32 m0, s3, 0x8000
    ds_read_b64_tr_b16 v[224:225], v17 offset:16384
    buffer_load_dwordx4 v13, s[28:31], s65 offen lds
    v_mfma_f32_16x16x32_bf16 v[68:71], v[188:191], v[160:163], 0
    s_add_u32 m0, s3, 0x8400
    ds_read_b64_tr_b16 v[226:227], v17 offset:16896
    buffer_load_dwordx4 v14, s[28:31], s65 offen lds
    s_add_u32 s65, s65, 122880
    s_cmp_ge_u32 s65, 2457600
    s_cselect_b32 s65, 0, s65
    v_mfma_f32_16x16x32_bf16 v[72:75], v[192:195], v[160:163], 0
    s_add_u32 m0, s3, 0xc000
    ds_read_b64_tr_b16 v[228:229], v18 offset:16384
    buffer_load_dwordx4 v13, s[28:31], s65 offen lds
    v_mfma_f32_16x16x32_bf16 v[76:79], v[196:199], v[160:163], 0
    s_add_u32 m0, s3, 0xc400
    ds_read_b64_tr_b16 v[230:231], v18 offset:16896
    buffer_load_dwordx4 v14, s[28:31], s65 offen lds
    s_add_u32 s65, s65, 122880
    s_cmp_ge_u32 s65, 2457600
    s_cselect_b32 s65, 0, s65
    v_mfma_f32_16x16x32_bf16 v[80:83], v[184:187], v[164:167], 0
    s_add_u32 m0, s79, 0x1b000
    ds_read_b64_tr_b16 v[232:233], v19 offset:16384
    buffer_load_dwordx4 v10, s[24:27], s64 offen lds
    v_mfma_f32_16x16x32_bf16 v[84:87], v[188:191], v[164:167], 0
    s_add_u32 m0, s79, 0x1d000
    ds_read_b64_tr_b16 v[234:235], v19 offset:16896
    buffer_load_dwordx4 v11, s[24:27], s64 offen lds
    v_mfma_f32_16x16x32_bf16 v[88:91], v[192:195], v[164:167], 0
    ds_read_b64_tr_b16 v[236:237], v20 offset:16384
    v_mfma_f32_16x16x32_bf16 v[92:95], v[196:199], v[164:167], 0
    ds_read_b64_tr_b16 v[238:239], v20 offset:16896
    v_mfma_f32_16x16x32_bf16 v[96:99], v[184:187], v[168:171], 0
    ds_read_b128 v[200:203], v16 offset:0
    v_mfma_f32_16x16x32_bf16 v[100:103], v[188:191], v[168:171], 0
    ds_read_b128 v[204:207], v16 offset:2048
    v_mfma_f32_16x16x32_bf16 v[104:107], v[192:195], v[168:171], 0
    ds_read_b128 v[208:211], v16 offset:4096
    v_mfma_f32_16x16x32_bf16 v[108:111], v[196:199], v[168:171], 0
    ds_read_b128 v[212:215], v16 offset:6144
    v_mfma_f32_16x16x32_bf16 v[112:115], v[184:187], v[172:175], 0
    ds_read_b128 v[216:219], v16 offset:8192
    v_mfma_f32_16x16x32_bf16 v[116:119], v[188:191], v[172:175], 0
    buffer_load_dwordx4 v[52:55], v31, s[40:43], s76 offen
    v_mfma_f32_16x16x32_bf16 v[120:123], v[192:195], v[172:175], 0
    buffer_load_dwordx4 v[44:47], v31, s[40:43], 0 offen
    v_mfma_f32_16x16x32_bf16 v[124:127], v[196:199], v[172:175], 0
    buffer_load_dwordx4 v[56:59], v31, s[40:43], s75 offen
    v_mfma_f32_16x16x32_bf16 v[128:131], v[184:187], v[176:179], 0
    buffer_load_dwordx4 v[60:63], v31, s[40:43], s74 offen
    v_mfma_f32_16x16x32_bf16 v[132:135], v[188:191], v[176:179], 0
    v_mfma_f32_16x16x32_bf16 v[136:139], v[192:195], v[176:179], 0
    v_mfma_f32_16x16x32_bf16 v[140:143], v[196:199], v[176:179], 0
    s_waitcnt vmcnt(4) lgkmcnt(0)
    s_barrier
    v_mfma_f32_16x16x32_bf16 v[64:67], v[224:227], v[200:203], v[64:67]
    s_add_u32 m0, s3, 0x0
    ds_read_b64_tr_b16 v[184:185], v17 offset:32768
    buffer_load_dwordx4 v13, s[28:31], s65 offen lds
    v_mfma_f32_16x16x32_bf16 v[68:71], v[228:231], v[200:203], v[68:71]
    s_add_u32 m0, s3, 0x400
    ds_read_b64_tr_b16 v[186:187], v17 offset:33280
    buffer_load_dwordx4 v14, s[28:31], s65 offen lds
    s_add_u32 s65, s65, 122880
    s_cmp_ge_u32 s65, 2457600
    s_cselect_b32 s65, 0, s65
    v_mfma_f32_16x16x32_bf16 v[72:75], v[232:235], v[200:203], v[72:75]
    s_add_u32 m0, s3, 0x4000
    ds_read_b64_tr_b16 v[188:189], v18 offset:32768
    buffer_load_dwordx4 v13, s[28:31], s65 offen lds
    v_mfma_f32_16x16x32_bf16 v[76:79], v[236:239], v[200:203], v[76:79]
    s_add_u32 m0, s3, 0x4400
    ds_read_b64_tr_b16 v[190:191], v18 offset:33280
    buffer_load_dwordx4 v14, s[28:31], s65 offen lds
    s_add_u32 s65, s65, 122880
    s_cmp_ge_u32 s65, 2457600
    s_cselect_b32 s65, 0, s65
    v_mfma_f32_16x16x32_bf16 v[80:83], v[224:227], v[204:207], v[80:83]
    s_add_u32 m0, s78, 0x1b000
    ds_read_b64_tr_b16 v[192:193], v19 offset:32768
    buffer_load_dwordx4 v12, s[24:27], s64 offen lds
    s_add_u32 s64, s64, 128
    s_cmp_ge_u32 s64, 1280
    s_cselect_b32 s64, 0, s64
    v_mfma_f32_16x16x32_bf16 v[84:87], v[228:231], v[204:207], v[84:87]
    ds_read_b64_tr_b16 v[194:195], v19 offset:33280
    v_mfma_f32_16x16x32_bf16 v[88:91], v[232:235], v[204:207], v[88:91]
    ds_read_b64_tr_b16 v[196:197], v20 offset:32768
    v_mfma_f32_16x16x32_bf16 v[92:95], v[236:239], v[204:207], v[92:95]
    ds_read_b64_tr_b16 v[198:199], v20 offset:33280
    v_mfma_f32_16x16x32_bf16 v[96:99], v[224:227], v[208:211], v[96:99]
    ds_read_b128 v[160:163], v15 offset:22528
    v_mfma_f32_16x16x32_bf16 v[100:103], v[228:231], v[208:211], v[100:103]
    ds_read_b128 v[164:167], v15 offset:24576
    v_mfma_f32_16x16x32_bf16 v[104:107], v[232:235], v[208:211], v[104:107]
    ds_read_b128 v[168:171], v15 offset:26624
    v_mfma_f32_16x16x32_bf16 v[108:111], v[236:239], v[208:211], v[108:111]
    ds_read_b128 v[172:175], v15 offset:28672
    v_mfma_f32_16x16x32_bf16 v[112:115], v[224:227], v[212:215], v[112:115]
    ds_read_b128 v[176:179], v15 offset:30720
    v_mfma_f32_16x16x32_bf16 v[116:119], v[228:231], v[212:215], v[116:119]
    v_mfma_f32_16x16x32_bf16 v[120:123], v[232:235], v[212:215], v[120:123]
    v_mfma_f32_16x16x32_bf16 v[124:127], v[236:239], v[212:215], v[124:127]
    v_mfma_f32_16x16x32_bf16 v[128:131], v[224:227], v[216:219], v[128:131]
    v_mfma_f32_16x16x32_bf16 v[132:135], v[228:231], v[216:219], v[132:135]
    v_mfma_f32_16x16x32_bf16 v[136:139], v[232:235], v[216:219], v[136:139]
    v_mfma_f32_16x16x32_bf16 v[140:143], v[236:239], v[216:219], v[140:143]
    s_waitcnt vmcnt(0) lgkmcnt(0)
    s_barrier
    v_mfma_f32_16x16x32_bf16 v[64:67], v[184:187], v[160:163], v[64:67]
    s_add_u32 m0, s3, 0x8000
    ds_read_b64_tr_b16 v[224:225], v17 offset:49152
    buffer_load_dwordx4 v13, s[28:31], s65 offen lds
    s_add_u32 m0, s3, 0x8400
    ds_read_b64_tr_b16 v[226:227], v17 offset:49664
    buffer_load_dwordx4 v14, s[28:31], s65 offen lds
    s_add_u32 s65, s65, 122880
    s_cmp_ge_u32 s65, 2457600
    s_cselect_b32 s65, 0, s65
    s_add_u32 m0, s79, 0x10000
    ds_read_b64_tr_b16 v[228:229], v18 offset:49152
    buffer_load_dwordx4 v10, s[24:27], s64 offen lds
    v_mfma_f32_16x16x32_bf16 v[68:71], v[188:191], v[160:163], v[68:71]
    s_add_u32 m0, s79, 0x12000
    ds_read_b64_tr_b16 v[230:231], v18 offset:49664
    buffer_load_dwordx4 v11, s[24:27], s64 offen lds
    s_add_u32 m0, s78, 0x10000
    ds_read_b64_tr_b16 v[232:233], v19 offset:49152
    buffer_load_dwordx4 v12, s[24:27], s64 offen lds
    s_add_u32 s64, s64, 128
    s_cmp_ge_u32 s64, 1280
    s_cselect_b32 s64, 0, s64
    ds_read_b64_tr_b16 v[234:235], v19 offset:49664
    v_mfma_f32_16x16x32_bf16 v[72:75], v[192:195], v[160:163], v[72:75]
    ds_read_b64_tr_b16 v[236:237], v20 offset:49152
    ds_read_b64_tr_b16 v[238:239], v20 offset:49664
    ds_read_b128 v[200:203], v16 offset:22528
    v_mfma_f32_16x16x32_bf16 v[76:79], v[196:199], v[160:163], v[76:79]
    ds_read_b128 v[204:207], v16 offset:24576
    ds_read_b128 v[208:211], v16 offset:26624
    ds_read_b128 v[212:215], v16 offset:28672
    v_mfma_f32_16x16x32_bf16 v[80:83], v[184:187], v[164:167], v[80:83]
    ds_read_b128 v[216:219], v16 offset:30720
    v_mfma_f32_16x16x32_bf16 v[244:247], v[44:47], v[240:243], 0
    v_mfma_f32_16x16x32_bf16 v[244:247], v[48:51], v[240:243], v[244:247]
    v_mfma_f32_16x16x32_bf16 v[84:87], v[188:191], v[164:167], v[84:87]
    v_mfma_f32_16x16x32_bf16 v[244:247], v[52:55], v[240:243], v[244:247]
    v_mfma_f32_16x16x32_bf16 v[244:247], v[56:59], v[240:243], v[244:247]
    v_mfma_f32_16x16x32_bf16 v[244:247], v[60:63], v[240:243], v[244:247]
    v_mfma_f32_16x16x32_bf16 v[88:91], v[192:195], v[164:167], v[88:91]
    v_mov_b32 v252, 0x3f803f80
    v_dot2_f32_bf16 v248, v36, v252, 0
    v_dot2_f32_bf16 v250, v36, v36, 0
    v_mfma_f32_16x16x32_bf16 v[92:95], v[196:199], v[164:167], v[92:95]
    v_dot2_f32_bf16 v249, v37, v252, 0
    v_dot2_f32_bf16 v251, v37, v37, 0
    v_dot2_f32_bf16 v248, v38, v252, v248
    v_mfma_f32_16x16x32_bf16 v[96:99], v[184:187], v[168:171], v[96:99]
    v_dot2_f32_bf16 v250, v38, v38, v250
    v_dot2_f32_bf16 v249, v39, v252, v249
    v_dot2_f32_bf16 v251, v39, v39, v251
    v_mfma_f32_16x16x32_bf16 v[100:103], v[188:191], v[168:171], v[100:103]
    v_dot2_f32_bf16 v248, v40, v252, v248
    v_dot2_f32_bf16 v250, v40, v40, v250
    v_dot2_f32_bf16 v249, v41, v252, v249
    v_mfma_f32_16x16x32_bf16 v[104:107], v[192:195], v[168:171], v[104:107]
    v_dot2_f32_bf16 v251, v41, v41, v251
    v_dot2_f32_bf16 v248, v42, v252, v248
    v_dot2_f32_bf16 v250, v42, v42, v250
    v_mfma_f32_16x16x32_bf16 v[108:111], v[196:199], v[168:171], v[108:111]
    v_dot2_f32_bf16 v249, v43, v252, v249
    v_dot2_f32_bf16 v251, v43, v43, v251
    s_nop 2
    v_mfma_f32_16x16x32_bf16 v[112:115], v[184:187], v[172:175], v[112:115]
    v_add_f32 v248, v248, v249
    v_add_f32 v250, v250, v251
    s_nop 1
    v_mfma_f32_16x16x32_bf16 v[116:119], v[188:191], v[172:175], v[116:119]
    v_add_f32_dpp v248, v248, v248 row_ror:8 row_mask:0xf bank_mask:0xf
    v_add_f32_dpp v250, v250, v250 row_ror:8 row_mask:0xf bank_mask:0xf
    s_nop 1
    v_mfma_f32_16x16x32_bf16 v[120:123], v[192:195], v[172:175], v[120:123]
    v_add_f32_dpp v248, v248, v248 row_ror:4 row_mask:0xf bank_mask:0xf
    v_add_f32_dpp v250, v250, v250 row_ror:4 row_mask:0xf bank_mask:0xf
    s_nop 1
    v_mfma_f32_16x16x32_bf16 v[124:127], v[196:199], v[172:175], v[124:127]
    v_add_f32_dpp v248, v248, v248 row_ror:2 row_mask:0xf bank_mask:0xf
    v_add_f32_dpp v250, v250, v250 row_ror:2 row_mask:0xf bank_mask:0xf
    s_nop 1
    v_mfma_f32_16x16x32_bf16 v[128:131], v[184:187], v[176:179], v[128:131]
    v_add_f32_dpp v248, v248, v248 row_ror:1 row_mask:0xf bank_mask:0xf
    v_add_f32_dpp v250, v250, v250 row_ror:1 row_mask:0xf bank_mask:0xf
    v_mov_b32 v249, v248
    v_mfma_f32_16x16x32_bf16 v[132:135], v[188:191], v[176:179], v[132:135]
    v_mov_b32 v251, v250
    v_mov_b32 v44, v244
    v_mov_b32 v45, v245
    v_mfma_f32_16x16x32_bf16 v[136:139], v[192:195], v[176:179], v[136:139]
    v_mov_b32 v46, v246
    v_mov_b32 v47, v247
    s_nop 1
    v_mfma_f32_16x16x32_bf16 v[140:143], v[196:199], v[176:179], v[140:143]
    v_permlane16_swap_b32 v248, v249
    v_permlane16_swap_b32 v250, v251
    v_permlane16_swap_b32 v244, v44
    s_waitcnt vmcnt(5) lgkmcnt(0)
    s_barrier
    v_mfma_f32_16x16x32_bf16 v[64:67], v[224:227], v[200:203], v[64:67]
    s_add_u32 m0, s3, 0xc000
    ds_read_b64_tr_b16 v[184:185], v17 offset:0
    buffer_load_dwordx4 v13, s[28:31], s65 offen lds
    s_add_u32 m0, s3, 0xc400
    ds_read_b64_tr_b16 v[186:187], v17 offset:512
    buffer_load_dwordx4 v14, s[28:31], s65 offen lds
    s_add_u32 s65, s65, 122880
    s_cmp_ge_u32 s65, 2457600
    s_cselect_b32 s65, 0, s65
    s_add_u32 m0, s79, 0x15800
    ds_read_b64_tr_b16 v[188:189], v18 offset:0
    buffer_load_dwordx4 v10, s[24:27], s64 offen lds
    v_mfma_f32_16x16x32_bf16 v[68:71], v[228:231], v[200:203], v[68:71]
    s_add_u32 m0, s79, 0x17800
    ds_read_b64_tr_b16 v[190:191], v18 offset:512
    buffer_load_dwordx4 v11, s[24:27], s64 offen lds
    ds_read_b64_tr_b16 v[192:193], v19 offset:0
    ds_read_b64_tr_b16 v[194:195], v19 offset:512
    v_mfma_f32_16x16x32_bf16 v[72:75], v[232:235], v[200:203], v[72:75]
    ds_read_b64_tr_b16 v[196:197], v20 offset:0
    ds_read_b64_tr_b16 v[198:199], v20 offset:512
    ds_read_b128 v[160:163], v15 offset:45056
    v_mfma_f32_16x16x32_bf16 v[76:79], v[236:239], v[200:203], v[76:79]
    ds_read_b128 v[164:167], v15 offset:47104
    ds_read_b128 v[168:171], v15 offset:49152
    ds_read_b128 v[172:175], v15 offset:51200
    v_mfma_f32_16x16x32_bf16 v[80:83], v[224:227], v[204:207], v[80:83]
    ds_read_b128 v[176:179], v15 offset:53248
    v_permlane16_swap_b32 v245, v45
    v_permlane16_swap_b32 v246, v46
    v_mfma_f32_16x16x32_bf16 v[84:87], v[228:231], v[204:207], v[84:87]
    v_permlane16_swap_b32 v247, v47
    s_nop 1
    v_add_f32 v248, v248, v249
    v_mfma_f32_16x16x32_bf16 v[88:91], v[232:235], v[204:207], v[88:91]
    v_add_f32 v250, v250, v251
    v_add_f32 v244, v244, v44
    v_add_f32 v245, v245, v45
    v_mfma_f32_16x16x32_bf16 v[92:95], v[236:239], v[204:207], v[92:95]
    v_add_f32 v246, v246, v46
    v_add_f32 v247, v247, v47
    v_mov_b32 v249, v248
    v_mfma_f32_16x16x32_bf16 v[96:99], v[224:227], v[208:211], v[96:99]
    v_mov_b32 v251, v250
    v_mov_b32 v44, v244
    v_mov_b32 v45, v245
    v_mfma_f32_16x16x32_bf16 v[100:103], v[228:231], v[208:211], v[100:103]
    v_mov_b32 v46, v246
    v_mov_b32 v47, v247
    s_nop 1
    v_mfma_f32_16x16x32_bf16 v[104:107], v[232:235], v[208:211], v[104:107]
    v_permlane32_swap_b32 v248, v249
    v_permlane32_swap_b32 v250, v251
    v_permlane32_swap_b32 v244, v44
    v_mfma_f32_16x16x32_bf16 v[108:111], v[236:239], v[208:211], v[108:111]
    v_permlane32_swap_b32 v245, v45
    v_permlane32_swap_b32 v246, v46
    v_permlane32_swap_b32 v247, v47
    v_mfma_f32_16x16x32_bf16 v[112:115], v[224:227], v[212:215], v[112:115]
    s_nop 1
    v_add_f32 v248, v248, v249
    v_add_f32 v250, v250, v251
    v_mfma_f32_16x16x32_bf16 v[116:119], v[228:231], v[212:215], v[116:119]
    v_add_f32 v244, v244, v44
    v_add_f32 v245, v245, v45
    v_add_f32 v246, v246, v46
    v_mfma_f32_16x16x32_bf16 v[120:123], v[232:235], v[212:215], v[120:123]
    v_add_f32 v247, v247, v47
    ds_write_b128 v35, v[244:247]
    v_mul_f32 v248, 0x3acccccd, v248
    v_mfma_f32_16x16x32_bf16 v[124:127], v[236:239], v[212:215], v[124:127]
    v_mul_f32 v250, 0x3acccccd, v250
    v_fma_f32 v250, -v248, v248, v250
    v_max_f32 v250, 0, v250
    v_mfma_f32_16x16x32_bf16 v[128:131], v[224:227], v[216:219], v[128:131]
    v_cvt_pk_bf16_f32 v249, v248, v250
    v_lshlrev_b32 v252, 16, v249
    v_and_b32 v253, 0xffff0000, v249
    v_mfma_f32_16x16x32_bf16 v[132:135], v[228:231], v[216:219], v[132:135]
    v_add_f32 v253, 0x3727c5ac, v253
    v_cvt_pk_bf16_f32 v253, v253, v253
    v_lshlrev_b32 v253, 16, v253
    v_mfma_f32_16x16x32_bf16 v[136:139], v[232:235], v[216:219], v[136:139]
    v_sqrt_f32 v253, v253
    s_nop 0
    v_cvt_pk_bf16_f32 v253, v253, v253
    v_mfma_f32_16x16x32_bf16 v[140:143], v[236:239], v[216:219], v[140:143]
    v_lshlrev_b32 v253, 16, v253
    s_lshl_b32 s66, s56, 3
    s_add_u32 s66, s66, 150016
    v_mov_b32 v248, s66
    ds_write_b64 v248, v[252:253] offset:0
    s_waitcnt vmcnt(9) lgkmcnt(0)
    s_barrier
    v_mfma_f32_16x16x32_bf16 v[64:67], v[184:187], v[160:163], v[64:67]
    s_add_u32 m0, s3, 0x0
    ds_read_b64_tr_b16 v[224:225], v17 offset:16384
    buffer_load_dwordx4 v13, s[28:31], s65 offen lds
    s_add_u32 m0, s3, 0x400
    ds_read_b64_tr_b16 v[226:227], v17 offset:16896
    buffer_load_dwordx4 v14, s[28:31], s65 offen lds
    s_add_u32 s65, s65, 122880
    s_cmp_ge_u32 s65, 2457600
    s_cselect_b32 s65, 0, s65
    v_mfma_f32_16x16x32_bf16 v[68:71], v[188:191], v[160:163], v[68:71]
    s_add_u32 m0, s78, 0x15800
    ds_read_b64_tr_b16 v[228:229], v18 offset:16384
    buffer_load_dwordx4 v12, s[24:27], s64 offen lds
    s_add_u32 s64, s64, 128
    s_cmp_ge_u32 s64, 1280
    s_cselect_b32 s64, 0, s64
    ds_read_b64_tr_b16 v[230:231], v18 offset:16896
    v_mfma_f32_16x16x32_bf16 v[72:75], v[192:195], v[160:163], v[72:75]
    ds_read_b64_tr_b16 v[232:233], v19 offset:16384
    ds_read_b64_tr_b16 v[234:235], v19 offset:16896
    v_mfma_f32_16x16x32_bf16 v[76:79], v[196:199], v[160:163], v[76:79]
    ds_read_b64_tr_b16 v[236:237], v20 offset:16384
    ds_read_b64_tr_b16 v[238:239], v20 offset:16896
    v_mfma_f32_16x16x32_bf16 v[80:83], v[184:187], v[164:167], v[80:83]
    ds_read_b128 v[200:203], v16 offset:45056
    ds_read_b128 v[204:207], v16 offset:47104
    v_mfma_f32_16x16x32_bf16 v[84:87], v[188:191], v[164:167], v[84:87]
    ds_read_b128 v[208:211], v16 offset:49152
    v_mfma_f32_16x16x32_bf16 v[88:91], v[192:195], v[164:167], v[88:91]
    ds_read_b128 v[212:215], v16 offset:51200
    v_mfma_f32_16x16x32_bf16 v[92:95], v[196:199], v[164:167], v[92:95]
    ds_read_b128 v[216:219], v16 offset:53248
    v_mfma_f32_16x16x32_bf16 v[96:99], v[184:187], v[168:171], v[96:99]
    ds_read_b32 v44, v29 offset:0
    v_mfma_f32_16x16x32_bf16 v[100:103], v[188:191], v[168:171], v[100:103]
    ds_read_b32 v45, v29 offset:128
    v_mfma_f32_16x16x32_bf16 v[104:107], v[192:195], v[168:171], v[104:107]
    ds_read_b32 v46, v29 offset:256
    v_mfma_f32_16x16x32_bf16 v[108:111], v[196:199], v[168:171], v[108:111]
    ds_read_b32 v47, v29 offset:384
    v_mfma_f32_16x16x32_bf16 v[112:115], v[184:187], v[172:175], v[112:115]
    ds_read_b32 v48, v29 offset:512
    v_mfma_f32_16x16x32_bf16 v[116:119], v[188:191], v[172:175], v[116:119]
    ds_read_b32 v49, v29 offset:640
    v_mfma_f32_16x16x32_bf16 v[120:123], v[192:195], v[172:175], v[120:123]
    ds_read_b32 v50, v29 offset:768
    v_mfma_f32_16x16x32_bf16 v[124:127], v[196:199], v[172:175], v[124:127]
    ds_read_b32 v51, v29 offset:896
    v_mfma_f32_16x16x32_bf16 v[128:131], v[184:187], v[176:179], v[128:131]
    v_and_b32 v248, 7, v2
    v_mfma_f32_16x16x32_bf16 v[132:135], v[188:191], v[176:179], v[132:135]
    v_lshlrev_b32 v248, 3, v248
    v_mfma_f32_16x16x32_bf16 v[136:139], v[192:195], v[176:179], v[136:139]
    v_add_u32 v248, 150016, v248
    v_mfma_f32_16x16x32_bf16 v[140:143], v[196:199], v[176:179], v[140:143]
    ds_read_b64 v[250:251], v248
    s_waitcnt vmcnt(7) lgkmcnt(0)
    s_barrier
    v_mfma_f32_16x16x32_bf16 v[64:67], v[224:227], v[200:203], v[64:67]
    s_add_u32 m0, s3, 0x4000
    ds_read_b64_tr_b16 v[184:185], v17 offset:32768
    buffer_load_dwordx4 v13, s[28:31], s65 offen lds
    s_add_u32 m0, s3, 0x4400
    ds_read_b64_tr_b16 v[186:187], v17 offset:33280
    buffer_load_dwordx4 v14, s[28:31], s65 offen lds
    s_add_u32 s65, s65, 122880
    s_cmp_ge_u32 s65, 2457600
    s_cselect_b32 s65, 0, s65
    v_mfma_f32_16x16x32_bf16 v[68:71], v[228:231], v[200:203], v[68:71]
    s_add_u32 m0, s79, 0x1b000
    ds_read_b64_tr_b16 v[188:189], v18 offset:32768
    buffer_load_dwordx4 v10, s[24:27], s64 offen lds
    s_add_u32 m0, s79, 0x1d000
    ds_read_b64_tr_b16 v[190:191], v18 offset:33280
    buffer_load_dwordx4 v11, s[24:27], s64 offen lds
    v_mfma_f32_16x16x32_bf16 v[72:75], v[232:235], v[200:203], v[72:75]
    ds_read_b64_tr_b16 v[192:193], v19 offset:32768
    v_mfma_f32_16x16x32_bf16 v[76:79], v[236:239], v[200:203], v[76:79]
    ds_read_b64_tr_b16 v[194:195], v19 offset:33280
    v_mfma_f32_16x16x32_bf16 v[80:83], v[224:227], v[204:207], v[80:83]
    ds_read_b64_tr_b16 v[196:197], v20 offset:32768
    v_mfma_f32_16x16x32_bf16 v[84:87], v[228:231], v[204:207], v[84:87]
    ds_read_b64_tr_b16 v[198:199], v20 offset:33280
    v_mfma_f32_16x16x32_bf16 v[88:91], v[232:235], v[204:207], v[88:91]
    ds_read_b128 v[160:163], v15 offset:0
    v_mfma_f32_16x16x32_bf16 v[92:95], v[236:239], v[204:207], v[92:95]
    ds_read_b128 v[164:167], v15 offset:2048
    v_mfma_f32_16x16x32_bf16 v[96:99], v[224:227], v[208:211], v[96:99]
    ds_read_b128 v[168:171], v15 offset:4096
    v_mfma_f32_16x16x32_bf16 v[100:103], v[228:231], v[208:211], v[100:103]
    ds_read_b128 v[172:175], v15 offset:6144
    v_mfma_f32_16x16x32_bf16 v[104:107], v[232:235], v[208:211], v[104:107]
    ds_read_b128 v[176:179], v15 offset:8192
    v_mfma_f32_16x16x32_bf16 v[108:111], v[236:239], v[208:211], v[108:111]
    v_add_f32 v44, v44, v45
    v_mfma_f32_16x16x32_bf16 v[112:115], v[224:227], v[212:215], v[112:115]
    v_add_f32 v46, v46, v47
    v_mfma_f32_16x16x32_bf16 v[116:119], v[228:231], v[212:215], v[116:119]
    v_add_f32 v48, v48, v49
    v_mfma_f32_16x16x32_bf16 v[120:123], v[232:235], v[212:215], v[120:123]
    v_add_f32 v50, v50, v51
    v_mfma_f32_16x16x32_bf16 v[124:127], v[236:239], v[212:215], v[124:127]
    v_add_f32 v44, v44, v46
    v_mfma_f32_16x16x32_bf16 v[128:131], v[224:227], v[216:219], v[128:131]
    v_add_f32 v48, v48, v50
    v_mfma_f32_16x16x32_bf16 v[132:135], v[228:231], v[216:219], v[132:135]
    v_add_f32 v44, v44, v48
    v_mfma_f32_16x16x32_bf16 v[136:139], v[232:235], v[216:219], v[136:139]
    buffer_store_dword v44, v33, s[36:39], 0 offen sc1
    v_mfma_f32_16x16x32_bf16 v[140:143], v[236:239], v[216:219], v[140:143]
    buffer_store_dwordx2 v[250:251], v32, s[36:39], 0 offen sc1
    s_waitcnt vmcnt(9) lgkmcnt(0)
    s_barrier
    v_mfma_f32_16x16x32_bf16 v[64:67], v[184:187], v[160:163], v[64:67]
    s_add_u32 m0, s3, 0x8000
    ds_read_b64_tr_b16 v[224:225], v17 offset:49152
    buffer_load_dwordx4 v13, s[28:31], s65 offen lds
    v_mfma_f32_16x16x32_bf16 v[68:71], v[188:191], v[160:163], v[68:71]
    s_add_u32 m0, s3, 0x8400
    ds_read_b64_tr_b16 v[226:227], v17 offset:49664
    buffer_load_dwordx4 v14, s[28:31], s65 offen lds
    s_add_u32 s65, s65, 122880
    s_cmp_ge_u32 s65, 2457600
    s_cselect_b32 s65, 0, s65
    v_mfma_f32_16x16x32_bf16 v[72:75], v[192:195], v[160:163], v[72:75]
    s_add_u32 m0, s78, 0x1b000
    ds_read_b64_tr_b16 v[228:229], v18 offset:49152
    buffer_load_dwordx4 v12, s[24:27], s64 offen lds
    s_add_u32 s64, s64, 128
    s_cmp_ge_u32 s64, 1280
    s_cselect_b32 s64, 0, s64
    v_mfma_f32_16x16x32_bf16 v[76:79], v[196:199], v[160:163], v[76:79]
    ds_read_b64_tr_b16 v[230:231], v18 offset:49664
    v_mfma_f32_16x16x32_bf16 v[80:83], v[184:187], v[164:167], v[80:83]
    ds_read_b64_tr_b16 v[232:233], v19 offset:49152
    v_mfma_f32_16x16x32_bf16 v[84:87], v[188:191], v[164:167], v[84:87]
    ds_read_b64_tr_b16 v[234:235], v19 offset:49664
    v_mfma_f32_16x16x32_bf16 v[88:91], v[192:195], v[164:167], v[88:91]
    ds_read_b64_tr_b16 v[236:237], v20 offset:49152
    v_mfma_f32_16x16x32_bf16 v[92:95], v[196:199], v[164:167], v[92:95]
    ds_read_b64_tr_b16 v[238:239], v20 offset:49664
    v_mfma_f32_16x16x32_bf16 v[96:99], v[184:187], v[168:171], v[96:99]
    ds_read_b128 v[200:203], v16 offset:0
    v_mfma_f32_16x16x32_bf16 v[100:103], v[188:191], v[168:171], v[100:103]
    ds_read_b128 v[204:207], v16 offset:2048
    v_mfma_f32_16x16x32_bf16 v[104:107], v[192:195], v[168:171], v[104:107]
    ds_read_b128 v[208:211], v16 offset:4096
    v_mfma_f32_16x16x32_bf16 v[108:111], v[196:199], v[168:171], v[108:111]
    ds_read_b128 v[212:215], v16 offset:6144
    v_mfma_f32_16x16x32_bf16 v[112:115], v[184:187], v[172:175], v[112:115]
    ds_read_b128 v[216:219], v16 offset:8192
    v_mfma_f32_16x16x32_bf16 v[116:119], v[188:191], v[172:175], v[116:119]
    v_mfma_f32_16x16x32_bf16 v[120:123], v[192:195], v[172:175], v[120:123]
    v_mfma_f32_16x16x32_bf16 v[124:127], v[196:199], v[172:175], v[124:127]
    v_mfma_f32_16x16x32_bf16 v[128:131], v[184:187], v[176:179], v[128:131]
    v_mfma_f32_16x16x32_bf16 v[132:135], v[188:191], v[176:179], v[132:135]
    v_mfma_f32_16x16x32_bf16 v[136:139], v[192:195], v[176:179], v[136:139]
    v_mfma_f32_16x16x32_bf16 v[140:143], v[196:199], v[176:179], v[140:143]
    s_waitcnt vmcnt(7) lgkmcnt(0)
    s_barrier
    v_mfma_f32_16x16x32_bf16 v[64:67], v[224:227], v[200:203], v[64:67]
    s_add_u32 m0, s3, 0xc000
    ds_read_b64_tr_b16 v[184:185], v17 offset:0
    buffer_load_dwordx4 v13, s[28:31], s65 offen lds
    v_mfma_f32_16x16x32_bf16 v[68:71], v[228:231], v[200:203], v[68:71]
    s_add_u32 m0, s3, 0xc400
    ds_read_b64_tr_b16 v[186:187], v17 offset:512
    buffer_load_dwordx4 v14, s[28:31], s65 offen lds
    s_add_u32 s65, s65, 122880
    s_cmp_ge_u32 s65, 2457600
    s_cselect_b32 s65, 0, s65
    v_mfma_f32_16x16x32_bf16 v[72:75], v[232:235], v[200:203], v[72:75]
    s_add_u32 m0, s79, 0x10000
    ds_read_b64_tr_b16 v[188:189], v18 offset:0
    buffer_load_dwordx4 v10, s[24:27], s64 offen lds
    v_mfma_f32_16x16x32_bf16 v[76:79], v[236:239], v[200:203], v[76:79]
    s_add_u32 m0, s79, 0x12000
    ds_read_b64_tr_b16 v[190:191], v18 offset:512
    buffer_load_dwordx4 v11, s[24:27], s64 offen lds
    v_mfma_f32_16x16x32_bf16 v[80:83], v[224:227], v[204:207], v[80:83]
    ds_read_b64_tr_b16 v[192:193], v19 offset:0
    v_mfma_f32_16x16x32_bf16 v[84:87], v[228:231], v[204:207], v[84:87]
    ds_read_b64_tr_b16 v[194:195], v19 offset:512
    v_mfma_f32_16x16x32_bf16 v[88:91], v[232:235], v[204:207], v[88:91]
    ds_read_b64_tr_b16 v[196:197], v20 offset:0
    v_mfma_f32_16x16x32_bf16 v[92:95], v[236:239], v[204:207], v[92:95]
    ds_read_b64_tr_b16 v[198:199], v20 offset:512
    v_mfma_f32_16x16x32_bf16 v[96:99], v[224:227], v[208:211], v[96:99]
    ds_read_b128 v[160:163], v15 offset:22528
    v_mfma_f32_16x16x32_bf16 v[100:103], v[228:231], v[208:211], v[100:103]
    ds_read_b128 v[164:167], v15 offset:24576
    v_mfma_f32_16x16x32_bf16 v[104:107], v[232:235], v[208:211], v[104:107]
    ds_read_b128 v[168:171], v15 offset:26624
    v_mfma_f32_16x16x32_bf16 v[108:111], v[236:239], v[208:211], v[108:111]
    ds_read_b128 v[172:175], v15 offset:28672
    v_mfma_f32_16x16x32_bf16 v[112:115], v[224:227], v[212:215], v[112:115]
    ds_read_b128 v[176:179], v15 offset:30720
    v_mfma_f32_16x16x32_bf16 v[116:119], v[228:231], v[212:215], v[116:119]
    v_mfma_f32_16x16x32_bf16 v[120:123], v[232:235], v[212:215], v[120:123]
    v_mfma_f32_16x16x32_bf16 v[124:127], v[236:239], v[212:215], v[124:127]
    v_mfma_f32_16x16x32_bf16 v[128:131], v[224:227], v[216:219], v[128:131]
    v_mfma_f32_16x16x32_bf16 v[132:135], v[228:231], v[216:219], v[132:135]
    v_mfma_f32_16x16x32_bf16 v[136:139], v[232:235], v[216:219], v[136:139]
    v_mfma_f32_16x16x32_bf16 v[140:143], v[236:239], v[216:219], v[140:143]
    s_waitcnt vmcnt(7) lgkmcnt(0)
    s_barrier
    v_mfma_f32_16x16x32_bf16 v[64:67], v[184:187], v[160:163], v[64:67]
    s_add_u32 m0, s3, 0x0
    ds_read_b64_tr_b16 v[224:225], v17 offset:16384
    buffer_load_dwordx4 v13, s[28:31], s65 offen lds
    v_mfma_f32_16x16x32_bf16 v[68:71], v[188:191], v[160:163], v[68:71]
    s_add_u32 m0, s3, 0x400
    ds_read_b64_tr_b16 v[226:227], v17 offset:16896
    buffer_load_dwordx4 v14, s[28:31], s65 offen lds
    s_add_u32 s65, s65, 122880
    s_cmp_ge_u32 s65, 2457600
    s_cselect_b32 s65, 0, s65
    v_mfma_f32_16x16x32_bf16 v[72:75], v[192:195], v[160:163], v[72:75]
    s_add_u32 m0, s78, 0x10000
    ds_read_b64_tr_b16 v[228:229], v18 offset:16384
    buffer_load_dwordx4 v12, s[24:27], s64 offen lds
    s_add_u32 s64, s64, 128
    s_cmp_ge_u32 s64, 1280
    s_cselect_b32 s64, 0, s64
    v_mfma_f32_16x16x32_bf16 v[76:79], v[196:199], v[160:163], v[76:79]
    ds_read_b64_tr_b16 v[230:231], v18 offset:16896
    v_mfma_f32_16x16x32_bf16 v[80:83], v[184:187], v[164:167], v[80:83]
    ds_read_b64_tr_b16 v[232:233], v19 offset:16384
    v_mfma_f32_16x16x32_bf16 v[84:87], v[188:191], v[164:167], v[84:87]
    ds_read_b64_tr_b16 v[234:235], v19 offset:16896
    v_mfma_f32_16x16x32_bf16 v[88:91], v[192:195], v[164:167], v[88:91]
    ds_read_b64_tr_b16 v[236:237], v20 offset:16384
    v_mfma_f32_16x16x32_bf16 v[92:95], v[196:199], v[164:167], v[92:95]
    ds_read_b64_tr_b16 v[238:239], v20 offset:16896
    v_mfma_f32_16x16x32_bf16 v[96:99], v[184:187], v[168:171], v[96:99]
    ds_read_b128 v[200:203], v16 offset:22528
    v_mfma_f32_16x16x32_bf16 v[100:103], v[188:191], v[168:171], v[100:103]
    ds_read_b128 v[204:207], v16 offset:24576
    v_mfma_f32_16x16x32_bf16 v[104:107], v[192:195], v[168:171], v[104:107]
    ds_read_b128 v[208:211], v16 offset:26624
    v_mfma_f32_16x16x32_bf16 v[108:111], v[196:199], v[168:171], v[108:111]
    ds_read_b128 v[212:215], v16 offset:28672
    v_mfma_f32_16x16x32_bf16 v[112:115], v[184:187], v[172:175], v[112:115]
    ds_read_b128 v[216:219], v16 offset:30720
    v_mfma_f32_16x16x32_bf16 v[116:119], v[188:191], v[172:175], v[116:119]
    v_mov_b32 v248, 1
    v_mfma_f32_16x16x32_bf16 v[120:123], v[192:195], v[172:175], v[120:123]
    buffer_atomic_add v248, v34, s[52:55], 0 offen
    v_mfma_f32_16x16x32_bf16 v[124:127], v[196:199], v[172:175], v[124:127]
    v_mfma_f32_16x16x32_bf16 v[128:131], v[184:187], v[176:179], v[128:131]
    v_mfma_f32_16x16x32_bf16 v[132:135], v[188:191], v[176:179], v[132:135]
    v_mfma_f32_16x16x32_bf16 v[136:139], v[192:195], v[176:179], v[136:139]
    v_mfma_f32_16x16x32_bf16 v[140:143], v[196:199], v[176:179], v[140:143]
    s_waitcnt vmcnt(7) lgkmcnt(0)
    s_barrier
    v_mfma_f32_16x16x32_bf16 v[64:67], v[224:227], v[200:203], v[64:67]
    s_add_u32 m0, s3, 0x4000
    ds_read_b64_tr_b16 v[184:185], v17 offset:32768
    buffer_load_dwordx4 v13, s[28:31], s65 offen lds
    v_mfma_f32_16x16x32_bf16 v[68:71], v[228:231], v[200:203], v[68:71]
    s_add_u32 m0, s3, 0x4400
    ds_read_b64_tr_b16 v[186:187], v17 offset:33280
    buffer_load_dwordx4 v14, s[28:31], s65 offen lds
    s_add_u32 s65, s65, 122880
    s_cmp_ge_u32 s65, 2457600
    s_cselect_b32 s65, 0, s65
    v_mfma_f32_16x16x32_bf16 v[72:75], v[232:235], v[200:203], v[72:75]
    s_add_u32 m0, s79, 0x15800
    ds_read_b64_tr_b16 v[188:189], v18 offset:32768
    buffer_load_dwordx4 v10, s[24:27], s64 offen lds
    v_mfma_f32_16x16x32_bf16 v[76:79], v[236:239], v[200:203], v[76:79]
    s_add_u32 m0, s79, 0x17800
    ds_read_b64_tr_b16 v[190:191], v18 offset:33280
    buffer_load_dwordx4 v11, s[24:27], s64 offen lds
    v_mfma_f32_16x16x32_bf16 v[80:83], v[224:227], v[204:207], v[80:83]
    ds_read_b64_tr_b16 v[192:193], v19 offset:32768
    v_mfma_f32_16x16x32_bf16 v[84:87], v[228:231], v[204:207], v[84:87]
    ds_read_b64_tr_b16 v[194:195], v19 offset:33280
    v_mfma_f32_16x16x32_bf16 v[88:91], v[232:235], v[204:207], v[88:91]
    ds_read_b64_tr_b16 v[196:197], v20 offset:32768
    v_mfma_f32_16x16x32_bf16 v[92:95], v[236:239], v[204:207], v[92:95]
    ds_read_b64_tr_b16 v[198:199], v20 offset:33280
    v_mfma_f32_16x16x32_bf16 v[96:99], v[224:227], v[208:211], v[96:99]
    ds_read_b128 v[160:163], v15 offset:45056
    v_mfma_f32_16x16x32_bf16 v[100:103], v[228:231], v[208:211], v[100:103]
    ds_read_b128 v[164:167], v15 offset:47104
    v_mfma_f32_16x16x32_bf16 v[104:107], v[232:235], v[208:211], v[104:107]
    ds_read_b128 v[168:171], v15 offset:49152
    v_mfma_f32_16x16x32_bf16 v[108:111], v[236:239], v[208:211], v[108:111]
    ds_read_b128 v[172:175], v15 offset:51200
    v_mfma_f32_16x16x32_bf16 v[112:115], v[224:227], v[212:215], v[112:115]
    ds_read_b128 v[176:179], v15 offset:53248
    v_mfma_f32_16x16x32_bf16 v[116:119], v[228:231], v[212:215], v[116:119]
    s_lshl_b32 s66, s2, 3
    s_add_u32 s66, s66, s56
    s_lshl_b32 s66, s66, 10
    buffer_load_dwordx4 v[252:255], v3, s[44:47], s66 offen
    buffer_load_dwordx4 v[252:255], v3, s[48:51], s66 offen
    s_add_u32 s66, s66, 0x200000
    buffer_load_dwordx4 v[252:255], v3, s[44:47], s66 offen
    v_mfma_f32_16x16x32_bf16 v[120:123], v[232:235], v[212:215], v[120:123]
    v_mfma_f32_16x16x32_bf16 v[124:127], v[236:239], v[212:215], v[124:127]
    v_mfma_f32_16x16x32_bf16 v[128:131], v[224:227], v[216:219], v[128:131]
    v_mfma_f32_16x16x32_bf16 v[132:135], v[228:231], v[216:219], v[132:135]
    v_mfma_f32_16x16x32_bf16 v[136:139], v[232:235], v[216:219], v[136:139]
    v_mfma_f32_16x16x32_bf16 v[140:143], v[236:239], v[216:219], v[140:143]
    s_waitcnt vmcnt(9) lgkmcnt(0)
    s_barrier
    v_mfma_f32_16x16x32_bf16 v[64:67], v[184:187], v[160:163], v[64:67]
    s_add_u32 m0, s3, 0x8000
    ds_read_b64_tr_b16 v[224:225], v17 offset:49152
    buffer_load_dwordx4 v13, s[28:31], s65 offen lds
    v_mfma_f32_16x16x32_bf16 v[68:71], v[188:191], v[160:163], v[68:71]
    s_add_u32 m0, s3, 0x8400
    ds_read_b64_tr_b16 v[226:227], v17 offset:49664
    buffer_load_dwordx4 v14, s[28:31], s65 offen lds
    s_add_u32 s65, s65, 122880
    s_cmp_ge_u32 s65, 2457600
    s_cselect_b32 s65, 0, s65
    v_mfma_f32_16x16x32_bf16 v[72:75], v[192:195], v[160:163], v[72:75]
    s_add_u32 m0, s78, 0x15800
    ds_read_b64_tr_b16 v[228:229], v18 offset:49152
    buffer_load_dwordx4 v12, s[24:27], s64 offen lds
    s_add_u32 s64, s64, 128
    s_cmp_ge_u32 s64, 1280
    s_cselect_b32 s64, 0, s64
    v_mfma_f32_16x16x32_bf16 v[76:79], v[196:199], v[160:163], v[76:79]
    ds_read_b64_tr_b16 v[230:231], v18 offset:49664
    v_mfma_f32_16x16x32_bf16 v[80:83], v[184:187], v[164:167], v[80:83]
    ds_read_b64_tr_b16 v[232:233], v19 offset:49152
    v_mfma_f32_16x16x32_bf16 v[84:87], v[188:191], v[164:167], v[84:87]
    ds_read_b64_tr_b16 v[234:235], v19 offset:49664
    v_mfma_f32_16x16x32_bf16 v[88:91], v[192:195], v[164:167], v[88:91]
    ds_read_b64_tr_b16 v[236:237], v20 offset:49152
    v_mfma_f32_16x16x32_bf16 v[92:95], v[196:199], v[164:167], v[92:95]
    ds_read_b64_tr_b16 v[238:239], v20 offset:49664
    v_mfma_f32_16x16x32_bf16 v[96:99], v[184:187], v[168:171], v[96:99]
    ds_read_b128 v[200:203], v16 offset:45056
    v_mfma_f32_16x16x32_bf16 v[100:103], v[188:191], v[168:171], v[100:103]
    ds_read_b128 v[204:207], v16 offset:47104
    v_mfma_f32_16x16x32_bf16 v[104:107], v[192:195], v[168:171], v[104:107]
    ds_read_b128 v[208:211], v16 offset:49152
    v_mfma_f32_16x16x32_bf16 v[108:111], v[196:199], v[168:171], v[108:111]
    ds_read_b128 v[212:215], v16 offset:51200
    v_mfma_f32_16x16x32_bf16 v[112:115], v[184:187], v[172:175], v[112:115]
    ds_read_b128 v[216:219], v16 offset:53248
    v_mfma_f32_16x16x32_bf16 v[116:119], v[188:191], v[172:175], v[116:119]
    v_mfma_f32_16x16x32_bf16 v[120:123], v[192:195], v[172:175], v[120:123]
    v_mfma_f32_16x16x32_bf16 v[124:127], v[196:199], v[172:175], v[124:127]
    v_mfma_f32_16x16x32_bf16 v[128:131], v[184:187], v[176:179], v[128:131]
    v_mfma_f32_16x16x32_bf16 v[132:135], v[188:191], v[176:179], v[132:135]
    v_mfma_f32_16x16x32_bf16 v[136:139], v[192:195], v[176:179], v[136:139]
    v_mfma_f32_16x16x32_bf16 v[140:143], v[196:199], v[176:179], v[140:143]
    s_waitcnt vmcnt(7) lgkmcnt(0)
    s_barrier
    v_mfma_f32_16x16x32_bf16 v[64:67], v[224:227], v[200:203], v[64:67]
    s_add_u32 m0, s3, 0xc000
    ds_read_b64_tr_b16 v[184:185], v17 offset:0
    buffer_load_dwordx4 v13, s[28:31], s65 offen lds
    v_mfma_f32_16x16x32_bf16 v[68:71], v[228:231], v[200:203], v[68:71]
    s_add_u32 m0, s3, 0xc400
    ds_read_b64_tr_b16 v[186:187], v17 offset:512
    buffer_load_dwordx4 v14, s[28:31], s65 offen lds
    s_add_u32 s65, s65, 122880
    s_cmp_ge_u32 s65, 2457600
    s_cselect_b32 s65, 0, s65
    v_mfma_f32_16x16x32_bf16 v[72:75], v[232:235], v[200:203], v[72:75]
    s_add_u32 m0, s79, 0x1b000
    ds_read_b64_tr_b16 v[188:189], v18 offset:0
    buffer_load_dwordx4 v10, s[24:27], s64 offen lds
    v_mfma_f32_16x16x32_bf16 v[76:79], v[236:239], v[200:203], v[76:79]
    s_add_u32 m0, s79, 0x1d000
    ds_read_b64_tr_b16 v[190:191], v18 offset:512
    buffer_load_dwordx4 v11, s[24:27], s64 offen lds
    v_mfma_f32_16x16x32_bf16 v[80:83], v[224:227], v[204:207], v[80:83]
    ds_read_b64_tr_b16 v[192:193], v19 offset:0
    v_mfma_f32_16x16x32_bf16 v[84:87], v[228:231], v[204:207], v[84:87]
    ds_read_b64_tr_b16 v[194:195], v19 offset:512
    v_mfma_f32_16x16x32_bf16 v[88:91], v[232:235], v[204:207], v[88:91]
    ds_read_b64_tr_b16 v[196:197], v20 offset:0
    v_mfma_f32_16x16x32_bf16 v[92:95], v[236:239], v[204:207], v[92:95]
    ds_read_b64_tr_b16 v[198:199], v20 offset:512
    v_mfma_f32_16x16x32_bf16 v[96:99], v[224:227], v[208:211], v[96:99]
    ds_read_b128 v[160:163], v15 offset:0
    v_mfma_f32_16x16x32_bf16 v[100:103], v[228:231], v[208:211], v[100:103]
    ds_read_b128 v[164:167], v15 offset:2048
    v_mfma_f32_16x16x32_bf16 v[104:107], v[232:235], v[208:211], v[104:107]
    ds_read_b128 v[168:171], v15 offset:4096
    v_mfma_f32_16x16x32_bf16 v[108:111], v[236:239], v[208:211], v[108:111]
    ds_read_b128 v[172:175], v15 offset:6144
    v_mfma_f32_16x16x32_bf16 v[112:115], v[224:227], v[212:215], v[112:115]
    ds_read_b128 v[176:179], v15 offset:8192
    v_mfma_f32_16x16x32_bf16 v[116:119], v[228:231], v[212:215], v[116:119]
    v_mfma_f32_16x16x32_bf16 v[120:123], v[232:235], v[212:215], v[120:123]
    v_mfma_f32_16x16x32_bf16 v[124:127], v[236:239], v[212:215], v[124:127]
    v_mfma_f32_16x16x32_bf16 v[128:131], v[224:227], v[216:219], v[128:131]
    v_mfma_f32_16x16x32_bf16 v[132:135], v[228:231], v[216:219], v[132:135]
    v_mfma_f32_16x16x32_bf16 v[136:139], v[232:235], v[216:219], v[136:139]
    v_mfma_f32_16x16x32_bf16 v[140:143], v[236:239], v[216:219], v[140:143]
    s_waitcnt vmcnt(9) lgkmcnt(0)
    s_barrier
    v_mfma_f32_16x16x32_bf16 v[64:67], v[184:187], v[160:163], v[64:67]
    s_add_u32 m0, s3, 0x0
    ds_read_b64_tr_b16 v[224:225], v17 offset:16384
    buffer_load_dwordx4 v13, s[28:31], s65 offen lds
    s_add_u32 m0, s3, 0x400
    ds_read_b64_tr_b16 v[226:227], v17 offset:16896
    buffer_load_dwordx4 v14, s[28:31], s65 offen lds
    s_add_u32 s65, s65, 122880
    s_cmp_ge_u32 s65, 2457600
    s_cselect_b32 s65, 0, s65
    s_add_u32 m0, s78, 0x1b000
    ds_read_b64_tr_b16 v[228:229], v18 offset:16384
    buffer_load_dwordx4 v12, s[24:27], s64 offen lds
    s_add_u32 s64, s64, 128
    s_cmp_ge_u32 s64, 1280
    s_cselect_b32 s64, 0, s64
    v_mfma_f32_16x16x32_bf16 v[68:71], v[188:191], v[160:163], v[68:71]
    ds_read_b64_tr_b16 v[230:231], v18 offset:16896
    ds_read_b64_tr_b16 v[232:233], v19 offset:16384
    ds_read_b64_tr_b16 v[234:235], v19 offset:16896
    v_mfma_f32_16x16x32_bf16 v[72:75], v[192:195], v[160:163], v[72:75]
    ds_read_b64_tr_b16 v[236:237], v20 offset:16384
    ds_read_b64_tr_b16 v[238:239], v20 offset:16896
    ds_read_b128 v[200:203], v16 offset:0
    v_mfma_f32_16x16x32_bf16 v[76:79], v[196:199], v[160:163], v[76:79]
    ds_read_b128 v[204:207], v16 offset:2048
    ds_read_b128 v[208:211], v16 offset:4096
    ds_read_b128 v[212:215], v16 offset:6144
    v_mfma_f32_16x16x32_bf16 v[80:83], v[184:187], v[164:167], v[80:83]
    ds_read_b128 v[216:219], v16 offset:8192
    v_lshlrev_b32 v6, 4, v4
    s_mul_i32 s66, s59, 96
    v_mfma_f32_16x16x32_bf16 v[84:87], v[188:191], v[164:167], v[84:87]
    s_mul_i32 s67, s62, 160
    s_add_u32 s66, s66, s67
    s_sub_u32 s66, s66, 16
    v_mfma_f32_16x16x32_bf16 v[88:91], v[192:195], v[164:167], v[88:91]
    s_lshl_b32 s66, s66, 4
    v_and_b32 v63, 7, v2
    v_lshl_add_u32 v63, v63, 3, s66
    v_mfma_f32_16x16x32_bf16 v[92:95], v[196:199], v[164:167], v[92:95]
    v_bfe_u32 v7, v2, 3, 1
    v_lshl_add_u32 v63, v7, 7, v63
    v_readlane_b32 s67, v25, 0
    s_nop 1
    v_add_u32 v52, s67, v6
    v_mfma_f32_16x16x32_bf16 v[96:99], v[184:187], v[168:171], v[96:99]
    v_readlane_b32 s67, v25, 1
    s_nop 1
    v_add_u32 v53, s67, v6
    v_readlane_b32 s67, v25, 2
    s_nop 1
    v_add_u32 v54, s67, v6
    v_readlane_b32 s67, v25, 3
    s_nop 1
    v_add_u32 v55, s67, v6
    v_mfma_f32_16x16x32_bf16 v[100:103], v[188:191], v[168:171], v[100:103]
    v_and_b32 v1, 15, v2
    s_mul_i32 s66, s59, 13440
    s_mul_i32 s67, s60, 40
    v_mfma_f32_16x16x32_bf16 v[104:107], v[192:195], v[168:171], v[104:107]
    s_add_u32 s66, s66, s67
    v_mul_u32_u24 v5, 168, v1
    v_add_u32 v5, s66, v5
    v_mfma_f32_16x16x32_bf16 v[108:111], v[196:199], v[168:171], v[108:111]
    v_lshlrev_b32 v6, 4, v26
    v_cmp_gt_u32 s[76:77], 3, v26
    v_mfma_f32_16x16x32_bf16 v[112:115], v[184:187], v[172:175], v[112:115]
    v_cmp_gt_u32 s[74:75], 2, v26
    s_nop 1
    v_mfma_f32_16x16x32_bf16 v[116:119], v[188:191], v[172:175], v[116:119]
    v_cndmask_b32 v6, 0, v6, s[76:77]
    v_add_u32 v56, v5, v6
    v_mfma_f32_16x16x32_bf16 v[120:123], v[192:195], v[172:175], v[120:123]
    v_add_u32 v58, 67200, v56
    v_min_u32 v57, 191, v0
    v_mfma_f32_16x16x32_bf16 v[124:127], v[196:199], v[172:175], v[124:127]
    v_mul_u32_u24 v57, 168, v57
    v_add_u32 v57, 160, v57
    v_mfma_f32_16x16x32_bf16 v[128:131], v[184:187], v[176:179], v[128:131]
    v_lshrrev_b32 v60, 2, v2
    v_mul_u32_u24 v60, 168, v60
    v_mfma_f32_16x16x32_bf16 v[132:135], v[188:191], v[176:179], v[132:135]
    v_and_b32 v6, 3, v2
    v_lshl_add_u32 v60, v6, 3, v60
    v_mfma_f32_16x16x32_bf16 v[136:139], v[192:195], v[176:179], v[136:139]
    s_add_u32 s66, s66, 32256
    v_add_u32 v60, s66, v60
    v_mfma_f32_16x16x32_bf16 v[140:143], v[196:199], v[176:179], v[140:143]
    s_mul_i32 s66, s60, 5
    s_mul_i32 s67, s59, 12800
    s_waitcnt vmcnt(7) lgkmcnt(0)
    s_barrier
    v_mfma_f32_16x16x32_bf16 v[64:67], v[224:227], v[200:203], v[64:67]
    s_add_u32 m0, s3, 0x4000
    ds_read_b64_tr_b16 v[184:185], v17 offset:32768
    buffer_load_dwordx4 v13, s[28:31], s65 offen lds
    s_add_u32 m0, s3, 0x4400
    ds_read_b64_tr_b16 v[186:187], v17 offset:33280
    buffer_load_dwordx4 v14, s[28:31], s65 offen lds
    s_add_u32 s65, s65, 122880
    s_cmp_ge_u32 s65, 2457600
    s_cselect_b32 s65, 0, s65
    s_add_u32 m0, s79, 0x10000
    ds_read_b64_tr_b16 v[188:189], v18 offset:32768
    buffer_load_dwordx4 v10, s[24:27], s64 offen lds
    v_mfma_f32_16x16x32_bf16 v[68:71], v[228:231], v[200:203], v[68:71]
    s_add_u32 m0, s79, 0x12000
    ds_read_b64_tr_b16 v[190:191], v18 offset:33280
    buffer_load_dwordx4 v11, s[24:27], s64 offen lds
    ds_read_b64_tr_b16 v[192:193], v19 offset:32768
    ds_read_b64_tr_b16 v[194:195], v19 offset:33280
    v_mfma_f32_16x16x32_bf16 v[72:75], v[232:235], v[200:203], v[72:75]
    ds_read_b64_tr_b16 v[196:197], v20 offset:32768
    ds_read_b64_tr_b16 v[198:199], v20 offset:33280
    ds_read_b128 v[160:163], v15 offset:22528
    v_mfma_f32_16x16x32_bf16 v[76:79], v[236:239], v[200:203], v[76:79]
    ds_read_b128 v[164:167], v15 offset:24576
    ds_read_b128 v[168:171], v15 offset:26624
    ds_read_b128 v[172:175], v15 offset:28672
    v_mfma_f32_16x16x32_bf16 v[80:83], v[224:227], v[204:207], v[80:83]
    ds_read_b128 v[176:179], v15 offset:30720
    s_add_u32 s67, s67, 122880
    v_add_u32 v6, s66, v26
    v_mfma_f32_16x16x32_bf16 v[84:87], v[228:231], v[204:207], v[84:87]
    v_lshrrev_b32 v7, 1, v6
    v_lshlrev_b32 v7, 8, v7
    v_and_b32 v6, 1, v6
    v_mfma_f32_16x16x32_bf16 v[88:91], v[232:235], v[204:207], v[88:91]
    v_lshl_add_u32 v7, v6, 3, v7
    v_lshl_add_u32 v7, v1, 4, v7
    v_add_u32 v61, s67, v7
    v_mfma_f32_16x16x32_bf16 v[92:95], v[236:239], v[204:207], v[92:95]
    v_add_u32 v6, s66, v26
    v_add_u32 v6, 4, v6
    v_lshrrev_b32 v7, 1, v6
    v_mfma_f32_16x16x32_bf16 v[96:99], v[224:227], v[208:211], v[96:99]
    v_lshlrev_b32 v7, 8, v7
    v_and_b32 v6, 1, v6
    v_lshl_add_u32 v7, v6, 3, v7
    v_mfma_f32_16x16x32_bf16 v[100:103], v[228:231], v[208:211], v[100:103]
    v_lshl_add_u32 v7, v1, 4, v7
    v_add_u32 v62, s67, v7
    v_cmp_gt_u32 vcc, 16, v2
    v_mfma_f32_16x16x32_bf16 v[104:107], v[232:235], v[208:211], v[104:107]
    v_mov_b32 v6, 83840
    s_nop 1
    v_cndmask_b32 v62, v6, v62, vcc
    v_mfma_f32_16x16x32_bf16 v[108:111], v[236:239], v[208:211], v[108:111]
    v_mov_b32 v6, 0x40000000
    s_mov_b32 s67, 26215
    v_mfma_f32_16x16x32_bf16 v[112:115], v[224:227], v[212:215], v[112:115]
    s_mov_b32 s68, 74240
    s_lshl_b32 s66, s56, 10
    v_mfma_f32_16x16x32_bf16 v[116:119], v[228:231], v[212:215], v[116:119]
    s_add_u32 s66, s66, 0
    v_add_u32 v7, s66, v3
    v_mfma_f32_16x16x32_bf16 v[120:123], v[232:235], v[212:215], v[120:123]
    v_mul_lo_u32 v5, v7, s67
    v_lshrrev_b32 v5, 26, v5
    v_mfma_f32_16x16x32_bf16 v[124:127], v[236:239], v[212:215], v[124:127]
    v_mul_lo_u32 v5, v5, s68
    v_cmp_gt_u32 vcc, 25600, v7
    v_mfma_f32_16x16x32_bf16 v[128:131], v[224:227], v[216:219], v[128:131]
    v_add_u32 v5, v5, v7
    s_nop 0
    v_mfma_f32_16x16x32_bf16 v[132:135], v[228:231], v[216:219], v[132:135]
    v_cndmask_b32 v48, v6, v5, vcc
    s_lshl_b32 s66, s56, 10
    v_mfma_f32_16x16x32_bf16 v[136:139], v[232:235], v[216:219], v[136:139]
    s_add_u32 s66, s66, 8192
    v_add_u32 v7, s66, v3
    v_mfma_f32_16x16x32_bf16 v[140:143], v[236:239], v[216:219], v[140:143]
    v_mul_lo_u32 v5, v7, s67
    v_lshrrev_b32 v5, 26, v5
    s_waitcnt vmcnt(9) lgkmcnt(0)
    s_barrier
    v_mfma_f32_16x16x32_bf16 v[64:67], v[184:187], v[160:163], v[64:67]
    s_add_u32 m0, s3, 0x8000
    ds_read_b64_tr_b16 v[224:225], v17 offset:49152
    buffer_load_dwordx4 v13, s[28:31], s65 offen lds
    s_add_u32 m0, s3, 0x8400
    ds_read_b64_tr_b16 v[226:227], v17 offset:49664
    buffer_load_dwordx4 v14, s[28:31], s65 offen lds
    s_add_u32 s65, s65, 122880
    s_cmp_ge_u32 s65, 2457600
    s_cselect_b32 s65, 0, s65
    s_add_u32 m0, s78, 0x10000
    ds_read_b64_tr_b16 v[228:229], v18 offset:49152
    buffer_load_dwordx4 v12, s[24:27], s64 offen lds
    s_add_u32 s64, s64, 128
    s_cmp_ge_u32 s64, 1280
    s_cselect_b32 s64, 0, s64
    v_mfma_f32_16x16x32_bf16 v[68:71], v[188:191], v[160:163], v[68:71]
    ds_read_b64_tr_b16 v[230:231], v18 offset:49664
    ds_read_b64_tr_b16 v[232:233], v19 offset:49152
    ds_read_b64_tr_b16 v[234:235], v19 offset:49664
    v_mfma_f32_16x16x32_bf16 v[72:75], v[192:195], v[160:163], v[72:75]
    ds_read_b64_tr_b16 v[236:237], v20 offset:49152
    ds_read_b64_tr_b16 v[238:239], v20 offset:49664
    ds_read_b128 v[200:203], v16 offset:22528
    v_mfma_f32_16x16x32_bf16 v[76:79], v[196:199], v[160:163], v[76:79]
    ds_read_b128 v[204:207], v16 offset:24576
    ds_read_b128 v[208:211], v16 offset:26624
    ds_read_b128 v[212:215], v16 offset:28672
    v_mfma_f32_16x16x32_bf16 v[80:83], v[184:187], v[164:167], v[80:83]
    ds_read_b128 v[216:219], v16 offset:30720
    v_mul_lo_u32 v5, v5, s68
    v_cmp_gt_u32 vcc, 25600, v7
    v_mfma_f32_16x16x32_bf16 v[84:87], v[188:191], v[164:167], v[84:87]
    v_add_u32 v5, v5, v7
    s_nop 0
    v_cndmask_b32 v49, v6, v5, vcc
    v_mfma_f32_16x16x32_bf16 v[88:91], v[192:195], v[164:167], v[88:91]
    s_lshl_b32 s66, s56, 10
    s_add_u32 s66, s66, 16384
    v_add_u32 v7, s66, v3
    v_mfma_f32_16x16x32_bf16 v[92:95], v[196:199], v[164:167], v[92:95]
    v_mul_lo_u32 v5, v7, s67
    v_lshrrev_b32 v5, 26, v5
    v_mul_lo_u32 v5, v5, s68
    v_mfma_f32_16x16x32_bf16 v[96:99], v[184:187], v[168:171], v[96:99]
    v_cmp_gt_u32 vcc, 25600, v7
    v_add_u32 v5, v5, v7
    s_nop 0
    v_mfma_f32_16x16x32_bf16 v[100:103], v[188:191], v[168:171], v[100:103]
    v_cndmask_b32 v50, v6, v5, vcc
    s_lshl_b32 s66, s56, 10
    v_mfma_f32_16x16x32_bf16 v[104:107], v[192:195], v[168:171], v[104:107]
    s_add_u32 s66, s66, 24576
    v_add_u32 v7, s66, v3
    v_mfma_f32_16x16x32_bf16 v[108:111], v[196:199], v[168:171], v[108:111]
    v_mul_lo_u32 v5, v7, s67
    v_lshrrev_b32 v5, 26, v5
    v_mfma_f32_16x16x32_bf16 v[112:115], v[184:187], v[172:175], v[112:115]
    v_mul_lo_u32 v5, v5, s68
    v_cmp_gt_u32 vcc, 25600, v7
    v_mfma_f32_16x16x32_bf16 v[116:119], v[188:191], v[172:175], v[116:119]
    v_add_u32 v5, v5, v7
    s_nop 0
    v_mfma_f32_16x16x32_bf16 v[120:123], v[192:195], v[172:175], v[120:123]
    v_cndmask_b32 v51, v6, v5, vcc
    v_cmp_gt_u32 vcc, 20, v2
    v_mfma_f32_16x16x32_bf16 v[124:127], v[196:199], v[172:175], v[124:127]
    s_nop 1
    v_cndmask_b32 v27, v6, v3, vcc
    v_mfma_f32_16x16x32_bf16 v[128:131], v[184:187], v[176:179], v[128:131]
    s_mul_i32 s69, s62, 768000
    s_mul_i32 s67, s57, 2560
    v_mfma_f32_16x16x32_bf16 v[132:135], v[188:191], v[176:179], v[132:135]
    s_add_u32 s69, s69, s67
    s_mul_i32 s70, s57, 320
    v_mfma_f32_16x16x32_bf16 v[136:139], v[192:195], v[176:179], v[136:139]
    s_add_u32 s70, s70, 32768
    s_add_u32 s71, s70, 2560
    v_mfma_f32_16x16x32_bf16 v[140:143], v[196:199], v[176:179], v[140:143]
    s_add_u32 s72, s70, 5120
    v_mov_b32 v249, 240
    s_waitcnt vmcnt(7) lgkmcnt(0)
    s_barrier
    v_mfma_f32_16x16x32_bf16 v[64:67], v[224:227], v[200:203], v[64:67]
    s_add_u32 m0, s3, 0xc000
    ds_read_b64_tr_b16 v[184:185], v17 offset:0
    buffer_load_dwordx4 v13, s[28:31], s65 offen lds
    v_mfma_f32_16x16x32_bf16 v[68:71], v[228:231], v[200:203], v[68:71]
    s_add_u32 m0, s3, 0xc400
    ds_read_b64_tr_b16 v[186:187], v17 offset:512
    buffer_load_dwordx4 v14, s[28:31], s65 offen lds
    s_add_u32 s65, s65, 122880
    s_cmp_ge_u32 s65, 2457600
    s_cselect_b32 s65, 0, s65
    v_mfma_f32_16x16x32_bf16 v[72:75], v[232:235], v[200:203], v[72:75]
    ds_read_b64_tr_b16 v[188:189], v18 offset:0
    v_mfma_f32_16x16x32_bf16 v[76:79], v[236:239], v[200:203], v[76:79]
    ds_read_b64_tr_b16 v[190:191], v18 offset:512
    v_mfma_f32_16x16x32_bf16 v[80:83], v[224:227], v[204:207], v[80:83]
    ds_read_b64_tr_b16 v[192:193], v19 offset:0
    v_mfma_f32_16x16x32_bf16 v[84:87], v[228:231], v[204:207], v[84:87]
    ds_read_b64_tr_b16 v[194:195], v19 offset:512
    v_mfma_f32_16x16x32_bf16 v[88:91], v[232:235], v[204:207], v[88:91]
    ds_read_b64_tr_b16 v[196:197], v20 offset:0
    v_mfma_f32_16x16x32_bf16 v[92:95], v[236:239], v[204:207], v[92:95]
    ds_read_b64_tr_b16 v[198:199], v20 offset:512
    v_mfma_f32_16x16x32_bf16 v[96:99], v[224:227], v[208:211], v[96:99]
    ds_read_b128 v[160:163], v15 offset:45056
    v_mfma_f32_16x16x32_bf16 v[100:103], v[228:231], v[208:211], v[100:103]
    ds_read_b128 v[164:167], v15 offset:47104
    v_mfma_f32_16x16x32_bf16 v[104:107], v[232:235], v[208:211], v[104:107]
    ds_read_b128 v[168:171], v15 offset:49152
    v_mfma_f32_16x16x32_bf16 v[108:111], v[236:239], v[208:211], v[108:111]
    ds_read_b128 v[172:175], v15 offset:51200
    v_mfma_f32_16x16x32_bf16 v[112:115], v[224:227], v[212:215], v[112:115]
    ds_read_b128 v[176:179], v15 offset:53248
    v_mfma_f32_16x16x32_bf16 v[116:119], v[228:231], v[212:215], v[116:119]
    buffer_load_dword v248, v249, s[52:55], 0 offen sc1
    v_mfma_f32_16x16x32_bf16 v[120:123], v[232:235], v[212:215], v[120:123]
    v_mfma_f32_16x16x32_bf16 v[124:127], v[236:239], v[212:215], v[124:127]
    v_mfma_f32_16x16x32_bf16 v[128:131], v[224:227], v[216:219], v[128:131]
    v_mfma_f32_16x16x32_bf16 v[132:135], v[228:231], v[216:219], v[132:135]
    v_mfma_f32_16x16x32_bf16 v[136:139], v[232:235], v[216:219], v[136:139]
    v_mfma_f32_16x16x32_bf16 v[140:143], v[236:239], v[216:219], v[140:143]
    s_waitcnt vmcnt(7) lgkmcnt(0)
    s_barrier
    v_mfma_f32_16x16x32_bf16 v[64:67], v[184:187], v[160:163], v[64:67]
    ds_read_b64_tr_b16 v[224:225], v17 offset:16384
    v_mfma_f32_16x16x32_bf16 v[68:71], v[188:191], v[160:163], v[68:71]
    ds_read_b64_tr_b16 v[226:227], v17 offset:16896
    v_mfma_f32_16x16x32_bf16 v[72:75], v[192:195], v[160:163], v[72:75]
    ds_read_b64_tr_b16 v[228:229], v18 offset:16384
    v_mfma_f32_16x16x32_bf16 v[76:79], v[196:199], v[160:163], v[76:79]
    ds_read_b64_tr_b16 v[230:231], v18 offset:16896
    v_mfma_f32_16x16x32_bf16 v[80:83], v[184:187], v[164:167], v[80:83]
    ds_read_b64_tr_b16 v[232:233], v19 offset:16384
    v_mfma_f32_16x16x32_bf16 v[84:87], v[188:191], v[164:167], v[84:87]
    ds_read_b64_tr_b16 v[234:235], v19 offset:16896
    v_mfma_f32_16x16x32_bf16 v[88:91], v[192:195], v[164:167], v[88:91]
    ds_read_b64_tr_b16 v[236:237], v20 offset:16384
    v_mfma_f32_16x16x32_bf16 v[92:95], v[196:199], v[164:167], v[92:95]
    ds_read_b64_tr_b16 v[238:239], v20 offset:16896
    v_mfma_f32_16x16x32_bf16 v[96:99], v[184:187], v[168:171], v[96:99]
    ds_read_b128 v[200:203], v16 offset:45056
    v_mfma_f32_16x16x32_bf16 v[100:103], v[188:191], v[168:171], v[100:103]
    ds_read_b128 v[204:207], v16 offset:47104
    v_mfma_f32_16x16x32_bf16 v[104:107], v[192:195], v[168:171], v[104:107]
    ds_read_b128 v[208:211], v16 offset:49152
    v_mfma_f32_16x16x32_bf16 v[108:111], v[196:199], v[168:171], v[108:111]
    ds_read_b128 v[212:215], v16 offset:51200
    v_mfma_f32_16x16x32_bf16 v[112:115], v[184:187], v[172:175], v[112:115]
    ds_read_b128 v[216:219], v16 offset:53248
    v_mfma_f32_16x16x32_bf16 v[116:119], v[188:191], v[172:175], v[116:119]
    v_mfma_f32_16x16x32_bf16 v[120:123], v[192:195], v[172:175], v[120:123]
    v_mfma_f32_16x16x32_bf16 v[124:127], v[196:199], v[172:175], v[124:127]
    v_mfma_f32_16x16x32_bf16 v[128:131], v[184:187], v[176:179], v[128:131]
    v_mfma_f32_16x16x32_bf16 v[132:135], v[188:191], v[176:179], v[132:135]
    v_mfma_f32_16x16x32_bf16 v[136:139], v[192:195], v[176:179], v[136:139]
    v_mfma_f32_16x16x32_bf16 v[140:143], v[196:199], v[176:179], v[140:143]
    s_waitcnt vmcnt(0) lgkmcnt(0)
    s_mov_b32 s66, 0
L_poll_att1:
    v_readfirstlane_b32 s67, v248
    s_add_u32 s66, s66, 1
    s_cmp_ge_u32 s67, 256
    s_cbranch_scc1 L_pollok_att1
    s_cmp_ge_u32 s66, 0x40000
    s_cbranch_scc1 L_pollok_att1
    s_sleep 2
    buffer_load_dword v248, v249, s[52:55], 0 offen sc1
    s_waitcnt vmcnt(0)
    s_branch L_poll_att1
L_pollok_att1:
    s_barrier
    v_mfma_f32_16x16x32_bf16 v[64:67], v[224:227], v[200:203], v[64:67]
    ds_read_b64_tr_b16 v[184:185], v17 offset:32768
    ds_read_b64_tr_b16 v[186:187], v17 offset:33280
    v_mfma_f32_16x16x32_bf16 v[68:71], v[228:231], v[200:203], v[68:71]
    ds_read_b64_tr_b16 v[188:189], v18 offset:32768
    ds_read_b64_tr_b16 v[190:191], v18 offset:33280
    v_mfma_f32_16x16x32_bf16 v[72:75], v[232:235], v[200:203], v[72:75]
    ds_read_b64_tr_b16 v[192:193], v19 offset:32768
    ds_read_b64_tr_b16 v[194:195], v19 offset:33280
    v_mfma_f32_16x16x32_bf16 v[76:79], v[236:239], v[200:203], v[76:79]
    ds_read_b64_tr_b16 v[196:197], v20 offset:32768
    v_mfma_f32_16x16x32_bf16 v[80:83], v[224:227], v[204:207], v[80:83]
    ds_read_b64_tr_b16 v[198:199], v20 offset:33280
    v_mfma_f32_16x16x32_bf16 v[84:87], v[228:231], v[204:207], v[84:87]
    ds_read_b128 v[160:163], v15 offset:0
    v_mfma_f32_16x16x32_bf16 v[88:91], v[232:235], v[204:207], v[88:91]
    ds_read_b128 v[164:167], v15 offset:2048
    v_mfma_f32_16x16x32_bf16 v[92:95], v[236:239], v[204:207], v[92:95]
    ds_read_b128 v[168:171], v15 offset:4096
    v_mfma_f32_16x16x32_bf16 v[96:99], v[224:227], v[208:211], v[96:99]
    ds_read_b128 v[172:175], v15 offset:6144
    v_mfma_f32_16x16x32_bf16 v[100:103], v[228:231], v[208:211], v[100:103]
    ds_read_b128 v[176:179], v15 offset:8192
    v_mfma_f32_16x16x32_bf16 v[104:107], v[232:235], v[208:211], v[104:107]
    v_add_u32 v1, 256, v63
    v_mfma_f32_16x16x32_bf16 v[108:111], v[236:239], v[208:211], v[108:111]
    buffer_load_dwordx2 v[36:37], v63, s[36:39], 0 offen sc1
    v_mfma_f32_16x16x32_bf16 v[112:115], v[224:227], v[212:215], v[112:115]
    buffer_load_dwordx2 v[38:39], v1, s[36:39], 0 offen offset:0 sc1
    v_mfma_f32_16x16x32_bf16 v[116:119], v[228:231], v[212:215], v[116:119]
    buffer_load_dwordx2 v[40:41], v1, s[36:39], 0 offen offset:256 sc1
    v_mfma_f32_16x16x32_bf16 v[120:123], v[232:235], v[212:215], v[120:123]
    buffer_load_dwordx2 v[42:43], v1, s[36:39], 0 offen offset:512 sc1
    v_mfma_f32_16x16x32_bf16 v[124:127], v[236:239], v[212:215], v[124:127]
    buffer_load_dwordx2 v[44:45], v1, s[36:39], 0 offen offset:768 sc1
    v_mfma_f32_16x16x32_bf16 v[128:131], v[224:227], v[216:219], v[128:131]
    buffer_load_dwordx2 v[46:47], v1, s[36:39], 0 offen offset:1024 sc1
    v_mfma_f32_16x16x32_bf16 v[132:135], v[228:231], v[216:219], v[132:135]
    s_mov_b32 m0, 150528
    s_nop 0
    buffer_load_dwordx4 v27, s[36:39], s70 offen sc1 lds
    v_mfma_f32_16x16x32_bf16 v[136:139], v[232:235], v[216:219], v[136:139]
    s_mov_b32 m0, 151552
    s_nop 0
    buffer_load_dwordx4 v27, s[36:39], s71 offen sc1 lds
    v_mfma_f32_16x16x32_bf16 v[140:143], v[236:239], v[216:219], v[140:143]
    s_mov_b32 m0, 152576
    s_nop 0
    buffer_load_dwordx4 v27, s[36:39], s72 offen sc1 lds
    s_waitcnt vmcnt(3) lgkmcnt(0)
    s_barrier
    v_mfma_f32_16x16x32_bf16 v[64:67], v[184:187], v[160:163], v[64:67]
    ds_read_b64_tr_b16 v[224:225], v17 offset:49152
    v_mfma_f32_16x16x32_bf16 v[68:71], v[188:191], v[160:163], v[68:71]
    ds_read_b64_tr_b16 v[226:227], v17 offset:49664
    v_mfma_f32_16x16x32_bf16 v[72:75], v[192:195], v[160:163], v[72:75]
    ds_read_b64_tr_b16 v[228:229], v18 offset:49152
    v_mfma_f32_16x16x32_bf16 v[76:79], v[196:199], v[160:163], v[76:79]
    ds_read_b64_tr_b16 v[230:231], v18 offset:49664
    v_mfma_f32_16x16x32_bf16 v[80:83], v[184:187], v[164:167], v[80:83]
    ds_read_b64_tr_b16 v[232:233], v19 offset:49152
    v_mfma_f32_16x16x32_bf16 v[84:87], v[188:191], v[164:167], v[84:87]
    ds_read_b64_tr_b16 v[234:235], v19 offset:49664
    v_mfma_f32_16x16x32_bf16 v[88:91], v[192:195], v[164:167], v[88:91]
    ds_read_b64_tr_b16 v[236:237], v20 offset:49152
    v_mfma_f32_16x16x32_bf16 v[92:95], v[196:199], v[164:167], v[92:95]
    ds_read_b64_tr_b16 v[238:239], v20 offset:49664
    v_mfma_f32_16x16x32_bf16 v[96:99], v[184:187], v[168:171], v[96:99]
    ds_read_b128 v[200:203], v16 offset:0
    v_mfma_f32_16x16x32_bf16 v[100:103], v[188:191], v[168:171], v[100:103]
    ds_read_b128 v[204:207], v16 offset:2048
    v_mfma_f32_16x16x32_bf16 v[104:107], v[192:195], v[168:171], v[104:107]
    ds_read_b128 v[208:211], v16 offset:4096
    v_mfma_f32_16x16x32_bf16 v[108:111], v[196:199], v[168:171], v[108:111]
    ds_read_b128 v[212:215], v16 offset:6144
    v_mfma_f32_16x16x32_bf16 v[112:115], v[184:187], v[172:175], v[112:115]
    ds_read_b128 v[216:219], v16 offset:8192
    v_mfma_f32_16x16x32_bf16 v[116:119], v[188:191], v[172:175], v[116:119]
    v_mfma_f32_16x16x32_bf16 v[120:123], v[192:195], v[172:175], v[120:123]
    v_mfma_f32_16x16x32_bf16 v[124:127], v[196:199], v[172:175], v[124:127]
    v_mfma_f32_16x16x32_bf16 v[128:131], v[184:187], v[176:179], v[128:131]
    v_mfma_f32_16x16x32_bf16 v[132:135], v[188:191], v[176:179], v[132:135]
    v_mfma_f32_16x16x32_bf16 v[136:139], v[192:195], v[176:179], v[136:139]
    v_mfma_f32_16x16x32_bf16 v[140:143], v[196:199], v[176:179], v[140:143]
    s_waitcnt vmcnt(0) lgkmcnt(0)
    s_barrier
    v_mfma_f32_16x16x32_bf16 v[64:67], v[224:227], v[200:203], v[64:67]
    ds_read_b128 v[240:243], v52
    v_mfma_f32_16x16x32_bf16 v[68:71], v[228:231], v[200:203], v[68:71]
    ds_read_b128 v[244:247], v53
    v_mfma_f32_16x16x32_bf16 v[72:75], v[232:235], v[200:203], v[72:75]
    ds_read_b128 v[248:251], v54
    v_mfma_f32_16x16x32_bf16 v[76:79], v[236:239], v[200:203], v[76:79]
    ds_read_b128 v[252:255], v55
    v_mfma_f32_16x16x32_bf16 v[80:83], v[224:227], v[204:207], v[80:83]
    v_mfma_f32_16x16x32_bf16 v[84:87], v[228:231], v[204:207], v[84:87]
    v_mfma_f32_16x16x32_bf16 v[88:91], v[232:235], v[204:207], v[88:91]
    v_mfma_f32_16x16x32_bf16 v[92:95], v[236:239], v[204:207], v[92:95]
    v_mfma_f32_16x16x32_bf16 v[96:99], v[224:227], v[208:211], v[96:99]
    v_mfma_f32_16x16x32_bf16 v[100:103], v[228:231], v[208:211], v[100:103]
    v_mfma_f32_16x16x32_bf16 v[104:107], v[232:235], v[208:211], v[104:107]
    v_mfma_f32_16x16x32_bf16 v[108:111], v[236:239], v[208:211], v[108:111]
    v_mfma_f32_16x16x32_bf16 v[112:115], v[224:227], v[212:215], v[112:115]
    v_mfma_f32_16x16x32_bf16 v[116:119], v[228:231], v[212:215], v[116:119]
    v_mfma_f32_16x16x32_bf16 v[120:123], v[232:235], v[212:215], v[120:123]
    v_mfma_f32_16x16x32_bf16 v[124:127], v[236:239], v[212:215], v[124:127]
    v_mfma_f32_16x16x32_bf16 v[128:131], v[224:227], v[216:219], v[128:131]
    v_mfma_f32_16x16x32_bf16 v[132:135], v[228:231], v[216:219], v[132:135]
    v_mfma_f32_16x16x32_bf16 v[136:139], v[232:235], v[216:219], v[136:139]
    v_mfma_f32_16x16x32_bf16 v[140:143], v[236:239], v[216:219], v[140:143]
L_att_epi:
    s_or_b32 s66, s59, s62
    s_cmp_eq_u32 s66, 0
    s_cselect_b64 s[28:29], 0, s[4:5]
    s_cselect_b64 s[30:31], 0, s[6:7]
    s_cselect_b64 s[40:41], 0, s[8:9]
    s_cselect_b64 s[42:43], 0, s[10:11]
    s_mov_b32 s63, s69
    v_max_f32 v37, 0x3a83126f, v37
    v_max_f32 v39, 0x3a83126f, v39
    v_max_f32 v41, 0x3a83126f, v41
    v_max_f32 v43, 0x3a83126f, v43
    v_max_f32 v45, 0x3a83126f, v45
    v_max_f32 v47, 0x3a83126f, v47
    v_rcp_f32 v37, v37
    v_rcp_f32 v39, v39
    v_rcp_f32 v41, v41
    v_rcp_f32 v43, v43
    v_rcp_f32 v45, v45
    v_rcp_f32 v47, v47
    s_waitcnt lgkmcnt(0)
    v_mov_b32 v8, 0
    v_mov_b32 v9, 0
    ds_write_b64 v57, v[8:9]
    v_pk_fma_f32 v[64:65], v[36:37], v[240:241], v[64:65] op_sel:[0,0,0] op_sel_hi:[0,1,1] neg_lo:[1,0,0] neg_hi:[1,0,0]
    v_pk_fma_f32 v[66:67], v[36:37], v[242:243], v[66:67] op_sel:[0,0,0] op_sel_hi:[0,1,1] neg_lo:[1,0,0] neg_hi:[1,0,0]
    v_pk_fma_f32 v[68:69], v[36:37], v[244:245], v[68:69] op_sel:[0,0,0] op_sel_hi:[0,1,1] neg_lo:[1,0,0] neg_hi:[1,0,0]
    v_pk_fma_f32 v[70:71], v[36:37], v[246:247], v[70:71] op_sel:[0,0,0] op_sel_hi:[0,1,1] neg_lo:[1,0,0] neg_hi:[1,0,0]
    v_pk_fma_f32 v[72:73], v[36:37], v[248:249], v[72:73] op_sel:[0,0,0] op_sel_hi:[0,1,1] neg_lo:[1,0,0] neg_hi:[1,0,0]
    v_pk_fma_f32 v[74:75], v[36:37], v[250:251], v[74:75] op_sel:[0,0,0] op_sel_hi:[0,1,1] neg_lo:[1,0,0] neg_hi:[1,0,0]
    v_pk_fma_f32 v[76:77], v[36:37], v[252:253], v[76:77] op_sel:[0,0,0] op_sel_hi:[0,1,1] neg_lo:[1,0,0] neg_hi:[1,0,0]
    v_pk_fma_f32 v[78:79], v[36:37], v[254:255], v[78:79] op_sel:[0,0,0] op_sel_hi:[0,1,1] neg_lo:[1,0,0] neg_hi:[1,0,0]
    v_pk_mul_f32 v[64:65], v[64:65], v[36:37] op_sel:[0,1] op_sel_hi:[1,1]
    v_pk_mul_f32 v[66:67], v[66:67], v[36:37] op_sel:[0,1] op_sel_hi:[1,1]
    v_pk_mul_f32 v[68:69], v[68:69], v[36:37] op_sel:[0,1] op_sel_hi:[1,1]
    v_pk_mul_f32 v[70:71], v[70:71], v[36:37] op_sel:[0,1] op_sel_hi:[1,1]
    v_pk_mul_f32 v[72:73], v[72:73], v[36:37] op_sel:[0,1] op_sel_hi:[1,1]
    v_pk_mul_f32 v[74:75], v[74:75], v[36:37] op_sel:[0,1] op_sel_hi:[1,1]
    v_pk_mul_f32 v[76:77], v[76:77], v[36:37] op_sel:[0,1] op_sel_hi:[1,1]
    v_pk_mul_f32 v[78:79], v[78:79], v[36:37] op_sel:[0,1] op_sel_hi:[1,1]
    v_cvt_pk_bf16_f32 v160, v64, v65
    v_cvt_pk_bf16_f32 v161, v66, v67
    ds_write_b64 v21, v[160:161] offset:0
    v_cvt_pk_bf16_f32 v162, v68, v69
    v_cvt_pk_bf16_f32 v163, v70, v71
    ds_write_b64 v22, v[162:163] offset:0
    v_cvt_pk_bf16_f32 v164, v72, v73
    v_cvt_pk_bf16_f32 v165, v74, v75
    ds_write_b64 v23, v[164:165] offset:0
    v_cvt_pk_bf16_f32 v166, v76, v77
    v_cvt_pk_bf16_f32 v167, v78, v79
    ds_write_b64 v24, v[166:167] offset:0
    v_pk_fma_f32 v[80:81], v[38:39], v[240:241], v[80:81] op_sel:[0,0,0] op_sel_hi:[0,1,1] neg_lo:[1,0,0] neg_hi:[1,0,0]
    v_pk_fma_f32 v[82:83], v[38:39], v[242:243], v[82:83] op_sel:[0,0,0] op_sel_hi:[0,1,1] neg_lo:[1,0,0] neg_hi:[1,0,0]
    v_pk_fma_f32 v[84:85], v[38:39], v[244:245], v[84:85] op_sel:[0,0,0] op_sel_hi:[0,1,1] neg_lo:[1,0,0] neg_hi:[1,0,0]
    v_pk_fma_f32 v[86:87], v[38:39], v[246:247], v[86:87] op_sel:[0,0,0] op_sel_hi:[0,1,1] neg_lo:[1,0,0] neg_hi:[1,0,0]
    v_pk_fma_f32 v[88:89], v[38:39], v[248:249], v[88:89] op_sel:[0,0,0] op_sel_hi:[0,1,1] neg_lo:[1,0,0] neg_hi:[1,0,0]
    v_pk_fma_f32 v[90:91], v[38:39], v[250:251], v[90:91] op_sel:[0,0,0] op_sel_hi:[0,1,1] neg_lo:[1,0,0] neg_hi:[1,0,0]
    v_pk_fma_f32 v[92:93], v[38:39], v[252:253], v[92:93] op_sel:[0,0,0] op_sel_hi:[0,1,1] neg_lo:[1,0,0] neg_hi:[1,0,0]
    v_pk_fma_f32 v[94:95], v[38:39], v[254:255], v[94:95] op_sel:[0,0,0] op_sel_hi:[0,1,1] neg_lo:[1,0,0] neg_hi:[1,0,0]
    v_pk_mul_f32 v[80:81], v[80:81], v[38:39] op_sel:[0,1] op_sel_hi:[1,1]
    v_pk_mul_f32 v[82:83], v[82:83], v[38:39] op_sel:[0,1] op_sel_hi:[1,1]
    v_pk_mul_f32 v[84:85], v[84:85], v[38:39] op_sel:[0,1] op_sel_hi:[1,1]
    v_pk_mul_f32 v[86:87], v[86:87], v[38:39] op_sel:[0,1] op_sel_hi:[1,1]
    v_pk_mul_f32 v[88:89], v[88:89], v[38:39] op_sel:[0,1] op_sel_hi:[1,1]
    v_pk_mul_f32 v[90:91], v[90:91], v[38:39] op_sel:[0,1] op_sel_hi:[1,1]
    v_pk_mul_f32 v[92:93], v[92:93], v[38:39] op_sel:[0,1] op_sel_hi:[1,1]
    v_pk_mul_f32 v[94:95], v[94:95], v[38:39] op_sel:[0,1] op_sel_hi:[1,1]
    v_cvt_pk_bf16_f32 v168, v80, v81
    v_cvt_pk_bf16_f32 v169, v82, v83
    ds_write_b64 v21, v[168:169] offset:2688
    v_cvt_pk_bf16_f32 v170, v84, v85
    v_cvt_pk_bf16_f32 v171, v86, v87
    ds_write_b64 v22, v[170:171] offset:2688
    v_cvt_pk_bf16_f32 v172, v88, v89
    v_cvt_pk_bf16_f32 v173, v90, v91
    ds_write_b64 v23, v[172:173] offset:2688
    v_cvt_pk_bf16_f32 v174, v92, v93
    v_cvt_pk_bf16_f32 v175, v94, v95
    ds_write_b64 v24, v[174:175] offset:2688
    v_pk_fma_f32 v[96:97], v[40:41], v[240:241], v[96:97] op_sel:[0,0,0] op_sel_hi:[0,1,1] neg_lo:[1,0,0] neg_hi:[1,0,0]
    v_pk_fma_f32 v[98:99], v[40:41], v[242:243], v[98:99] op_sel:[0,0,0] op_sel_hi:[0,1,1] neg_lo:[1,0,0] neg_hi:[1,0,0]
    v_pk_fma_f32 v[100:101], v[40:41], v[244:245], v[100:101] op_sel:[0,0,0] op_sel_hi:[0,1,1] neg_lo:[1,0,0] neg_hi:[1,0,0]
    v_pk_fma_f32 v[102:103], v[40:41], v[246:247], v[102:103] op_sel:[0,0,0] op_sel_hi:[0,1,1] neg_lo:[1,0,0] neg_hi:[1,0,0]
    v_pk_fma_f32 v[104:105], v[40:41], v[248:249], v[104:105] op_sel:[0,0,0] op_sel_hi:[0,1,1] neg_lo:[1,0,0] neg_hi:[1,0,0]
    v_pk_fma_f32 v[106:107], v[40:41], v[250:251], v[106:107] op_sel:[0,0,0] op_sel_hi:[0,1,1] neg_lo:[1,0,0] neg_hi:[1,0,0]
    v_pk_fma_f32 v[108:109], v[40:41], v[252:253], v[108:109] op_sel:[0,0,0] op_sel_hi:[0,1,1] neg_lo:[1,0,0] neg_hi:[1,0,0]
    v_pk_fma_f32 v[110:111], v[40:41], v[254:255], v[110:111] op_sel:[0,0,0] op_sel_hi:[0,1,1] neg_lo:[1,0,0] neg_hi:[1,0,0]
    v_pk_mul_f32 v[96:97], v[96:97], v[40:41] op_sel:[0,1] op_sel_hi:[1,1]
    v_pk_mul_f32 v[98:99], v[98:99], v[40:41] op_sel:[0,1] op_sel_hi:[1,1]
    v_pk_mul_f32 v[100:101], v[100:101], v[40:41] op_sel:[0,1] op_sel_hi:[1,1]
    v_pk_mul_f32 v[102:103], v[102:103], v[40:41] op_sel:[0,1] op_sel_hi:[1,1]
    v_pk_mul_f32 v[104:105], v[104:105], v[40:41] op_sel:[0,1] op_sel_hi:[1,1]
    v_pk_mul_f32 v[106:107], v[106:107], v[40:41] op_sel:[0,1] op_sel_hi:[1,1]
    v_pk_mul_f32 v[108:109], v[108:109], v[40:41] op_sel:[0,1] op_sel_hi:[1,1]
    v_pk_mul_f32 v[110:111], v[110:111], v[40:41] op_sel:[0,1] op_sel_hi:[1,1]
    v_cvt_pk_bf16_f32 v160, v96, v97
    v_cvt_pk_bf16_f32 v161, v98, v99
    ds_write_b64 v21, v[160:161] offset:5376
    v_cvt_pk_bf16_f32 v162, v100, v101
    v_cvt_pk_bf16_f32 v163, v102, v103
    ds_write_b64 v22, v[162:163] offset:5376
    v_cvt_pk_bf16_f32 v164, v104, v105
    v_cvt_pk_bf16_f32 v165, v106, v107
    ds_write_b64 v23, v[164:165] offset:5376
    v_cvt_pk_bf16_f32 v166, v108, v109
    v_cvt_pk_bf16_f32 v167, v110, v111
    ds_write_b64 v24, v[166:167] offset:5376
    v_pk_fma_f32 v[112:113], v[42:43], v[240:241], v[112:113] op_sel:[0,0,0] op_sel_hi:[0,1,1] neg_lo:[1,0,0] neg_hi:[1,0,0]
    v_pk_fma_f32 v[114:115], v[42:43], v[242:243], v[114:115] op_sel:[0,0,0] op_sel_hi:[0,1,1] neg_lo:[1,0,0] neg_hi:[1,0,0]
    v_pk_fma_f32 v[116:117], v[42:43], v[244:245], v[116:117] op_sel:[0,0,0] op_sel_hi:[0,1,1] neg_lo:[1,0,0] neg_hi:[1,0,0]
    v_pk_fma_f32 v[118:119], v[42:43], v[246:247], v[118:119] op_sel:[0,0,0] op_sel_hi:[0,1,1] neg_lo:[1,0,0] neg_hi:[1,0,0]
    v_pk_fma_f32 v[120:121], v[42:43], v[248:249], v[120:121] op_sel:[0,0,0] op_sel_hi:[0,1,1] neg_lo:[1,0,0] neg_hi:[1,0,0]
    v_pk_fma_f32 v[122:123], v[42:43], v[250:251], v[122:123] op_sel:[0,0,0] op_sel_hi:[0,1,1] neg_lo:[1,0,0] neg_hi:[1,0,0]
    v_pk_fma_f32 v[124:125], v[42:43], v[252:253], v[124:125] op_sel:[0,0,0] op_sel_hi:[0,1,1] neg_lo:[1,0,0] neg_hi:[1,0,0]
    v_pk_fma_f32 v[126:127], v[42:43], v[254:255], v[126:127] op_sel:[0,0,0] op_sel_hi:[0,1,1] neg_lo:[1,0,0] neg_hi:[1,0,0]
    v_pk_mul_f32 v[112:113], v[112:113], v[42:43] op_sel:[0,1] op_sel_hi:[1,1]
    v_pk_mul_f32 v[114:115], v[114:115], v[42:43] op_sel:[0,1] op_sel_hi:[1,1]
    v_pk_mul_f32 v[116:117], v[116:117], v[42:43] op_sel:[0,1] op_sel_hi:[1,1]
    v_pk_mul_f32 v[118:119], v[118:119], v[42:43] op_sel:[0,1] op_sel_hi:[1,1]
    v_pk_mul_f32 v[120:121], v[120:121], v[42:43] op_sel:[0,1] op_sel_hi:[1,1]
    v_pk_mul_f32 v[122:123], v[122:123], v[42:43] op_sel:[0,1] op_sel_hi:[1,1]
    v_pk_mul_f32 v[124:125], v[124:125], v[42:43] op_sel:[0,1] op_sel_hi:[1,1]
    v_pk_mul_f32 v[126:127], v[126:127], v[42:43] op_sel:[0,1] op_sel_hi:[1,1]
    v_cvt_pk_bf16_f32 v168, v112, v113
    v_cvt_pk_bf16_f32 v169, v114, v115
    ds_write_b64 v21, v[168:169] offset:8064
    v_cvt_pk_bf16_f32 v170, v116, v117
    v_cvt_pk_bf16_f32 v171, v118, v119
    ds_write_b64 v22, v[170:171] offset:8064
    v_cvt_pk_bf16_f32 v172, v120, v121
    v_cvt_pk_bf16_f32 v173, v122, v123
    ds_write_b64 v23, v[172:173] offset:8064
    v_cvt_pk_bf16_f32 v174, v124, v125
    v_cvt_pk_bf16_f32 v175, v126, v127
    ds_write_b64 v24, v[174:175] offset:8064
    v_pk_fma_f32 v[128:129], v[44:45], v[240:241], v[128:129] op_sel:[0,0,0] op_sel_hi:[0,1,1] neg_lo:[1,0,0] neg_hi:[1,0,0]
    v_pk_fma_f32 v[130:131], v[44:45], v[242:243], v[130:131] op_sel:[0,0,0] op_sel_hi:[0,1,1] neg_lo:[1,0,0] neg_hi:[1,0,0]
    v_pk_fma_f32 v[132:133], v[44:45], v[244:245], v[132:133] op_sel:[0,0,0] op_sel_hi:[0,1,1] neg_lo:[1,0,0] neg_hi:[1,0,0]
    v_pk_fma_f32 v[134:135], v[44:45], v[246:247], v[134:135] op_sel:[0,0,0] op_sel_hi:[0,1,1] neg_lo:[1,0,0] neg_hi:[1,0,0]
    v_pk_fma_f32 v[136:137], v[44:45], v[248:249], v[136:137] op_sel:[0,0,0] op_sel_hi:[0,1,1] neg_lo:[1,0,0] neg_hi:[1,0,0]
    v_pk_fma_f32 v[138:139], v[44:45], v[250:251], v[138:139] op_sel:[0,0,0] op_sel_hi:[0,1,1] neg_lo:[1,0,0] neg_hi:[1,0,0]
    v_pk_fma_f32 v[140:141], v[44:45], v[252:253], v[140:141] op_sel:[0,0,0] op_sel_hi:[0,1,1] neg_lo:[1,0,0] neg_hi:[1,0,0]
    v_pk_fma_f32 v[142:143], v[44:45], v[254:255], v[142:143] op_sel:[0,0,0] op_sel_hi:[0,1,1] neg_lo:[1,0,0] neg_hi:[1,0,0]
    v_pk_mul_f32 v[128:129], v[128:129], v[44:45] op_sel:[0,1] op_sel_hi:[1,1]
    v_pk_mul_f32 v[130:131], v[130:131], v[44:45] op_sel:[0,1] op_sel_hi:[1,1]
    v_pk_mul_f32 v[132:133], v[132:133], v[44:45] op_sel:[0,1] op_sel_hi:[1,1]
    v_pk_mul_f32 v[134:135], v[134:135], v[44:45] op_sel:[0,1] op_sel_hi:[1,1]
    v_pk_mul_f32 v[136:137], v[136:137], v[44:45] op_sel:[0,1] op_sel_hi:[1,1]
    v_pk_mul_f32 v[138:139], v[138:139], v[44:45] op_sel:[0,1] op_sel_hi:[1,1]
    v_pk_mul_f32 v[140:141], v[140:141], v[44:45] op_sel:[0,1] op_sel_hi:[1,1]
    v_pk_mul_f32 v[142:143], v[142:143], v[44:45] op_sel:[0,1] op_sel_hi:[1,1]
    v_cvt_pk_bf16_f32 v160, v128, v129
    v_cvt_pk_bf16_f32 v161, v130, v131
    ds_write_b64 v21, v[160:161] offset:10752
    v_cvt_pk_bf16_f32 v162, v132, v133
    v_cvt_pk_bf16_f32 v163, v134, v135
    ds_write_b64 v22, v[162:163] offset:10752
    v_cvt_pk_bf16_f32 v164, v136, v137
    v_cvt_pk_bf16_f32 v165, v138, v139
    ds_write_b64 v23, v[164:165] offset:10752
    v_cvt_pk_bf16_f32 v166, v140, v141
    v_cvt_pk_bf16_f32 v167, v142, v143
    ds_write_b64 v24, v[166:167] offset:10752
    s_cmp_eq_u32 s59, 1
    s_cbranch_scc1 L_att_wdone
    v_pk_fma_f32 v[144:145], v[46:47], v[240:241], v[144:145] op_sel:[0,0,0] op_sel_hi:[0,1,1] neg_lo:[1,0,0] neg_hi:[1,0,0]
    v_pk_fma_f32 v[146:147], v[46:47], v[242:243], v[146:147] op_sel:[0,0,0] op_sel_hi:[0,1,1] neg_lo:[1,0,0] neg_hi:[1,0,0]
    v_pk_fma_f32 v[148:149], v[46:47], v[244:245], v[148:149] op_sel:[0,0,0] op_sel_hi:[0,1,1] neg_lo:[1,0,0] neg_hi:[1,0,0]
    v_pk_fma_f32 v[150:151], v[46:47], v[246:247], v[150:151] op_sel:[0,0,0] op_sel_hi:[0,1,1] neg_lo:[1,0,0] neg_hi:[1,0,0]
    v_pk_fma_f32 v[152:153], v[46:47], v[248:249], v[152:153] op_sel:[0,0,0] op_sel_hi:[0,1,1] neg_lo:[1,0,0] neg_hi:[1,0,0]
    v_pk_fma_f32 v[154:155], v[46:47], v[250:251], v[154:155] op_sel:[0,0,0] op_sel_hi:[0,1,1] neg_lo:[1,0,0] neg_hi:[1,0,0]
    v_pk_fma_f32 v[156:157], v[46:47], v[252:253], v[156:157] op_sel:[0,0,0] op_sel_hi:[0,1,1] neg_lo:[1,0,0] neg_hi:[1,0,0]
    v_pk_fma_f32 v[158:159], v[46:47], v[254:255], v[158:159] op_sel:[0,0,0] op_sel_hi:[0,1,1] neg_lo:[1,0,0] neg_hi:[1,0,0]
    v_pk_mul_f32 v[144:145], v[144:145], v[46:47] op_sel:[0,1] op_sel_hi:[1,1]
    v_pk_mul_f32 v[146:147], v[146:147], v[46:47] op_sel:[0,1] op_sel_hi:[1,1]
    v_pk_mul_f32 v[148:149], v[148:149], v[46:47] op_sel:[0,1] op_sel_hi:[1,1]
    v_pk_mul_f32 v[150:151], v[150:151], v[46:47] op_sel:[0,1] op_sel_hi:[1,1]
    v_pk_mul_f32 v[152:153], v[152:153], v[46:47] op_sel:[0,1] op_sel_hi:[1,1]
    v_pk_mul_f32 v[154:155], v[154:155], v[46:47] op_sel:[0,1] op_sel_hi:[1,1]
    v_pk_mul_f32 v[156:157], v[156:157], v[46:47] op_sel:[0,1] op_sel_hi:[1,1]
    v_pk_mul_f32 v[158:159], v[158:159], v[46:47] op_sel:[0,1] op_sel_hi:[1,1]
    v_cvt_pk_bf16_f32 v168, v144, v145
    v_cvt_pk_bf16_f32 v169, v146, v147
    ds_write_b64 v21, v[168:169] offset:13440
    v_cvt_pk_bf16_f32 v170, v148, v149
    v_cvt_pk_bf16_f32 v171, v150, v151
    ds_write_b64 v22, v[170:171] offset:13440
    v_cvt_pk_bf16_f32 v172, v152, v153
    v_cvt_pk_bf16_f32 v173, v154, v155
    ds_write_b64 v23, v[172:173] offset:13440
    v_cvt_pk_bf16_f32 v174, v156, v157
    v_cvt_pk_bf16_f32 v175, v158, v159
    ds_write_b64 v24, v[174:175] offset:13440
L_att_wdone:
    s_and_b32 s64, s2, 7
    s_lshr_b32 s65, s2, 3
    s_cmp_ge_u32 s64, 2
    s_cselect_b32 s66, 12, 31
    s_cselect_b32 s67, 12, 99
    s_cmp_eq_u32 s65, s67
    s_cselect_b32 s68, 1, 0
    s_cmp_eq_u32 s65, 31
    s_cselect_b32 s65, s66, s65
    s_min_u32 s66, s64, 2
    s_mul_i32 s64, s64, 31
    s_add_u32 s64, s64, s66
    s_add_u32 s65, s64, s65
    s_mul_i32 s64, s65, 205
    s_lshr_b32 s64, s64, 11
    s_mul_i32 s66, s64, 10
    s_sub_u32 s65, s65, s66
    s_mul_i32 s66, s64, 5
    s_mov_b32 s67, 5
    s_cmp_gt_u32 s64, 2
    s_addc_u32 s66, s66, 0
    s_cmp_eq_u32 s64, 2
    s_addc_u32 s67, s67, 0
    s_cmp_gt_u32 s64, 5
    s_addc_u32 s66, s66, 0
    s_cmp_eq_u32 s64, 5
    s_addc_u32 s67, s67, 0
    s_cmp_gt_u32 s64, 8
    s_addc_u32 s66, s66, 0
    s_cmp_eq_u32 s64, 8
    s_addc_u32 s67, s67, 0
    v_bfe_u32 v17, v2, 1, 2
    v_bfe_u32 v18, v2, 4, 1
    v_xor_b32 v17, v17, v18
    v_and_b32 v18, 1, v2
    v_lshlrev_b32 v17, 5, v17
    v_lshl_add_u32 v17, v18, 4, v17
    s_and_b32 s3, s56, 1
    s_lshl_b32 s3, s3, 6
    v_xor_b32 v17, s3, v17
    v_lshrrev_b32 v18, 3, v2
    v_mul_u32_u24 v18, 1280, v18
    s_mul_i32 s3, s56, 10240
    s_lshl_b32 s64, s65, 7
    s_add_u32 s3, s3, s64
    v_add3_u32 v20, v17, v18, s3
    s_lshl_b32 s65, s56, 10
    s_mov_b32 s64, 0
    s_add_u32 m0, s65, 0x18000
    s_nop 0
    buffer_load_dwordx4 v20, s[44:47], s64 offen lds
    s_add_u32 s64, s64, 81920
    s_add_u32 m0, s65, 0x1a000
    s_nop 0
    buffer_load_dwordx4 v20, s[44:47], s64 offen lds
    s_add_u32 s64, s64, 81920
    s_add_u32 m0, s65, 0x1c000
    s_nop 0
    buffer_load_dwordx4 v20, s[44:47], s64 offen lds
    s_add_u32 s64, s64, 81920
    s_waitcnt lgkmcnt(0)
    s_barrier
    v_add_u32 v7, 0, v58
    v_add_u32 v8, 0, v56
    v_add_u32 v9, 2688, v56
    ds_read2_b64 v[64:67], v7 offset0:0 offset1:1
    ds_read2_b64 v[68:71], v8 offset0:0 offset1:1
    ds_read2_b64 v[72:75], v9 offset0:0 offset1:1
    v_add_u32 v7, 2688, v58
    v_add_u32 v8, 2688, v56
    v_add_u32 v9, 5376, v56
    ds_read2_b64 v[84:87], v7 offset0:0 offset1:1
    ds_read2_b64 v[88:91], v8 offset0:0 offset1:1
    ds_read2_b64 v[92:95], v9 offset0:0 offset1:1
    v_add_u32 v7, 5376, v58
    v_add_u32 v8, 5376, v56
    v_add_u32 v9, 8064, v56
    ds_read2_b64 v[104:107], v7 offset0:0 offset1:1
    ds_read2_b64 v[108:111], v8 offset0:0 offset1:1
    ds_read2_b64 v[112:115], v9 offset0:0 offset1:1
    v_add_u32 v7, 8064, v58
    v_add_u32 v8, 8064, v56
    v_add_u32 v9, 10752, v56
    ds_read2_b64 v[124:127], v7 offset0:0 offset1:1
    ds_read2_b64 v[128:131], v8 offset0:0 offset1:1
    ds_read2_b64 v[132:135], v9 offset0:0 offset1:1
    v_add_u32 v7, 10752, v58
    v_add_u32 v8, 10752, v56
    v_add_u32 v9, 13440, v56
    ds_read2_b64 v[144:147], v7 offset0:0 offset1:1
    ds_read2_b64 v[148:151], v8 offset0:0 offset1:1
    ds_read2_b64 v[152:155], v9 offset0:0 offset1:1
    ds_read_b64_tr_b16 v[76:77], v60 offset:0
    ds_read_b64_tr_b16 v[78:79], v60 offset:2688
    ds_read_b64_tr_b16 v[80:81], v60 offset:32
    ds_read_b64_tr_b16 v[82:83], v60 offset:2720
    ds_read_b64_tr_b16 v[96:97], v60 offset:2688
    ds_read_b64_tr_b16 v[98:99], v60 offset:5376
    ds_read_b64_tr_b16 v[100:101], v60 offset:2720
    ds_read_b64_tr_b16 v[102:103], v60 offset:5408
    ds_read_b64_tr_b16 v[116:117], v60 offset:5376
    ds_read_b64_tr_b16 v[118:119], v60 offset:8064
    ds_read_b64_tr_b16 v[120:121], v60 offset:5408
    ds_read_b64_tr_b16 v[122:123], v60 offset:8096
    ds_read_b64_tr_b16 v[136:137], v60 offset:8064
    ds_read_b64_tr_b16 v[138:139], v60 offset:10752
    ds_read_b64_tr_b16 v[140:141], v60 offset:8096
    ds_read_b64_tr_b16 v[142:143], v60 offset:10784
    ds_read_b64_tr_b16 v[156:157], v60 offset:10752
    ds_read_b64_tr_b16 v[158:159], v60 offset:13440
    ds_read_b64_tr_b16 v[160:161], v60 offset:10784
    ds_read_b64_tr_b16 v[162:163], v60 offset:13472
    v_mov_b32 v5, 0x3ea52b5c
    v_mov_b32 v6, 0xce6e6b28
    s_waitcnt lgkmcnt(0)
    v_cndmask_b32 v64, 0, v64, s[76:77]
    v_cndmask_b32 v65, 0, v65, s[76:77]
    v_cndmask_b32 v66, 0, v66, s[74:75]
    v_cndmask_b32 v67, 0, v67, s[74:75]
    v_cndmask_b32 v84, 0, v84, s[76:77]
    v_cndmask_b32 v85, 0, v85, s[76:77]
    v_cndmask_b32 v86, 0, v86, s[74:75]
    v_cndmask_b32 v87, 0, v87, s[74:75]
    v_cndmask_b32 v104, 0, v104, s[76:77]
    v_cndmask_b32 v105, 0, v105, s[76:77]
    v_cndmask_b32 v106, 0, v106, s[74:75]
    v_cndmask_b32 v107, 0, v107, s[74:75]
    v_cndmask_b32 v124, 0, v124, s[76:77]
    v_cndmask_b32 v125, 0, v125, s[76:77]
    v_cndmask_b32 v126, 0, v126, s[74:75]
    v_cndmask_b32 v127, 0, v127, s[74:75]
    v_cndmask_b32 v144, 0, v144, s[76:77]
    v_cndmask_b32 v145, 0, v145, s[76:77]
    v_cndmask_b32 v146, 0, v146, s[74:75]
    v_cndmask_b32 v147, 0, v147, s[74:75]
    s_nop 1
    v_mfma_f32_16x16x32_bf16 v[168:171], v[68:71], v[64:67], 0
    v_mfma_f32_16x16x32_bf16 v[172:175], v[72:75], v[64:67], 0
    v_mfma_f32_16x16x32_bf16 v[176:179], v[88:91], v[84:87], 0
    v_mfma_f32_16x16x32_bf16 v[180:183], v[92:95], v[84:87], 0
    v_mfma_f32_16x16x32_bf16 v[184:187], v[108:111], v[104:107], 0
    v_mfma_f32_16x16x32_bf16 v[188:191], v[112:115], v[104:107], 0
    v_mfma_f32_16x16x32_bf16 v[192:195], v[128:131], v[124:127], 0
    v_mfma_f32_16x16x32_bf16 v[196:199], v[132:135], v[124:127], 0
    v_mfma_f32_16x16x32_bf16 v[200:203], v[148:151], v[144:147], 0
    v_mfma_f32_16x16x32_bf16 v[204:207], v[152:155], v[144:147], 0
    s_nop 0
    v_pk_mul_f32 v[168:169], v[168:169], v[4:5] op_sel:[0,1] op_sel_hi:[1,1]
    v_pk_mul_f32 v[170:171], v[170:171], v[4:5] op_sel:[0,1] op_sel_hi:[1,1]
    v_pk_mul_f32 v[172:173], v[172:173], v[4:5] op_sel:[0,1] op_sel_hi:[1,1]
    v_pk_mul_f32 v[174:175], v[174:175], v[4:5] op_sel:[0,1] op_sel_hi:[1,1]
    v_cndmask_b32 v168, v6, v168, s[28:29]
    v_cndmask_b32 v169, v6, v169, s[30:31]
    v_cndmask_b32 v170, v6, v170, s[40:41]
    v_cndmask_b32 v171, v6, v171, s[42:43]
    v_cndmask_b32 v172, v6, v172, s[12:13]
    v_cndmask_b32 v173, v6, v173, s[14:15]
    v_cndmask_b32 v174, v6, v174, s[16:17]
    v_cndmask_b32 v175, v6, v175, s[18:19]
    v_max3_f32 v208, v168, v169, v170
    v_max3_f32 v209, v171, v172, v173
    v_max3_f32 v208, v208, v174, v175
    v_max_f32 v208, v208, v209
    v_pk_mul_f32 v[176:177], v[176:177], v[4:5] op_sel:[0,1] op_sel_hi:[1,1]
    v_pk_mul_f32 v[178:179], v[178:179], v[4:5] op_sel:[0,1] op_sel_hi:[1,1]
    v_pk_mul_f32 v[180:181], v[180:181], v[4:5] op_sel:[0,1] op_sel_hi:[1,1]
    v_pk_mul_f32 v[182:183], v[182:183], v[4:5] op_sel:[0,1] op_sel_hi:[1,1]
    v_cndmask_b32 v176, v6, v176, s[4:5]
    v_cndmask_b32 v177, v6, v177, s[6:7]
    v_cndmask_b32 v178, v6, v178, s[8:9]
    v_cndmask_b32 v179, v6, v179, s[10:11]
    v_cndmask_b32 v180, v6, v180, s[12:13]
    v_cndmask_b32 v181, v6, v181, s[14:15]
    v_cndmask_b32 v182, v6, v182, s[16:17]
    v_cndmask_b32 v183, v6, v183, s[18:19]
    v_max3_f32 v210, v176, v177, v178
    v_max3_f32 v211, v179, v180, v181
    v_max3_f32 v210, v210, v182, v183
    v_max_f32 v210, v210, v211
    v_pk_mul_f32 v[184:185], v[184:185], v[4:5] op_sel:[0,1] op_sel_hi:[1,1]
    v_pk_mul_f32 v[186:187], v[186:187], v[4:5] op_sel:[0,1] op_sel_hi:[1,1]
    v_pk_mul_f32 v[188:189], v[188:189], v[4:5] op_sel:[0,1] op_sel_hi:[1,1]
    v_pk_mul_f32 v[190:191], v[190:191], v[4:5] op_sel:[0,1] op_sel_hi:[1,1]
    v_cndmask_b32 v184, v6, v184, s[4:5]
    v_cndmask_b32 v185, v6, v185, s[6:7]
    v_cndmask_b32 v186, v6, v186, s[8:9]
    v_cndmask_b32 v187, v6, v187, s[10:11]
    v_cndmask_b32 v188, v6, v188, s[12:13]
    v_cndmask_b32 v189, v6, v189, s[14:15]
    v_cndmask_b32 v190, v6, v190, s[16:17]
    v_cndmask_b32 v191, v6, v191, s[18:19]
    v_max3_f32 v212, v184, v185, v186
    v_max3_f32 v213, v187, v188, v189
    v_max3_f32 v212, v212, v190, v191
    v_max_f32 v212, v212, v213
    v_pk_mul_f32 v[192:193], v[192:193], v[4:5] op_sel:[0,1] op_sel_hi:[1,1]
    v_pk_mul_f32 v[194:195], v[194:195], v[4:5] op_sel:[0,1] op_sel_hi:[1,1]
    v_pk_mul_f32 v[196:197], v[196:197], v[4:5] op_sel:[0,1] op_sel_hi:[1,1]
    v_pk_mul_f32 v[198:199], v[198:199], v[4:5] op_sel:[0,1] op_sel_hi:[1,1]
    v_cndmask_b32 v192, v6, v192, s[4:5]
    v_cndmask_b32 v193, v6, v193, s[6:7]
    v_cndmask_b32 v194, v6, v194, s[8:9]
    v_cndmask_b32 v195, v6, v195, s[10:11]
    v_cndmask_b32 v196, v6, v196, s[12:13]
    v_cndmask_b32 v197, v6, v197, s[14:15]
    v_cndmask_b32 v198, v6, v198, s[16:17]
    v_cndmask_b32 v199, v6, v199, s[18:19]
    v_max3_f32 v214, v192, v193, v194
    v_max3_f32 v215, v195, v196, v197
    v_max3_f32 v214, v214, v198, v199
    v_max_f32 v214, v214, v215
    v_pk_mul_f32 v[200:201], v[200:201], v[4:5] op_sel:[0,1] op_sel_hi:[1,1]
    v_pk_mul_f32 v[202:203], v[202:203], v[4:5] op_sel:[0,1] op_sel_hi:[1,1]
    v_pk_mul_f32 v[204:205], v[204:205], v[4:5] op_sel:[0,1] op_sel_hi:[1,1]
    v_pk_mul_f32 v[206:207], v[206:207], v[4:5] op_sel:[0,1] op_sel_hi:[1,1]
    v_cndmask_b32 v200, v6, v200, s[4:5]
    v_cndmask_b32 v201, v6, v201, s[6:7]
    v_cndmask_b32 v202, v6, v202, s[8:9]
    v_cndmask_b32 v203, v6, v203, s[10:11]
    v_cndmask_b32 v204, v6, v204, s[12:13]
    v_cndmask_b32 v205, v6, v205, s[14:15]
    v_cndmask_b32 v206, v6, v206, s[16:17]
    v_cndmask_b32 v207, v6, v207, s[18:19]
    v_max3_f32 v216, v200, v201, v202
    v_max3_f32 v217, v203, v204, v205
    v_max3_f32 v216, v216, v206, v207
    v_max_f32 v216, v216, v217
    v_mov_b32 v209, v208
    v_mov_b32 v211, v210
    v_mov_b32 v213, v212
    v_mov_b32 v215, v214
    v_mov_b32 v217, v216
    s_nop 1
    v_permlane16_swap_b32 v208, v209
    v_permlane16_swap_b32 v210, v211
    v_permlane16_swap_b32 v212, v213
    v_permlane16_swap_b32 v214, v215
    v_permlane16_swap_b32 v216, v217
    s_nop 1
    v_max_f32 v208, v208, v209
    v_max_f32 v210, v210, v211
    v_max_f32 v212, v212, v213
    v_max_f32 v214, v214, v215
    v_max_f32 v216, v216, v217
    v_mov_b32 v209, v208
    v_mov_b32 v211, v210
    v_mov_b32 v213, v212
    v_mov_b32 v215, v214
    v_mov_b32 v217, v216
    s_nop 1
    v_permlane32_swap_b32 v208, v209
    v_permlane32_swap_b32 v210, v211
    v_permlane32_swap_b32 v212, v213
    v_permlane32_swap_b32 v214, v215
    v_permlane32_swap_b32 v216, v217
    s_nop 1
    v_max_f32 v208, v208, v209
    v_max_f32 v210, v210, v211
    v_max_f32 v212, v212, v213
    v_max_f32 v214, v214, v215
    v_max_f32 v216, v216, v217
    v_pk_add_f32 v[168:169], v[168:169], v[208:209] op_sel:[0,0] op_sel_hi:[1,0] neg_lo:[0,1] neg_hi:[0,1]
    v_pk_add_f32 v[170:171], v[170:171], v[208:209] op_sel:[0,0] op_sel_hi:[1,0] neg_lo:[0,1] neg_hi:[0,1]
    v_pk_add_f32 v[172:173], v[172:173], v[208:209] op_sel:[0,0] op_sel_hi:[1,0] neg_lo:[0,1] neg_hi:[0,1]
    v_pk_add_f32 v[174:175], v[174:175], v[208:209] op_sel:[0,0] op_sel_hi:[1,0] neg_lo:[0,1] neg_hi:[0,1]
    v_exp_f32 v168, v168
    v_exp_f32 v169, v169
    v_exp_f32 v170, v170
    v_exp_f32 v171, v171
    v_exp_f32 v172, v172
    v_exp_f32 v173, v173
    v_exp_f32 v174, v174
    v_exp_f32 v175, v175
    s_nop 0
    v_add_f32 v208, v168, v169
    v_add_f32 v209, v170, v171
    v_add_f32 v208, v208, v172
    v_add_f32 v209, v209, v173
    v_add_f32 v208, v208, v174
    v_add_f32 v209, v209, v175
    v_add_f32 v208, v208, v209
    v_pk_add_f32 v[176:177], v[176:177], v[210:211] op_sel:[0,0] op_sel_hi:[1,0] neg_lo:[0,1] neg_hi:[0,1]
    v_pk_add_f32 v[178:179], v[178:179], v[210:211] op_sel:[0,0] op_sel_hi:[1,0] neg_lo:[0,1] neg_hi:[0,1]
    v_pk_add_f32 v[180:181], v[180:181], v[210:211] op_sel:[0,0] op_sel_hi:[1,0] neg_lo:[0,1] neg_hi:[0,1]
    v_pk_add_f32 v[182:183], v[182:183], v[210:211] op_sel:[0,0] op_sel_hi:[1,0] neg_lo:[0,1] neg_hi:[0,1]
    v_exp_f32 v176, v176
    v_exp_f32 v177, v177
    v_exp_f32 v178, v178
    v_exp_f32 v179, v179
    v_exp_f32 v180, v180
    v_exp_f32 v181, v181
    v_exp_f32 v182, v182
    v_exp_f32 v183, v183
    s_nop 0
    v_add_f32 v210, v176, v177
    v_add_f32 v211, v178, v179
    v_add_f32 v210, v210, v180
    v_add_f32 v211, v211, v181
    v_add_f32 v210, v210, v182
    v_add_f32 v211, v211, v183
    v_add_f32 v210, v210, v211
    v_pk_add_f32 v[184:185], v[184:185], v[212:213] op_sel:[0,0] op_sel_hi:[1,0] neg_lo:[0,1] neg_hi:[0,1]
    v_pk_add_f32 v[186:187], v[186:187], v[212:213] op_sel:[0,0] op_sel_hi:[1,0] neg_lo:[0,1] neg_hi:[0,1]
    v_pk_add_f32 v[188:189], v[188:189], v[212:213] op_sel:[0,0] op_sel_hi:[1,0] neg_lo:[0,1] neg_hi:[0,1]
    v_pk_add_f32 v[190:191], v[190:191], v[212:213] op_sel:[0,0] op_sel_hi:[1,0] neg_lo:[0,1] neg_hi:[0,1]
    v_exp_f32 v184, v184
    v_exp_f32 v185, v185
    v_exp_f32 v186, v186
    v_exp_f32 v187, v187
    v_exp_f32 v188, v188
    v_exp_f32 v189, v189
    v_exp_f32 v190, v190
    v_exp_f32 v191, v191
    s_nop 0
    v_add_f32 v212, v184, v185
    v_add_f32 v213, v186, v187
    v_add_f32 v212, v212, v188
    v_add_f32 v213, v213, v189
    v_add_f32 v212, v212, v190
    v_add_f32 v213, v213, v191
    v_add_f32 v212, v212, v213
    v_pk_add_f32 v[192:193], v[192:193], v[214:215] op_sel:[0,0] op_sel_hi:[1,0] neg_lo:[0,1] neg_hi:[0,1]
    v_pk_add_f32 v[194:195], v[194:195], v[214:215] op_sel:[0,0] op_sel_hi:[1,0] neg_lo:[0,1] neg_hi:[0,1]
    v_pk_add_f32 v[196:197], v[196:197], v[214:215] op_sel:[0,0] op_sel_hi:[1,0] neg_lo:[0,1] neg_hi:[0,1]
    v_pk_add_f32 v[198:199], v[198:199], v[214:215] op_sel:[0,0] op_sel_hi:[1,0] neg_lo:[0,1] neg_hi:[0,1]
    v_exp_f32 v192, v192
    v_exp_f32 v193, v193
    v_exp_f32 v194, v194
    v_exp_f32 v195, v195
    v_exp_f32 v196, v196
    v_exp_f32 v197, v197
    v_exp_f32 v198, v198
    v_exp_f32 v199, v199
    s_nop 0
    v_add_f32 v214, v192, v193
    v_add_f32 v215, v194, v195
    v_add_f32 v214, v214, v196
    v_add_f32 v215, v215, v197
    v_add_f32 v214, v214, v198
    v_add_f32 v215, v215, v199
    v_add_f32 v214, v214, v215
    v_pk_add_f32 v[200:201], v[200:201], v[216:217] op_sel:[0,0] op_sel_hi:[1,0] neg_lo:[0,1] neg_hi:[0,1]
    v_pk_add_f32 v[202:203], v[202:203], v[216:217] op_sel:[0,0] op_sel_hi:[1,0] neg_lo:[0,1] neg_hi:[0,1]
    v_pk_add_f32 v[204:205], v[204:205], v[216:217] op_sel:[0,0] op_sel_hi:[1,0] neg_lo:[0,1] neg_hi:[0,1]
    v_pk_add_f32 v[206:207], v[206:207], v[216:217] op_sel:[0,0] op_sel_hi:[1,0] neg_lo:[0,1] neg_hi:[0,1]
    v_exp_f32 v200, v200
    v_exp_f32 v201, v201
    v_exp_f32 v202, v202
    v_exp_f32 v203, v203
    v_exp_f32 v204, v204
    v_exp_f32 v205, v205
    v_exp_f32 v206, v206
    v_exp_f32 v207, v207
    s_nop 0
    v_add_f32 v216, v200, v201
    v_add_f32 v217, v202, v203
    v_add_f32 v216, v216, v204
    v_add_f32 v217, v217, v205
    v_add_f32 v216, v216, v206
    v_add_f32 v217, v217, v207
    v_add_f32 v216, v216, v217
    v_mov_b32 v209, v208
    v_mov_b32 v211, v210
    v_mov_b32 v213, v212
    v_mov_b32 v215, v214
    v_mov_b32 v217, v216
    s_nop 1
    v_permlane16_swap_b32 v208, v209
    v_permlane16_swap_b32 v210, v211
    v_permlane16_swap_b32 v212, v213
    v_permlane16_swap_b32 v214, v215
    v_permlane16_swap_b32 v216, v217
    s_nop 1
    v_add_f32 v208, v208, v209
    v_add_f32 v210, v210, v211
    v_add_f32 v212, v212, v213
    v_add_f32 v214, v214, v215
    v_add_f32 v216, v216, v217
    v_mov_b32 v209, v208
    v_mov_b32 v211, v210
    v_mov_b32 v213, v212
    v_mov_b32 v215, v214
    v_mov_b32 v217, v216
    s_nop 1
    v_permlane32_swap_b32 v208, v209
    v_permlane32_swap_b32 v210, v211
    v_permlane32_swap_b32 v212, v213
    v_permlane32_swap_b32 v214, v215
    v_permlane32_swap_b32 v216, v217
    s_nop 1
    v_add_f32 v208, v208, v209
    v_add_f32 v210, v210, v211
    v_add_f32 v212, v212, v213
    v_add_f32 v214, v214, v215
    v_add_f32 v216, v216, v217
    v_rcp_f32 v208, v208
    v_rcp_f32 v210, v210
    v_rcp_f32 v212, v212
    v_rcp_f32 v214, v214
    v_rcp_f32 v216, v216
    s_nop 0
    v_pk_mul_f32 v[168:169], v[168:169], v[208:209] op_sel:[0,0] op_sel_hi:[1,0]
    v_pk_mul_f32 v[170:171], v[170:171], v[208:209] op_sel:[0,0] op_sel_hi:[1,0]
    v_pk_mul_f32 v[172:173], v[172:173], v[208:209] op_sel:[0,0] op_sel_hi:[1,0]
    v_pk_mul_f32 v[174:175], v[174:175], v[208:209] op_sel:[0,0] op_sel_hi:[1,0]
    v_cvt_pk_bf16_f32 v64, v168, v169
    v_cvt_pk_bf16_f32 v65, v170, v171
    v_cvt_pk_bf16_f32 v66, v172, v173
    v_cvt_pk_bf16_f32 v67, v174, v175
    v_pk_mul_f32 v[176:177], v[176:177], v[210:211] op_sel:[0,0] op_sel_hi:[1,0]
    v_pk_mul_f32 v[178:179], v[178:179], v[210:211] op_sel:[0,0] op_sel_hi:[1,0]
    v_pk_mul_f32 v[180:181], v[180:181], v[210:211] op_sel:[0,0] op_sel_hi:[1,0]
    v_pk_mul_f32 v[182:183], v[182:183], v[210:211] op_sel:[0,0] op_sel_hi:[1,0]
    v_cvt_pk_bf16_f32 v84, v176, v177
    v_cvt_pk_bf16_f32 v85, v178, v179
    v_cvt_pk_bf16_f32 v86, v180, v181
    v_cvt_pk_bf16_f32 v87, v182, v183
    v_pk_mul_f32 v[184:185], v[184:185], v[212:213] op_sel:[0,0] op_sel_hi:[1,0]
    v_pk_mul_f32 v[186:187], v[186:187], v[212:213] op_sel:[0,0] op_sel_hi:[1,0]
    v_pk_mul_f32 v[188:189], v[188:189], v[212:213] op_sel:[0,0] op_sel_hi:[1,0]
    v_pk_mul_f32 v[190:191], v[190:191], v[212:213] op_sel:[0,0] op_sel_hi:[1,0]
    v_cvt_pk_bf16_f32 v104, v184, v185
    v_cvt_pk_bf16_f32 v105, v186, v187
    v_cvt_pk_bf16_f32 v106, v188, v189
    v_cvt_pk_bf16_f32 v107, v190, v191
    v_pk_mul_f32 v[192:193], v[192:193], v[214:215] op_sel:[0,0] op_sel_hi:[1,0]
    v_pk_mul_f32 v[194:195], v[194:195], v[214:215] op_sel:[0,0] op_sel_hi:[1,0]
    v_pk_mul_f32 v[196:197], v[196:197], v[214:215] op_sel:[0,0] op_sel_hi:[1,0]
    v_pk_mul_f32 v[198:199], v[198:199], v[214:215] op_sel:[0,0] op_sel_hi:[1,0]
    v_cvt_pk_bf16_f32 v124, v192, v193
    v_cvt_pk_bf16_f32 v125, v194, v195
    v_cvt_pk_bf16_f32 v126, v196, v197
    v_cvt_pk_bf16_f32 v127, v198, v199
    v_pk_mul_f32 v[200:201], v[200:201], v[216:217] op_sel:[0,0] op_sel_hi:[1,0]
    v_pk_mul_f32 v[202:203], v[202:203], v[216:217] op_sel:[0,0] op_sel_hi:[1,0]
    v_pk_mul_f32 v[204:205], v[204:205], v[216:217] op_sel:[0,0] op_sel_hi:[1,0]
    v_pk_mul_f32 v[206:207], v[206:207], v[216:217] op_sel:[0,0] op_sel_hi:[1,0]
    v_cvt_pk_bf16_f32 v144, v200, v201
    v_cvt_pk_bf16_f32 v145, v202, v203
    v_cvt_pk_bf16_f32 v146, v204, v205
    v_cvt_pk_bf16_f32 v147, v206, v207
    s_nop 1
    v_mfma_f32_16x16x32_bf16 v[168:171], v[76:79], v[64:67], 0
    v_mfma_f32_16x16x32_bf16 v[172:175], v[80:83], v[64:67], 0
    v_mfma_f32_16x16x32_bf16 v[176:179], v[96:99], v[84:87], 0
    v_mfma_f32_16x16x32_bf16 v[180:183], v[100:103], v[84:87], 0
    v_mfma_f32_16x16x32_bf16 v[184:187], v[116:119], v[104:107], 0
    v_mfma_f32_16x16x32_bf16 v[188:191], v[120:123], v[104:107], 0
    v_mfma_f32_16x16x32_bf16 v[192:195], v[136:139], v[124:127], 0
    v_mfma_f32_16x16x32_bf16 v[196:199], v[140:143], v[124:127], 0
    v_mfma_f32_16x16x32_bf16 v[200:203], v[156:159], v[144:147], 0
    v_mfma_f32_16x16x32_bf16 v[204:207], v[160:163], v[144:147], 0
    s_nop 0
    v_cvt_pk_bf16_f32 v68, v168, v169
    v_cvt_pk_bf16_f32 v69, v170, v171
    v_cvt_pk_bf16_f32 v70, v172, v173
    v_cvt_pk_bf16_f32 v71, v174, v175
    ds_write_b64 v61, v[68:69] offset:0
    v_cvt_pk_bf16_f32 v88, v176, v177
    v_cvt_pk_bf16_f32 v89, v178, v179
    v_cvt_pk_bf16_f32 v90, v180, v181
    v_cvt_pk_bf16_f32 v91, v182, v183
    ds_write_b64 v61, v[88:89] offset:2560
    v_cvt_pk_bf16_f32 v108, v184, v185
    v_cvt_pk_bf16_f32 v109, v186, v187
    v_cvt_pk_bf16_f32 v110, v188, v189
    v_cvt_pk_bf16_f32 v111, v190, v191
    ds_write_b64 v61, v[108:109] offset:5120
    v_cvt_pk_bf16_f32 v128, v192, v193
    v_cvt_pk_bf16_f32 v129, v194, v195
    v_cvt_pk_bf16_f32 v130, v196, v197
    v_cvt_pk_bf16_f32 v131, v198, v199
    ds_write_b64 v61, v[128:129] offset:7680
    v_cvt_pk_bf16_f32 v148, v200, v201
    v_cvt_pk_bf16_f32 v149, v202, v203
    v_cvt_pk_bf16_f32 v150, v204, v205
    v_cvt_pk_bf16_f32 v151, v206, v207
    ds_write_b64 v61, v[148:149] offset:10240
    s_mov_b64 exec, 0xffff
    ds_write_b64 v62, v[70:71] offset:0
    ds_write_b64 v62, v[90:91] offset:2560
    ds_write_b64 v62, v[110:111] offset:5120
    ds_write_b64 v62, v[130:131] offset:7680
    ds_write_b64 v62, v[150:151] offset:10240
    s_mov_b64 exec, -1
    s_add_u32 s3, s65, 122880
    v_add_u32 v5, s3, v3
    s_waitcnt lgkmcnt(0)
    s_barrier
    ds_read_b128 v[64:67], v5 offset:0
    ds_read_b128 v[68:71], v5 offset:8192
    ds_read_b128 v[72:75], v5 offset:16384
    ds_read_b128 v[76:79], v5 offset:24576
    s_waitcnt lgkmcnt(3)
    buffer_store_dwordx4 v[64:67], v48, s[32:35], s63 offen sc1
    s_waitcnt lgkmcnt(2)
    buffer_store_dwordx4 v[68:71], v49, s[32:35], s63 offen sc1
    s_waitcnt lgkmcnt(1)
    buffer_store_dwordx4 v[72:75], v50, s[32:35], s63 offen sc1
    s_waitcnt lgkmcnt(0)
    buffer_store_dwordx4 v[76:79], v51, s[32:35], s63 offen sc1
    s_add_u32 m0, s65, 0x1e000
    s_nop 0
    buffer_load_dwordx4 v20, s[44:47], s64 offen lds
    s_add_u32 s64, s64, 81920
    s_add_u32 m0, s65, 0x20000
    s_nop 0
    buffer_load_dwordx4 v20, s[44:47], s64 offen lds
    s_add_u32 s64, s64, 81920
    s_add_u32 m0, s65, 0x22000
    s_nop 0
    buffer_load_dwordx4 v20, s[44:47], s64 offen lds
    s_add_u32 s64, s64, 81920
    s_lshl_b32 s3, s2, 7
    s_add_u32 s3, s3, 65536
    v_mov_b32 v1, 0x40000000
    v_mov_b32 v5, s3
    v_cmp_eq_u32 vcc, 0, v0
    v_mov_b32 v6, 1
    s_waitcnt vmcnt(0)
    s_barrier
    v_cndmask_b32 v1, v1, v5, vcc
    buffer_store_dword v6, v1, s[36:39], 0 offen sc1
    s_branch L_phase2
L_k1_extra:
    buffer_load_dwordx4 v[36:39], v30, s[24:27], 0 offen
    buffer_load_dwordx4 v[40:43], v30, s[24:27], 0 offen offset:640
    buffer_load_dwordx4 v[48:51], v31, s[40:43], s77 offen
    buffer_load_dwordx4 v[52:55], v31, s[40:43], s76 offen
    buffer_load_dwordx4 v[44:47], v31, s[40:43], 0 offen
    buffer_load_dwordx4 v[56:59], v31, s[40:43], s75 offen
    buffer_load_dwordx4 v[60:63], v31, s[40:43], s74 offen
    s_lshl_b32 s66, s2, 3
    s_add_u32 s66, s66, s56
    s_lshl_b32 s66, s66, 10
    buffer_load_dwordx4 v[252:255], v3, s[44:47], s66 offen
    buffer_load_dwordx4 v[252:255], v3, s[48:51], s66 offen
    s_add_u32 s66, s66, 0x200000
    buffer_load_dwordx4 v[252:255], v3, s[44:47], s66 offen
    s_waitcnt vmcnt(0)
    v_mfma_f32_16x16x32_bf16 v[244:247], v[44:47], v[240:243], 0
    v_mfma_f32_16x16x32_bf16 v[244:247], v[48:51], v[240:243], v[244:247]
    v_mfma_f32_16x16x32_bf16 v[244:247], v[52:55], v[240:243], v[244:247]
    v_mfma_f32_16x16x32_bf16 v[244:247], v[56:59], v[240:243], v[244:247]
    v_mfma_f32_16x16x32_bf16 v[244:247], v[60:63], v[240:243], v[244:247]
    v_mov_b32 v252, 0x3f803f80
    v_dot2_f32_bf16 v248, v36, v252, 0
    v_dot2_f32_bf16 v250, v36, v36, 0
    v_dot2_f32_bf16 v249, v37, v252, 0
    v_dot2_f32_bf16 v251, v37, v37, 0
    v_dot2_f32_bf16 v248, v38, v252, v248
    v_dot2_f32_bf16 v250, v38, v38, v250
    v_dot2_f32_bf16 v249, v39, v252, v249
    v_dot2_f32_bf16 v251, v39, v39, v251
    v_dot2_f32_bf16 v248, v40, v252, v248
    v_dot2_f32_bf16 v250, v40, v40, v250
    v_dot2_f32_bf16 v249, v41, v252, v249
    v_dot2_f32_bf16 v251, v41, v41, v251
    v_dot2_f32_bf16 v248, v42, v252, v248
    v_dot2_f32_bf16 v250, v42, v42, v250
    v_dot2_f32_bf16 v249, v43, v252, v249
    v_dot2_f32_bf16 v251, v43, v43, v251
    s_nop 2
    v_add_f32 v248, v248, v249
    v_add_f32 v250, v250, v251
    s_nop 1
    v_add_f32_dpp v248, v248, v248 row_ror:8 row_mask:0xf bank_mask:0xf
    v_add_f32_dpp v250, v250, v250 row_ror:8 row_mask:0xf bank_mask:0xf
    s_nop 1
    v_add_f32_dpp v248, v248, v248 row_ror:4 row_mask:0xf bank_mask:0xf
    v_add_f32_dpp v250, v250, v250 row_ror:4 row_mask:0xf bank_mask:0xf
    s_nop 1
    v_add_f32_dpp v248, v248, v248 row_ror:2 row_mask:0xf bank_mask:0xf
    v_add_f32_dpp v250, v250, v250 row_ror:2 row_mask:0xf bank_mask:0xf
    s_nop 1
    v_add_f32_dpp v248, v248, v248 row_ror:1 row_mask:0xf bank_mask:0xf
    v_add_f32_dpp v250, v250, v250 row_ror:1 row_mask:0xf bank_mask:0xf
    v_mov_b32 v249, v248
    v_mov_b32 v251, v250
    v_mov_b32 v44, v244
    v_mov_b32 v45, v245
    v_mov_b32 v46, v246
    v_mov_b32 v47, v247
    s_nop 1
    v_permlane16_swap_b32 v248, v249
    v_permlane16_swap_b32 v250, v251
    v_permlane16_swap_b32 v244, v44
    v_permlane16_swap_b32 v245, v45
    v_permlane16_swap_b32 v246, v46
    v_permlane16_swap_b32 v247, v47
    s_nop 1
    v_add_f32 v248, v248, v249
    v_add_f32 v250, v250, v251
    v_add_f32 v244, v244, v44
    v_add_f32 v245, v245, v45
    v_add_f32 v246, v246, v46
    v_add_f32 v247, v247, v47
    v_mov_b32 v249, v248
    v_mov_b32 v251, v250
    v_mov_b32 v44, v244
    v_mov_b32 v45, v245
    v_mov_b32 v46, v246
    v_mov_b32 v47, v247
    s_nop 1
    v_permlane32_swap_b32 v248, v249
    v_permlane32_swap_b32 v250, v251
    v_permlane32_swap_b32 v244, v44
    v_permlane32_swap_b32 v245, v45
    v_permlane32_swap_b32 v246, v46
    v_permlane32_swap_b32 v247, v47
    s_nop 1
    v_add_f32 v248, v248, v249
    v_add_f32 v250, v250, v251
    v_add_f32 v244, v244, v44
    v_add_f32 v245, v245, v45
    v_add_f32 v246, v246, v46
    v_add_f32 v247, v247, v47
    ds_write_b128 v35, v[244:247]
    v_mul_f32 v248, 0x3acccccd, v248
    v_mul_f32 v250, 0x3acccccd, v250
    v_fma_f32 v250, -v248, v248, v250
    v_max_f32 v250, 0, v250
    v_cvt_pk_bf16_f32 v249, v248, v250
    v_lshlrev_b32 v252, 16, v249
    v_and_b32 v253, 0xffff0000, v249
    v_add_f32 v253, 0x3727c5ac, v253
    v_cvt_pk_bf16_f32 v253, v253, v253
    v_lshlrev_b32 v253, 16, v253
    v_sqrt_f32 v253, v253
    s_nop 0
    v_cvt_pk_bf16_f32 v253, v253, v253
    v_lshlrev_b32 v253, 16, v253
    s_lshl_b32 s66, s56, 3
    s_add_u32 s66, s66, 150016
    v_mov_b32 v248, s66
    ds_write_b64 v248, v[252:253] offset:0
    s_waitcnt lgkmcnt(0)
    s_barrier
    ds_read_b32 v44, v29 offset:0
    ds_read_b32 v45, v29 offset:128
    ds_read_b32 v46, v29 offset:256
    ds_read_b32 v47, v29 offset:384
    ds_read_b32 v48, v29 offset:512
    ds_read_b32 v49, v29 offset:640
    ds_read_b32 v50, v29 offset:768
    ds_read_b32 v51, v29 offset:896
    v_and_b32 v248, 7, v2
    v_lshlrev_b32 v248, 3, v248
    v_add_u32 v248, 150016, v248
    ds_read_b64 v[250:251], v248
    s_waitcnt lgkmcnt(0)
    v_add_f32 v44, v44, v45
    v_add_f32 v46, v46, v47
    v_add_f32 v48, v48, v49
    v_add_f32 v50, v50, v51
    v_add_f32 v44, v44, v46
    v_add_f32 v48, v48, v50
    v_add_f32 v44, v44, v48
    buffer_store_dword v44, v33, s[36:39], 0 offen sc1
    buffer_store_dwordx2 v[250:251], v32, s[36:39], 0 offen sc1
    s_waitcnt vmcnt(0)
    s_barrier
    v_mov_b32 v248, 1
    buffer_atomic_add v248, v34, s[52:55], 0 offen
    s_and_b32 s64, s2, 7
    s_lshr_b32 s65, s2, 3
    s_cmp_ge_u32 s64, 2
    s_cselect_b32 s66, 12, 31
    s_cselect_b32 s67, 12, 99
    s_cmp_eq_u32 s65, s67
    s_cselect_b32 s68, 1, 0
    s_cmp_eq_u32 s65, 31
    s_cselect_b32 s65, s66, s65
    s_min_u32 s66, s64, 2
    s_mul_i32 s64, s64, 31
    s_add_u32 s64, s64, s66
    s_add_u32 s65, s64, s65
    s_mul_i32 s64, s65, 205
    s_lshr_b32 s64, s64, 11
    s_mul_i32 s66, s64, 10
    s_sub_u32 s65, s65, s66
    s_mul_i32 s66, s64, 5
    s_mov_b32 s67, 5
    s_cmp_gt_u32 s64, 2
    s_addc_u32 s66, s66, 0
    s_cmp_eq_u32 s64, 2
    s_addc_u32 s67, s67, 0
    s_cmp_gt_u32 s64, 5
    s_addc_u32 s66, s66, 0
    s_cmp_eq_u32 s64, 5
    s_addc_u32 s67, s67, 0
    s_cmp_gt_u32 s64, 8
    s_addc_u32 s66, s66, 0
    s_cmp_eq_u32 s64, 8
    s_addc_u32 s67, s67, 0
    v_bfe_u32 v17, v2, 1, 2
    v_bfe_u32 v18, v2, 4, 1
    v_xor_b32 v17, v17, v18
    v_and_b32 v18, 1, v2
    v_lshlrev_b32 v17, 5, v17
    v_lshl_add_u32 v17, v18, 4, v17
    s_and_b32 s3, s56, 1
    s_lshl_b32 s3, s3, 6
    v_xor_b32 v17, s3, v17
    v_lshrrev_b32 v18, 3, v2
    v_mul_u32_u24 v18, 1280, v18
    s_mul_i32 s3, s56, 10240
    s_lshl_b32 s64, s65, 7
    s_add_u32 s3, s3, s64
    v_add3_u32 v20, v17, v18, s3
    s_lshl_b32 s65, s56, 10
    s_mov_b32 s64, 0
    s_add_u32 m0, s65, 0x18000
    s_nop 0
    buffer_load_dwordx4 v20, s[44:47], s64 offen lds
    s_add_u32 s64, s64, 81920
    s_add_u32 m0, s65, 0x1a000
    s_nop 0
    buffer_load_dwordx4 v20, s[44:47], s64 offen lds
    s_add_u32 s64, s64, 81920
    s_add_u32 m0, s65, 0x1c000
    s_nop 0
    buffer_load_dwordx4 v20, s[44:47], s64 offen lds
    s_add_u32 s64, s64, 81920
    s_add_u32 m0, s65, 0x1e000
    s_nop 0
    buffer_load_dwordx4 v20, s[44:47], s64 offen lds
    s_add_u32 s64, s64, 81920
    s_add_u32 m0, s65, 0x20000
    s_nop 0
    buffer_load_dwordx4 v20, s[44:47], s64 offen lds
    s_add_u32 s64, s64, 81920
    s_add_u32 m0, s65, 0x22000
    s_nop 0
    buffer_load_dwordx4 v20, s[44:47], s64 offen lds
    s_add_u32 s64, s64, 81920
    v_mov_b32 v249, 240
    s_mov_b32 s66, 0
    s_waitcnt vmcnt(0)
    s_cmp_lg_u32 s56, 0
    s_cbranch_scc1 L_xpoll_ok
L_xpoll:
    s_sleep 100
    buffer_load_dword v248, v249, s[52:55], 0 offen sc1
    s_waitcnt vmcnt(0)
    v_readfirstlane_b32 s67, v248
    s_add_u32 s66, s66, 1
    s_nop 2
    s_cmp_ge_u32 s67, 256
    s_cbranch_scc1 L_xpoll_ok
    s_cmp_lt_u32 s66, 0x20000
    s_cbranch_scc1 L_xpoll
L_xpoll_ok:
L_phase2:
    s_load_dwordx2 s[4:5], s[0:1], 0
    s_load_dwordx2 s[30:31], s[0:1], 56
    s_and_b32 s24, s2, 7
    s_lshr_b32 s25, s2, 3
    s_cmp_ge_u32 s24, 2
    s_cselect_b32 s26, 12, 31
    s_cselect_b32 s27, 12, 99
    s_cmp_eq_u32 s25, s27
    s_cselect_b32 s28, 1, 0
    s_cmp_eq_u32 s25, 31
    s_cselect_b32 s25, s26, s25
    s_min_u32 s26, s24, 2
    s_mul_i32 s24, s24, 31
    s_add_u32 s24, s24, s26
    s_add_u32 s25, s24, s25
    s_mul_i32 s24, s25, 205
    s_lshr_b32 s24, s24, 11
    s_mul_i32 s26, s24, 10
    s_sub_u32 s25, s25, s26
    s_mul_i32 s26, s24, 5
    s_mov_b32 s27, 5
    s_cmp_gt_u32 s24, 2
    s_addc_u32 s26, s26, 0
    s_cmp_eq_u32 s24, 2
    s_addc_u32 s27, s27, 0
    s_cmp_gt_u32 s24, 5
    s_addc_u32 s26, s26, 0
    s_cmp_eq_u32 s24, 5
    s_addc_u32 s27, s27, 0
    s_cmp_gt_u32 s24, 8
    s_addc_u32 s26, s26, 0
    s_cmp_eq_u32 s24, 8
    s_addc_u32 s27, s27, 0
    s_cmp_eq_u32 s28, 1
    s_cbranch_scc1 L_p2_end
    s_mov_b32 s20, s56
    v_lshrrev_b32 v4, 4, v2
    v_lshlrev_b32 v5, 10, v4
    v_bfe_u32 v6, v2, 2, 2
    v_lshl_add_u32 v5, v6, 7, v5
    v_and_b32 v6, 3, v2
    v_lshl_add_u32 v5, v6, 3, v5
    v_bfe_u32 v6, v2, 3, 2
    s_lshr_b32 s34, s20, 2
    s_mov_b32 s60, s22
    s_mov_b32 s61, s23
    s_mov_b32 s62, 0x18000
    s_mov_b32 s63, 0x00020000
    s_lshl_b32 s36, s26, 4
    s_add_u32 s37, s26, s27
    s_lshl_b32 s37, s37, 4
    s_sub_u32 s37, s37, 1
    s_lshr_b32 s38, s36, 7
    s_lshr_b32 s39, s37, 7
    v_mov_b32 v21, s38
    v_mov_b32 v22, s39
    v_cmp_gt_u32 vcc, 8, v2
    v_cmp_gt_u32 s[40:41], 16, v2
    v_and_b32 v25, 7, v2
    v_cndmask_b32 v21, v22, v21, vcc
    v_mov_b32 v22, 0x40000000
    v_lshl_add_u32 v23, v21, 3, v25
    v_lshlrev_b32 v23, 7, v23
    v_add_u32 v23, 78848, v23
    v_cndmask_b32 v23, v22, v23, s[40:41]
    s_mul_i32 s36, s36, 6554
    s_mul_i32 s37, s37, 6554
    s_lshr_b32 s36, s36, 20
    s_lshr_b32 s37, s37, 20
    v_mov_b32 v21, s36
    v_mov_b32 v24, s37
    v_cndmask_b32 v21, v24, v21, vcc
    v_lshl_add_u32 v24, v21, 3, v25
    v_lshlrev_b32 v24, 7, v24
    v_add_u32 v24, 65536, v24
    v_cndmask_b32 v24, v22, v24, s[40:41]
    s_and_b32 s36, s38, 1
    s_add_u32 s36, s36, 29
    s_lshl_b32 s36, s36, 3
    s_lshr_b32 s37, s38, 1
    s_add_u32 s36, s36, s37
    s_lshl_b32 s36, s36, 7
    s_add_u32 s36, s36, 65536
    v_writelane_b32 v24, s36, 16
    s_and_b32 s36, s39, 1
    s_add_u32 s36, s36, 29
    s_lshl_b32 s36, s36, 3
    s_lshr_b32 s37, s39, 1
    s_add_u32 s36, s36, s37
    s_lshl_b32 s36, s36, 7
    s_add_u32 s36, s36, 65536
    v_writelane_b32 v24, s36, 17
    s_lshr_b32 s35, s20, 2
    s_and_b32 s36, s20, 3
    s_waitcnt lgkmcnt(0)
    s_mov_b32 s40, s4
    s_mov_b32 s41, s5
    s_mov_b32 s42, 0x280000
    s_mov_b32 s43, 0x00020000
    s_mov_b32 s8, s30
    s_mov_b32 s9, s31
    s_mov_b32 s10, 0x280000
    s_mov_b32 s11, 0x00020000
    s_add_u32 s12, s22, 0x400000
    s_addc_u32 s13, s23, 0
    s_mov_b32 s14, 0x960000
    s_mov_b32 s15, 0x00020000
    s_mul_i32 s37, s35, 3
    s_add_u32 s37, s37, s26
    s_mul_i32 s37, s37, 20480
    s_lshl_b32 s38, s25, 7
    s_add_u32 s37, s37, s38
    s_lshl_b32 s38, s36, 5
    s_add_u32 s37, s37, s38
    v_and_b32 v26, 15, v2
    v_mul_u32_u24 v26, 1280, v26
    v_lshl_add_u32 v26, v4, 3, v26
    v_add_u32 v26, s37, v26
    s_mov_b32 s38, 20480
    s_mov_b32 s39, 40960
    buffer_load_dwordx2 v[28:29], v26, s[40:43], 0 offen
    buffer_load_dwordx2 v[30:31], v26, s[40:43], s38 offen
    buffer_load_dwordx2 v[32:33], v26, s[40:43], s39 offen
    s_add_u32 s37, s26, s20
    s_mul_i32 s37, s37, 76800
    v_add_u32 v10, s37, v3
    s_mov_b32 s16, 20480
    s_mov_b32 s17, 491520
    s_lshl_b32 s18, s20, 11
    s_lshl_b32 s19, s20, 10
    s_mul_i32 s37, s35, 6144
    v_add_u32 v12, s37, v3
    v_add_u32 v13, 0x10000, v12
    v_xor_b32 v15, s36, v6
    v_lshl_add_u32 v15, v15, 5, v5
    v_add_u32 v15, 98304, v15
    s_cmp_lg_u32 s20, 0
    s_cbranch_scc1 L_p2ok_f
    v_cmp_gt_u32 s[58:59], 0x40000000, v23
    s_mov_b32 s21, 0
L_p2poll_f:
    buffer_load_dword v22, v23, s[60:63], 0 offen sc1
    s_waitcnt vmcnt(0)
L_p2chk_f:
    v_cmp_eq_u32 vcc, 0, v22
    s_add_u32 s21, s21, 1
    s_nop 2
    s_and_b64 vcc, vcc, s[58:59]
    s_cbranch_scc0 L_p2ok_f
    s_cmp_ge_u32 s21, 0x20000
    s_cbranch_scc1 L_p2ok_f
    s_sleep 2
    s_cmp_lg_u64 vcc, s[58:59]
    s_cbranch_scc1 L_p2poll_f
    s_sleep 30
    s_branch L_p2poll_f
L_p2ok_f:
    s_waitcnt vmcnt(0)
    s_barrier
    s_cmp_lt_u32 s20, s27
    s_cbranch_scc0 L_k2_nl
    s_add_u32 m0, s18, 0x0
    s_nop 0
    buffer_load_dwordx4 v10, s[12:15], s16 offen lds
    buffer_load_dwordx4 v10, s[12:15], s16 offen offset:1024 lds
    s_add_u32 s16, s16, 2048
    s_add_u32 m0, s18, 0x3000
    s_nop 0
    buffer_load_dwordx4 v10, s[12:15], s16 offen lds
    buffer_load_dwordx4 v10, s[12:15], s16 offen offset:1024 lds
    s_add_u32 s16, s16, 2048
    s_add_u32 m0, s18, 0x6000
    s_nop 0
    buffer_load_dwordx4 v10, s[12:15], s16 offen lds
    buffer_load_dwordx4 v10, s[12:15], s16 offen offset:1024 lds
    s_add_u32 s16, s16, 2048
    s_add_u32 m0, s18, 0x9000
    s_nop 0
    buffer_load_dwordx4 v10, s[12:15], s16 offen lds
    buffer_load_dwordx4 v10, s[12:15], s16 offen offset:1024 lds
    s_add_u32 s16, s16, 2048
    s_add_u32 m0, s18, 0xc000
    s_nop 0
    buffer_load_dwordx4 v10, s[12:15], s16 offen lds
    buffer_load_dwordx4 v10, s[12:15], s16 offen offset:1024 lds
    s_add_u32 s16, s16, 2048
    s_add_u32 m0, s18, 0xf000
    s_nop 0
    buffer_load_dwordx4 v10, s[12:15], s16 offen lds
    buffer_load_dwordx4 v10, s[12:15], s16 offen offset:1024 lds
    s_add_u32 s16, s16, 2048
    s_waitcnt vmcnt(8)
    s_barrier
    ds_read_b64_tr_b16 v[108:109], v15 offset:0
    ds_read_b64_tr_b16 v[110:111], v15 offset:512
    ds_read_b128 v[96:99], v12 offset:0
    ds_read_b128 v[100:103], v12 offset:2048
    ds_read_b128 v[104:107], v12 offset:4096
    ds_read_b64_tr_b16 v[124:125], v15 offset:4096
    ds_read_b64_tr_b16 v[126:127], v15 offset:4608
    ds_read_b128 v[112:115], v12 offset:1024
    ds_read_b128 v[116:119], v12 offset:3072
    ds_read_b128 v[120:123], v12 offset:5120
    ds_read_b64_tr_b16 v[140:141], v15 offset:8192
    ds_read_b64_tr_b16 v[142:143], v15 offset:8704
    ds_read_b128 v[128:131], v12 offset:12288
    ds_read_b128 v[132:135], v12 offset:14336
    ds_read_b128 v[136:139], v12 offset:16384
    ds_read_b64_tr_b16 v[156:157], v15 offset:12288
    ds_read_b64_tr_b16 v[158:159], v15 offset:12800
    ds_read_b128 v[144:147], v12 offset:13312
    ds_read_b128 v[148:151], v12 offset:15360
    ds_read_b128 v[152:155], v12 offset:17408
    s_waitcnt vmcnt(4) lgkmcnt(0)
    s_barrier
    v_mfma_f32_16x16x32_bf16 v[64:67], v[108:111], v[96:99], 0
    s_add_u32 m0, s18, 0x0
    ds_read_b64_tr_b16 v[172:173], v15 offset:16384
    ds_read_b64_tr_b16 v[174:175], v15 offset:16896
    v_mfma_f32_16x16x32_bf16 v[68:71], v[108:111], v[100:103], 0
    buffer_load_dwordx4 v10, s[12:15], s16 offen lds
    ds_read_b128 v[160:163], v12 offset:24576
    ds_read_b128 v[164:167], v12 offset:26624
    v_mfma_f32_16x16x32_bf16 v[72:75], v[108:111], v[104:107], 0
    buffer_load_dwordx4 v10, s[12:15], s16 offen offset:1024 lds
    s_add_u32 s16, s16, 2048
    ds_read_b128 v[168:171], v12 offset:28672
    ds_read_b64_tr_b16 v[188:189], v15 offset:20480
    v_mfma_f32_16x16x32_bf16 v[64:67], v[124:127], v[112:115], v[64:67]
    s_add_u32 m0, s19, 0x18000
    ds_read_b64_tr_b16 v[190:191], v15 offset:20992
    ds_read_b128 v[176:179], v12 offset:25600
    v_mfma_f32_16x16x32_bf16 v[68:71], v[124:127], v[116:119], v[68:71]
    buffer_load_dwordx4 v20, s[44:47], s17 offen lds
    s_add_u32 s17, s17, 81920
    ds_read_b128 v[180:183], v12 offset:27648
    ds_read_b128 v[184:187], v12 offset:29696
    v_mfma_f32_16x16x32_bf16 v[72:75], v[124:127], v[120:123], v[72:75]
    s_add_u32 m0, s18, 0x3000
    ds_read_b64_tr_b16 v[204:205], v15 offset:24576
    ds_read_b64_tr_b16 v[206:207], v15 offset:25088
    v_mfma_f32_16x16x32_bf16 v[64:67], v[140:143], v[128:131], v[64:67]
    buffer_load_dwordx4 v10, s[12:15], s16 offen lds
    ds_read_b128 v[192:195], v12 offset:36864
    ds_read_b128 v[196:199], v12 offset:38912
    v_mfma_f32_16x16x32_bf16 v[68:71], v[140:143], v[132:135], v[68:71]
    buffer_load_dwordx4 v10, s[12:15], s16 offen offset:1024 lds
    s_add_u32 s16, s16, 2048
    ds_read_b128 v[200:203], v12 offset:40960
    ds_read_b64_tr_b16 v[220:221], v15 offset:28672
    v_mfma_f32_16x16x32_bf16 v[72:75], v[140:143], v[136:139], v[72:75]
    s_add_u32 m0, s19, 0x1a000
    ds_read_b64_tr_b16 v[222:223], v15 offset:29184
    v_mfma_f32_16x16x32_bf16 v[64:67], v[156:159], v[144:147], v[64:67]
    buffer_load_dwordx4 v20, s[44:47], s17 offen lds
    s_add_u32 s17, s17, 81920
    ds_read_b128 v[208:211], v12 offset:37888
    v_mfma_f32_16x16x32_bf16 v[68:71], v[156:159], v[148:151], v[68:71]
    ds_read_b128 v[212:215], v12 offset:39936
    v_mfma_f32_16x16x32_bf16 v[72:75], v[156:159], v[152:155], v[72:75]
    ds_read_b128 v[216:219], v12 offset:41984
    s_waitcnt vmcnt(6) lgkmcnt(0)
    s_barrier
    v_mfma_f32_16x16x32_bf16 v[64:67], v[172:175], v[160:163], v[64:67]
    s_add_u32 m0, s18, 0x6000
    ds_read_b64_tr_b16 v[108:109], v15 offset:32768
    ds_read_b64_tr_b16 v[110:111], v15 offset:33280
    v_mfma_f32_16x16x32_bf16 v[68:71], v[172:175], v[164:167], v[68:71]
    buffer_load_dwordx4 v10, s[12:15], s16 offen lds
    ds_read_b128 v[96:99], v12 offset:49152
    ds_read_b128 v[100:103], v12 offset:51200
    v_mfma_f32_16x16x32_bf16 v[72:75], v[172:175], v[168:171], v[72:75]
    buffer_load_dwordx4 v10, s[12:15], s16 offen offset:1024 lds
    s_add_u32 s16, s16, 2048
    ds_read_b128 v[104:107], v12 offset:53248
    ds_read_b64_tr_b16 v[124:125], v15 offset:36864
    v_mfma_f32_16x16x32_bf16 v[64:67], v[188:191], v[176:179], v[64:67]
    s_add_u32 m0, s19, 0x1c000
    ds_read_b64_tr_b16 v[126:127], v15 offset:37376
    ds_read_b128 v[112:115], v12 offset:50176
    v_mfma_f32_16x16x32_bf16 v[68:71], v[188:191], v[180:183], v[68:71]
    buffer_load_dwordx4 v20, s[44:47], s17 offen lds
    s_add_u32 s17, s17, 81920
    ds_read_b128 v[116:119], v12 offset:52224
    ds_read_b128 v[120:123], v12 offset:54272
    v_mfma_f32_16x16x32_bf16 v[72:75], v[188:191], v[184:187], v[72:75]
    s_add_u32 m0, s18, 0x9000
    ds_read_b64_tr_b16 v[140:141], v15 offset:40960
    ds_read_b64_tr_b16 v[142:143], v15 offset:41472
    v_mfma_f32_16x16x32_bf16 v[64:67], v[204:207], v[192:195], v[64:67]
    buffer_load_dwordx4 v10, s[12:15], s16 offen lds
    ds_read_b128 v[128:131], v12 offset:61440
    ds_read_b128 v[132:135], v12 offset:63488
    v_mfma_f32_16x16x32_bf16 v[68:71], v[204:207], v[196:199], v[68:71]
    buffer_load_dwordx4 v10, s[12:15], s16 offen offset:1024 lds
    s_add_u32 s16, s16, 2048
    ds_read_b128 v[136:139], v13 offset:0
    ds_read_b64_tr_b16 v[156:157], v15 offset:45056
    v_mfma_f32_16x16x32_bf16 v[72:75], v[204:207], v[200:203], v[72:75]
    s_add_u32 m0, s19, 0x1e000
    ds_read_b64_tr_b16 v[158:159], v15 offset:45568
    v_mfma_f32_16x16x32_bf16 v[64:67], v[220:223], v[208:211], v[64:67]
    buffer_load_dwordx4 v20, s[44:47], s17 offen lds
    s_add_u32 s17, s17, 81920
    ds_read_b128 v[144:147], v12 offset:62464
    v_mfma_f32_16x16x32_bf16 v[68:71], v[220:223], v[212:215], v[68:71]
    ds_read_b128 v[148:151], v12 offset:64512
    v_mfma_f32_16x16x32_bf16 v[72:75], v[220:223], v[216:219], v[72:75]
    ds_read_b128 v[152:155], v13 offset:1024
    s_waitcnt vmcnt(6) lgkmcnt(0)
    s_barrier
    v_mfma_f32_16x16x32_bf16 v[64:67], v[108:111], v[96:99], v[64:67]
    s_add_u32 m0, s18, 0xc000
    ds_read_b64_tr_b16 v[172:173], v15 offset:0
    ds_read_b64_tr_b16 v[174:175], v15 offset:512
    v_mfma_f32_16x16x32_bf16 v[68:71], v[108:111], v[100:103], v[68:71]
    buffer_load_dwordx4 v10, s[12:15], s16 offen lds
    ds_read_b128 v[160:163], v12 offset:0
    ds_read_b128 v[164:167], v12 offset:2048
    v_mfma_f32_16x16x32_bf16 v[72:75], v[108:111], v[104:107], v[72:75]
    buffer_load_dwordx4 v10, s[12:15], s16 offen offset:1024 lds
    s_add_u32 s16, s16, 2048
    ds_read_b128 v[168:171], v12 offset:4096
    ds_read_b64_tr_b16 v[188:189], v15 offset:4096
    v_mfma_f32_16x16x32_bf16 v[64:67], v[124:127], v[112:115], v[64:67]
    s_add_u32 m0, s19, 0x20000
    ds_read_b64_tr_b16 v[190:191], v15 offset:4608
    ds_read_b128 v[176:179], v12 offset:1024
    v_mfma_f32_16x16x32_bf16 v[68:71], v[124:127], v[116:119], v[68:71]
    buffer_load_dwordx4 v20, s[44:47], s17 offen lds
    s_add_u32 s17, s17, 81920
    ds_read_b128 v[180:183], v12 offset:3072
    ds_read_b128 v[184:187], v12 offset:5120
    v_mfma_f32_16x16x32_bf16 v[72:75], v[124:127], v[120:123], v[72:75]
    s_add_u32 m0, s18, 0xf000
    ds_read_b64_tr_b16 v[204:205], v15 offset:8192
    ds_read_b64_tr_b16 v[206:207], v15 offset:8704
    v_mfma_f32_16x16x32_bf16 v[64:67], v[140:143], v[128:131], v[64:67]
    buffer_load_dwordx4 v10, s[12:15], s16 offen lds
    ds_read_b128 v[192:195], v12 offset:12288
    ds_read_b128 v[196:199], v12 offset:14336
    v_mfma_f32_16x16x32_bf16 v[68:71], v[140:143], v[132:135], v[68:71]
    buffer_load_dwordx4 v10, s[12:15], s16 offen offset:1024 lds
    s_add_u32 s16, s16, 2048
    ds_read_b128 v[200:203], v12 offset:16384
    ds_read_b64_tr_b16 v[220:221], v15 offset:12288
    v_mfma_f32_16x16x32_bf16 v[72:75], v[140:143], v[136:139], v[72:75]
    s_add_u32 m0, s19, 0x22000
    ds_read_b64_tr_b16 v[222:223], v15 offset:12800
    v_mfma_f32_16x16x32_bf16 v[64:67], v[156:159], v[144:147], v[64:67]
    buffer_load_dwordx4 v20, s[44:47], s17 offen lds
    s_add_u32 s17, s17, 81920
    ds_read_b128 v[208:211], v12 offset:13312
    v_mfma_f32_16x16x32_bf16 v[68:71], v[156:159], v[148:151], v[68:71]
    ds_read_b128 v[212:215], v12 offset:15360
    v_mfma_f32_16x16x32_bf16 v[72:75], v[156:159], v[152:155], v[72:75]
    ds_read_b128 v[216:219], v12 offset:17408
    s_waitcnt vmcnt(6) lgkmcnt(0)
    s_barrier
    v_mfma_f32_16x16x32_bf16 v[64:67], v[172:175], v[160:163], v[64:67]
    s_add_u32 m0, s18, 0x0
    ds_read_b64_tr_b16 v[108:109], v15 offset:16384
    ds_read_b64_tr_b16 v[110:111], v15 offset:16896
    v_mfma_f32_16x16x32_bf16 v[68:71], v[172:175], v[164:167], v[68:71]
    buffer_load_dwordx4 v10, s[12:15], s16 offen lds
    ds_read_b128 v[96:99], v12 offset:24576
    ds_read_b128 v[100:103], v12 offset:26624
    v_mfma_f32_16x16x32_bf16 v[72:75], v[172:175], v[168:171], v[72:75]
    buffer_load_dwordx4 v10, s[12:15], s16 offen offset:1024 lds
    s_add_u32 s16, s16, 2048
    ds_read_b128 v[104:107], v12 offset:28672
    ds_read_b64_tr_b16 v[124:125], v15 offset:20480
    v_mfma_f32_16x16x32_bf16 v[64:67], v[188:191], v[176:179], v[64:67]
    s_add_u32 m0, s19, 0x18000
    ds_read_b64_tr_b16 v[126:127], v15 offset:20992
    ds_read_b128 v[112:115], v12 offset:25600
    v_mfma_f32_16x16x32_bf16 v[68:71], v[188:191], v[180:183], v[68:71]
    buffer_load_dwordx4 v20, s[44:47], s17 offen lds
    s_add_u32 s17, s17, 81920
    ds_read_b128 v[116:119], v12 offset:27648
    ds_read_b128 v[120:123], v12 offset:29696
    v_mfma_f32_16x16x32_bf16 v[72:75], v[188:191], v[184:187], v[72:75]
    s_add_u32 m0, s18, 0x3000
    ds_read_b64_tr_b16 v[140:141], v15 offset:24576
    ds_read_b64_tr_b16 v[142:143], v15 offset:25088
    v_mfma_f32_16x16x32_bf16 v[64:67], v[204:207], v[192:195], v[64:67]
    buffer_load_dwordx4 v10, s[12:15], s16 offen lds
    ds_read_b128 v[128:131], v12 offset:36864
    ds_read_b128 v[132:135], v12 offset:38912
    v_mfma_f32_16x16x32_bf16 v[68:71], v[204:207], v[196:199], v[68:71]
    buffer_load_dwordx4 v10, s[12:15], s16 offen offset:1024 lds
    s_add_u32 s16, s16, 2048
    ds_read_b128 v[136:139], v12 offset:40960
    ds_read_b64_tr_b16 v[156:157], v15 offset:28672
    v_mfma_f32_16x16x32_bf16 v[72:75], v[204:207], v[200:203], v[72:75]
    s_add_u32 m0, s19, 0x1a000
    ds_read_b64_tr_b16 v[158:159], v15 offset:29184
    v_mfma_f32_16x16x32_bf16 v[64:67], v[220:223], v[208:211], v[64:67]
    buffer_load_dwordx4 v20, s[44:47], s17 offen lds
    s_add_u32 s17, s17, 81920
    ds_read_b128 v[144:147], v12 offset:37888
    v_mfma_f32_16x16x32_bf16 v[68:71], v[220:223], v[212:215], v[68:71]
    ds_read_b128 v[148:151], v12 offset:39936
    v_mfma_f32_16x16x32_bf16 v[72:75], v[220:223], v[216:219], v[72:75]
    ds_read_b128 v[152:155], v12 offset:41984
    s_waitcnt vmcnt(6) lgkmcnt(0)
    s_barrier
    v_mfma_f32_16x16x32_bf16 v[64:67], v[108:111], v[96:99], v[64:67]
    s_add_u32 m0, s18, 0x6000
    ds_read_b64_tr_b16 v[172:173], v15 offset:32768
    ds_read_b64_tr_b16 v[174:175], v15 offset:33280
    v_mfma_f32_16x16x32_bf16 v[68:71], v[108:111], v[100:103], v[68:71]
    buffer_load_dwordx4 v10, s[12:15], s16 offen lds
    ds_read_b128 v[160:163], v12 offset:49152
    ds_read_b128 v[164:167], v12 offset:51200
    v_mfma_f32_16x16x32_bf16 v[72:75], v[108:111], v[104:107], v[72:75]
    buffer_load_dwordx4 v10, s[12:15], s16 offen offset:1024 lds
    s_add_u32 s16, s16, 2048
    ds_read_b128 v[168:171], v12 offset:53248
    ds_read_b64_tr_b16 v[188:189], v15 offset:36864
    v_mfma_f32_16x16x32_bf16 v[64:67], v[124:127], v[112:115], v[64:67]
    s_add_u32 m0, s19, 0x1c000
    ds_read_b64_tr_b16 v[190:191], v15 offset:37376
    ds_read_b128 v[176:179], v12 offset:50176
    v_mfma_f32_16x16x32_bf16 v[68:71], v[124:127], v[116:119], v[68:71]
    buffer_load_dwordx4 v20, s[44:47], s17 offen lds
    s_add_u32 s17, s17, 81920
    ds_read_b128 v[180:183], v12 offset:52224
    ds_read_b128 v[184:187], v12 offset:54272
    v_mfma_f32_16x16x32_bf16 v[72:75], v[124:127], v[120:123], v[72:75]
    s_add_u32 m0, s18, 0x9000
    ds_read_b64_tr_b16 v[204:205], v15 offset:40960
    ds_read_b64_tr_b16 v[206:207], v15 offset:41472
    v_mfma_f32_16x16x32_bf16 v[64:67], v[140:143], v[128:131], v[64:67]
    buffer_load_dwordx4 v10, s[12:15], s16 offen lds
    ds_read_b128 v[192:195], v12 offset:61440
    ds_read_b128 v[196:199], v12 offset:63488
    v_mfma_f32_16x16x32_bf16 v[68:71], v[140:143], v[132:135], v[68:71]
    buffer_load_dwordx4 v10, s[12:15], s16 offen offset:1024 lds
    s_add_u32 s16, s16, 2048
    ds_read_b128 v[200:203], v13 offset:0
    ds_read_b64_tr_b16 v[220:221], v15 offset:45056
    v_mfma_f32_16x16x32_bf16 v[72:75], v[140:143], v[136:139], v[72:75]
    s_add_u32 m0, s19, 0x1e000
    ds_read_b64_tr_b16 v[222:223], v15 offset:45568
    v_mfma_f32_16x16x32_bf16 v[64:67], v[156:159], v[144:147], v[64:67]
    buffer_load_dwordx4 v20, s[44:47], s17 offen lds
    s_add_u32 s17, s17, 81920
    ds_read_b128 v[208:211], v12 offset:62464
    v_mfma_f32_16x16x32_bf16 v[68:71], v[156:159], v[148:151], v[68:71]
    ds_read_b128 v[212:215], v12 offset:64512
    v_mfma_f32_16x16x32_bf16 v[72:75], v[156:159], v[152:155], v[72:75]
    ds_read_b128 v[216:219], v13 offset:1024
    s_waitcnt vmcnt(6) lgkmcnt(0)
    s_barrier
    v_mfma_f32_16x16x32_bf16 v[64:67], v[172:175], v[160:163], v[64:67]
    s_add_u32 m0, s18, 0xc000
    ds_read_b64_tr_b16 v[108:109], v15 offset:0
    ds_read_b64_tr_b16 v[110:111], v15 offset:512
    v_mfma_f32_16x16x32_bf16 v[68:71], v[172:175], v[164:167], v[68:71]
    buffer_load_dwordx4 v10, s[12:15], s16 offen lds
    ds_read_b128 v[96:99], v12 offset:0
    ds_read_b128 v[100:103], v12 offset:2048
    v_mfma_f32_16x16x32_bf16 v[72:75], v[172:175], v[168:171], v[72:75]
    buffer_load_dwordx4 v10, s[12:15], s16 offen offset:1024 lds
    s_add_u32 s16, s16, 2048
    ds_read_b128 v[104:107], v12 offset:4096
    ds_read_b64_tr_b16 v[124:125], v15 offset:4096
    v_mfma_f32_16x16x32_bf16 v[64:67], v[188:191], v[176:179], v[64:67]
    s_add_u32 m0, s19, 0x20000
    ds_read_b64_tr_b16 v[126:127], v15 offset:4608
    ds_read_b128 v[112:115], v12 offset:1024
    v_mfma_f32_16x16x32_bf16 v[68:71], v[188:191], v[180:183], v[68:71]
    buffer_load_dwordx4 v20, s[44:47], s17 offen lds
    s_add_u32 s17, s17, 81920
    ds_read_b128 v[116:119], v12 offset:3072
    ds_read_b128 v[120:123], v12 offset:5120
    v_mfma_f32_16x16x32_bf16 v[72:75], v[188:191], v[184:187], v[72:75]
    s_add_u32 m0, s18, 0xf000
    ds_read_b64_tr_b16 v[140:141], v15 offset:8192
    ds_read_b64_tr_b16 v[142:143], v15 offset:8704
    v_mfma_f32_16x16x32_bf16 v[64:67], v[204:207], v[192:195], v[64:67]
    buffer_load_dwordx4 v10, s[12:15], s16 offen lds
    ds_read_b128 v[128:131], v12 offset:12288
    ds_read_b128 v[132:135], v12 offset:14336
    v_mfma_f32_16x16x32_bf16 v[68:71], v[204:207], v[196:199], v[68:71]
    buffer_load_dwordx4 v10, s[12:15], s16 offen offset:1024 lds
    s_add_u32 s16, s16, 2048
    ds_read_b128 v[136:139], v12 offset:16384
    ds_read_b64_tr_b16 v[156:157], v15 offset:12288
    v_mfma_f32_16x16x32_bf16 v[72:75], v[204:207], v[200:203], v[72:75]
    s_add_u32 m0, s19, 0x22000
    ds_read_b64_tr_b16 v[158:159], v15 offset:12800
    v_mfma_f32_16x16x32_bf16 v[64:67], v[220:223], v[208:211], v[64:67]
    buffer_load_dwordx4 v20, s[44:47], s17 offen lds
    s_add_u32 s17, s17, 81920
    ds_read_b128 v[144:147], v12 offset:13312
    v_mfma_f32_16x16x32_bf16 v[68:71], v[220:223], v[212:215], v[68:71]
    ds_read_b128 v[148:151], v12 offset:15360
    v_mfma_f32_16x16x32_bf16 v[72:75], v[220:223], v[216:219], v[72:75]
    ds_read_b128 v[152:155], v12 offset:17408
    s_waitcnt vmcnt(6) lgkmcnt(0)
    s_barrier
    v_mfma_f32_16x16x32_bf16 v[64:67], v[108:111], v[96:99], v[64:67]
    s_add_u32 m0, s18, 0x0
    ds_read_b64_tr_b16 v[172:173], v15 offset:16384
    ds_read_b64_tr_b16 v[174:175], v15 offset:16896
    v_mfma_f32_16x16x32_bf16 v[68:71], v[108:111], v[100:103], v[68:71]
    buffer_load_dwordx4 v10, s[12:15], s16 offen lds
    ds_read_b128 v[160:163], v12 offset:24576
    ds_read_b128 v[164:167], v12 offset:26624
    v_mfma_f32_16x16x32_bf16 v[72:75], v[108:111], v[104:107], v[72:75]
    buffer_load_dwordx4 v10, s[12:15], s16 offen offset:1024 lds
    s_add_u32 s16, s16, 2048
    ds_read_b128 v[168:171], v12 offset:28672
    ds_read_b64_tr_b16 v[188:189], v15 offset:20480
    v_mfma_f32_16x16x32_bf16 v[64:67], v[124:127], v[112:115], v[64:67]
    s_add_u32 m0, s19, 0x18000
    ds_read_b64_tr_b16 v[190:191], v15 offset:20992
    ds_read_b128 v[176:179], v12 offset:25600
    v_mfma_f32_16x16x32_bf16 v[68:71], v[124:127], v[116:119], v[68:71]
    buffer_load_dwordx4 v20, s[44:47], s17 offen lds
    s_add_u32 s17, s17, 81920
    ds_read_b128 v[180:183], v12 offset:27648
    ds_read_b128 v[184:187], v12 offset:29696
    v_mfma_f32_16x16x32_bf16 v[72:75], v[124:127], v[120:123], v[72:75]
    s_add_u32 m0, s18, 0x3000
    ds_read_b64_tr_b16 v[204:205], v15 offset:24576
    ds_read_b64_tr_b16 v[206:207], v15 offset:25088
    v_mfma_f32_16x16x32_bf16 v[64:67], v[140:143], v[128:131], v[64:67]
    buffer_load_dwordx4 v10, s[12:15], s16 offen lds
    ds_read_b128 v[192:195], v12 offset:36864
    ds_read_b128 v[196:199], v12 offset:38912
    v_mfma_f32_16x16x32_bf16 v[68:71], v[140:143], v[132:135], v[68:71]
    buffer_load_dwordx4 v10, s[12:15], s16 offen offset:1024 lds
    s_add_u32 s16, s16, 2048
    ds_read_b128 v[200:203], v12 offset:40960
    ds_read_b64_tr_b16 v[220:221], v15 offset:28672
    v_mfma_f32_16x16x32_bf16 v[72:75], v[140:143], v[136:139], v[72:75]
    s_add_u32 m0, s19, 0x1a000
    ds_read_b64_tr_b16 v[222:223], v15 offset:29184
    v_mfma_f32_16x16x32_bf16 v[64:67], v[156:159], v[144:147], v[64:67]
    buffer_load_dwordx4 v20, s[44:47], s17 offen lds
    s_add_u32 s17, s17, 81920
    ds_read_b128 v[208:211], v12 offset:37888
    v_mfma_f32_16x16x32_bf16 v[68:71], v[156:159], v[148:151], v[68:71]
    ds_read_b128 v[212:215], v12 offset:39936
    v_mfma_f32_16x16x32_bf16 v[72:75], v[156:159], v[152:155], v[72:75]
    ds_read_b128 v[216:219], v12 offset:41984
    s_waitcnt vmcnt(6) lgkmcnt(0)
    s_barrier
    v_mov_b32 v22, 0
    buffer_load_dword v22, v24, s[60:63], 0 offen sc1
    v_mfma_f32_16x16x32_bf16 v[64:67], v[172:175], v[160:163], v[64:67]
    s_add_u32 m0, s18, 0x6000
    ds_read_b64_tr_b16 v[108:109], v15 offset:32768
    ds_read_b64_tr_b16 v[110:111], v15 offset:33280
    v_mfma_f32_16x16x32_bf16 v[68:71], v[172:175], v[164:167], v[68:71]
    buffer_load_dwordx4 v10, s[12:15], s16 offen lds
    ds_read_b128 v[96:99], v12 offset:49152
    ds_read_b128 v[100:103], v12 offset:51200
    v_mfma_f32_16x16x32_bf16 v[72:75], v[172:175], v[168:171], v[72:75]
    buffer_load_dwordx4 v10, s[12:15], s16 offen offset:1024 lds
    s_add_u32 s16, s16, 2048
    ds_read_b128 v[104:107], v12 offset:53248
    ds_read_b64_tr_b16 v[124:125], v15 offset:36864
    v_mfma_f32_16x16x32_bf16 v[64:67], v[188:191], v[176:179], v[64:67]
    s_add_u32 m0, s19, 0x1c000
    ds_read_b64_tr_b16 v[126:127], v15 offset:37376
    ds_read_b128 v[112:115], v12 offset:50176
    v_mfma_f32_16x16x32_bf16 v[68:71], v[188:191], v[180:183], v[68:71]
    buffer_load_dwordx4 v20, s[44:47], s17 offen lds
    s_add_u32 s17, s17, 81920
    ds_read_b128 v[116:119], v12 offset:52224
    ds_read_b128 v[120:123], v12 offset:54272
    v_mfma_f32_16x16x32_bf16 v[72:75], v[188:191], v[184:187], v[72:75]
    s_add_u32 m0, s18, 0x9000
    ds_read_b64_tr_b16 v[140:141], v15 offset:40960
    ds_read_b64_tr_b16 v[142:143], v15 offset:41472
    v_mfma_f32_16x16x32_bf16 v[64:67], v[204:207], v[192:195], v[64:67]
    buffer_load_dwordx4 v10, s[12:15], s16 offen lds
    ds_read_b128 v[128:131], v12 offset:61440
    ds_read_b128 v[132:135], v12 offset:63488
    v_mfma_f32_16x16x32_bf16 v[68:71], v[204:207], v[196:199], v[68:71]
    buffer_load_dwordx4 v10, s[12:15], s16 offen offset:1024 lds
    s_add_u32 s16, s16, 2048
    ds_read_b128 v[136:139], v13 offset:0
    ds_read_b64_tr_b16 v[156:157], v15 offset:45056
    v_mfma_f32_16x16x32_bf16 v[72:75], v[204:207], v[200:203], v[72:75]
    s_add_u32 m0, s19, 0x1e000
    ds_read_b64_tr_b16 v[158:159], v15 offset:45568
    v_mfma_f32_16x16x32_bf16 v[64:67], v[220:223], v[208:211], v[64:67]
    buffer_load_dwordx4 v20, s[44:47], s17 offen lds
    s_add_u32 s17, s17, 81920
    ds_read_b128 v[144:147], v12 offset:62464
    v_mfma_f32_16x16x32_bf16 v[68:71], v[220:223], v[212:215], v[68:71]
    ds_read_b128 v[148:151], v12 offset:64512
    v_mfma_f32_16x16x32_bf16 v[72:75], v[220:223], v[216:219], v[72:75]
    ds_read_b128 v[152:155], v13 offset:1024
    s_waitcnt vmcnt(6) lgkmcnt(0)
    s_barrier
    v_mfma_f32_16x16x32_bf16 v[64:67], v[108:111], v[96:99], v[64:67]
    s_add_u32 m0, s18, 0xc000
    ds_read_b64_tr_b16 v[172:173], v15 offset:0
    ds_read_b64_tr_b16 v[174:175], v15 offset:512
    v_mfma_f32_16x16x32_bf16 v[68:71], v[108:111], v[100:103], v[68:71]
    buffer_load_dwordx4 v10, s[12:15], s16 offen lds
    ds_read_b128 v[160:163], v12 offset:0
    ds_read_b128 v[164:167], v12 offset:2048
    v_mfma_f32_16x16x32_bf16 v[72:75], v[108:111], v[104:107], v[72:75]
    buffer_load_dwordx4 v10, s[12:15], s16 offen offset:1024 lds
    s_add_u32 s16, s16, 2048
    ds_read_b128 v[168:171], v12 offset:4096
    ds_read_b64_tr_b16 v[188:189], v15 offset:4096
    v_mfma_f32_16x16x32_bf16 v[64:67], v[124:127], v[112:115], v[64:67]
    s_add_u32 m0, s19, 0x20000
    ds_read_b64_tr_b16 v[190:191], v15 offset:4608
    ds_read_b128 v[176:179], v12 offset:1024
    v_mfma_f32_16x16x32_bf16 v[68:71], v[124:127], v[116:119], v[68:71]
    buffer_load_dwordx4 v20, s[44:47], s17 offen lds
    s_add_u32 s17, s17, 81920
    ds_read_b128 v[180:183], v12 offset:3072
    ds_read_b128 v[184:187], v12 offset:5120
    v_mfma_f32_16x16x32_bf16 v[72:75], v[124:127], v[120:123], v[72:75]
    s_add_u32 m0, s18, 0xf000
    ds_read_b64_tr_b16 v[204:205], v15 offset:8192
    ds_read_b64_tr_b16 v[206:207], v15 offset:8704
    v_mfma_f32_16x16x32_bf16 v[64:67], v[140:143], v[128:131], v[64:67]
    buffer_load_dwordx4 v10, s[12:15], s16 offen lds
    ds_read_b128 v[192:195], v12 offset:12288
    ds_read_b128 v[196:199], v12 offset:14336
    v_mfma_f32_16x16x32_bf16 v[68:71], v[140:143], v[132:135], v[68:71]
    buffer_load_dwordx4 v10, s[12:15], s16 offen offset:1024 lds
    s_add_u32 s16, s16, 2048
    ds_read_b128 v[200:203], v12 offset:16384
    ds_read_b64_tr_b16 v[220:221], v15 offset:12288
    v_mfma_f32_16x16x32_bf16 v[72:75], v[140:143], v[136:139], v[72:75]
    s_add_u32 m0, s19, 0x22000
    ds_read_b64_tr_b16 v[222:223], v15 offset:12800
    v_mfma_f32_16x16x32_bf16 v[64:67], v[156:159], v[144:147], v[64:67]
    buffer_load_dwordx4 v20, s[44:47], s17 offen lds
    s_add_u32 s17, s17, 81920
    ds_read_b128 v[208:211], v12 offset:13312
    v_mfma_f32_16x16x32_bf16 v[68:71], v[156:159], v[148:151], v[68:71]
    ds_read_b128 v[212:215], v12 offset:15360
    v_mfma_f32_16x16x32_bf16 v[72:75], v[156:159], v[152:155], v[72:75]
    ds_read_b128 v[216:219], v12 offset:17408
    s_cmp_lg_u32 s20, 0
    s_cbranch_scc1 L_p2ok_al
    v_cmp_gt_u32 s[58:59], 0x40000000, v24
    s_mov_b32 s21, 0
    s_branch L_p2chk_al
L_p2poll_al:
    buffer_load_dword v22, v24, s[60:63], 0 offen sc1
    s_waitcnt vmcnt(0)
L_p2chk_al:
    v_cmp_eq_u32 vcc, 0, v22
    s_add_u32 s21, s21, 1
    s_nop 2
    s_and_b64 vcc, vcc, s[58:59]
    s_cbranch_scc0 L_p2ok_al
    s_cmp_ge_u32 s21, 0x20000
    s_cbranch_scc1 L_p2ok_al
    s_sleep 2
    s_cmp_lg_u64 vcc, s[58:59]
    s_cbranch_scc1 L_p2poll_al
    s_sleep 30
    s_branch L_p2poll_al
L_p2ok_al:
    s_waitcnt vmcnt(6) lgkmcnt(0)
    s_barrier
    v_mfma_f32_16x16x32_bf16 v[64:67], v[172:175], v[160:163], v[64:67]
    s_add_u32 m0, s18, 0x0
    ds_read_b64_tr_b16 v[108:109], v15 offset:16384
    ds_read_b64_tr_b16 v[110:111], v15 offset:16896
    v_mfma_f32_16x16x32_bf16 v[68:71], v[172:175], v[164:167], v[68:71]
    buffer_load_dwordx4 v10, s[12:15], s16 offen lds
    ds_read_b128 v[96:99], v12 offset:24576
    ds_read_b128 v[100:103], v12 offset:26624
    v_mfma_f32_16x16x32_bf16 v[72:75], v[172:175], v[168:171], v[72:75]
    buffer_load_dwordx4 v10, s[12:15], s16 offen offset:1024 lds
    s_add_u32 s16, s16, 2048
    ds_read_b128 v[104:107], v12 offset:28672
    ds_read_b64_tr_b16 v[124:125], v15 offset:20480
    v_mfma_f32_16x16x32_bf16 v[64:67], v[188:191], v[176:179], v[64:67]
    s_add_u32 m0, s19, 0x18000
    ds_read_b64_tr_b16 v[126:127], v15 offset:20992
    ds_read_b128 v[112:115], v12 offset:25600
    v_mfma_f32_16x16x32_bf16 v[68:71], v[188:191], v[180:183], v[68:71]
    buffer_load_dwordx4 v20, s[44:47], s17 offen lds
    s_add_u32 s17, s17, 81920
    ds_read_b128 v[116:119], v12 offset:27648
    ds_read_b128 v[120:123], v12 offset:29696
    v_mfma_f32_16x16x32_bf16 v[72:75], v[188:191], v[184:187], v[72:75]
    s_add_u32 m0, s18, 0x3000
    ds_read_b64_tr_b16 v[140:141], v15 offset:24576
    ds_read_b64_tr_b16 v[142:143], v15 offset:25088
    v_mfma_f32_16x16x32_bf16 v[64:67], v[204:207], v[192:195], v[64:67]
    buffer_load_dwordx4 v10, s[12:15], s16 offen lds
    ds_read_b128 v[128:131], v12 offset:36864
    ds_read_b128 v[132:135], v12 offset:38912
    v_mfma_f32_16x16x32_bf16 v[68:71], v[204:207], v[196:199], v[68:71]
    buffer_load_dwordx4 v10, s[12:15], s16 offen offset:1024 lds
    s_add_u32 s16, s16, 2048
    ds_read_b128 v[136:139], v12 offset:40960
    ds_read_b64_tr_b16 v[156:157], v15 offset:28672
    v_mfma_f32_16x16x32_bf16 v[72:75], v[204:207], v[200:203], v[72:75]
    s_add_u32 m0, s19, 0x1a000
    ds_read_b64_tr_b16 v[158:159], v15 offset:29184
    v_mfma_f32_16x16x32_bf16 v[64:67], v[220:223], v[208:211], v[64:67]
    buffer_load_dwordx4 v20, s[44:47], s17 offen lds
    s_add_u32 s17, s17, 81920
    ds_read_b128 v[144:147], v12 offset:37888
    v_mfma_f32_16x16x32_bf16 v[68:71], v[220:223], v[212:215], v[68:71]
    ds_read_b128 v[148:151], v12 offset:39936
    v_mfma_f32_16x16x32_bf16 v[72:75], v[220:223], v[216:219], v[72:75]
    ds_read_b128 v[152:155], v12 offset:41984
    s_waitcnt vmcnt(6) lgkmcnt(0)
    s_barrier
    v_mfma_f32_16x16x32_bf16 v[64:67], v[108:111], v[96:99], v[64:67]
    s_add_u32 m0, s18, 0x6000
    ds_read_b64_tr_b16 v[172:173], v15 offset:32768
    ds_read_b64_tr_b16 v[174:175], v15 offset:33280
    v_mfma_f32_16x16x32_bf16 v[68:71], v[108:111], v[100:103], v[68:71]
    buffer_load_dwordx4 v10, s[12:15], s16 offen lds
    ds_read_b128 v[160:163], v12 offset:49152
    ds_read_b128 v[164:167], v12 offset:51200
    v_mfma_f32_16x16x32_bf16 v[72:75], v[108:111], v[104:107], v[72:75]
    buffer_load_dwordx4 v10, s[12:15], s16 offen offset:1024 lds
    s_add_u32 s16, s16, 2048
    ds_read_b128 v[168:171], v12 offset:53248
    ds_read_b64_tr_b16 v[188:189], v15 offset:36864
    v_mfma_f32_16x16x32_bf16 v[64:67], v[124:127], v[112:115], v[64:67]
    s_add_u32 m0, s19, 0x1c000
    ds_read_b64_tr_b16 v[190:191], v15 offset:37376
    ds_read_b128 v[176:179], v12 offset:50176
    v_mfma_f32_16x16x32_bf16 v[68:71], v[124:127], v[116:119], v[68:71]
    buffer_load_dwordx4 v20, s[44:47], s17 offen lds
    s_add_u32 s17, s17, 81920
    ds_read_b128 v[180:183], v12 offset:52224
    ds_read_b128 v[184:187], v12 offset:54272
    v_mfma_f32_16x16x32_bf16 v[72:75], v[124:127], v[120:123], v[72:75]
    s_mov_b32 s16, 0
    s_add_u32 m0, s18, 0x9000
    ds_read_b64_tr_b16 v[204:205], v15 offset:40960
    ds_read_b64_tr_b16 v[206:207], v15 offset:41472
    v_mfma_f32_16x16x32_bf16 v[64:67], v[140:143], v[128:131], v[64:67]
    buffer_load_dwordx4 v10, s[12:15], s16 offen lds
    ds_read_b128 v[192:195], v12 offset:61440
    ds_read_b128 v[196:199], v12 offset:63488
    v_mfma_f32_16x16x32_bf16 v[68:71], v[140:143], v[132:135], v[68:71]
    buffer_load_dwordx4 v10, s[12:15], s16 offen offset:1024 lds
    s_add_u32 s16, s16, 2048
    ds_read_b128 v[200:203], v13 offset:0
    ds_read_b64_tr_b16 v[220:221], v15 offset:45056
    v_mfma_f32_16x16x32_bf16 v[72:75], v[140:143], v[136:139], v[72:75]
    s_mov_b32 s17, 0
    s_add_u32 m0, s19, 0x1e000
    ds_read_b64_tr_b16 v[222:223], v15 offset:45568
    v_mfma_f32_16x16x32_bf16 v[64:67], v[156:159], v[144:147], v[64:67]
    buffer_load_dwordx4 v20, s[48:51], s17 offen lds
    s_add_u32 s17, s17, 81920
    ds_read_b128 v[208:211], v12 offset:62464
    v_mfma_f32_16x16x32_bf16 v[68:71], v[156:159], v[148:151], v[68:71]
    ds_read_b128 v[212:215], v12 offset:64512
    v_mfma_f32_16x16x32_bf16 v[72:75], v[156:159], v[152:155], v[72:75]
    ds_read_b128 v[216:219], v13 offset:1024
    s_waitcnt vmcnt(6) lgkmcnt(0)
    s_barrier
    v_mfma_f32_16x16x32_bf16 v[64:67], v[172:175], v[160:163], v[64:67]
    s_add_u32 m0, s18, 0xc000
    ds_read_b64_tr_b16 v[108:109], v15 offset:0
    ds_read_b64_tr_b16 v[110:111], v15 offset:512
    v_mfma_f32_16x16x32_bf16 v[68:71], v[172:175], v[164:167], v[68:71]
    buffer_load_dwordx4 v10, s[12:15], s16 offen lds
    ds_read_b128 v[96:99], v12 offset:0
    ds_read_b128 v[100:103], v12 offset:2048
    v_mfma_f32_16x16x32_bf16 v[72:75], v[172:175], v[168:171], v[72:75]
    buffer_load_dwordx4 v10, s[12:15], s16 offen offset:1024 lds
    s_add_u32 s16, s16, 2048
    ds_read_b128 v[104:107], v12 offset:4096
    ds_read_b64_tr_b16 v[124:125], v15 offset:4096
    v_mfma_f32_16x16x32_bf16 v[64:67], v[188:191], v[176:179], v[64:67]
    s_add_u32 m0, s19, 0x20000
    ds_read_b64_tr_b16 v[126:127], v15 offset:4608
    ds_read_b128 v[112:115], v12 offset:1024
    v_mfma_f32_16x16x32_bf16 v[68:71], v[188:191], v[180:183], v[68:71]
    buffer_load_dwordx4 v20, s[48:51], s17 offen lds
    s_add_u32 s17, s17, 81920
    ds_read_b128 v[116:119], v12 offset:3072
    ds_read_b128 v[120:123], v12 offset:5120
    v_mfma_f32_16x16x32_bf16 v[72:75], v[188:191], v[184:187], v[72:75]
    s_add_u32 m0, s18, 0xf000
    ds_read_b64_tr_b16 v[140:141], v15 offset:8192
    ds_read_b64_tr_b16 v[142:143], v15 offset:8704
    v_mfma_f32_16x16x32_bf16 v[64:67], v[204:207], v[192:195], v[64:67]
    buffer_load_dwordx4 v10, s[12:15], s16 offen lds
    ds_read_b128 v[128:131], v12 offset:12288
    ds_read_b128 v[132:135], v12 offset:14336
    v_mfma_f32_16x16x32_bf16 v[68:71], v[204:207], v[196:199], v[68:71]
    buffer_load_dwordx4 v10, s[12:15], s16 offen offset:1024 lds
    s_add_u32 s16, s16, 2048
    ds_read_b128 v[136:139], v12 offset:16384
    ds_read_b64_tr_b16 v[156:157], v15 offset:12288
    v_mfma_f32_16x16x32_bf16 v[72:75], v[204:207], v[200:203], v[72:75]
    s_add_u32 m0, s19, 0x22000
    ds_read_b64_tr_b16 v[158:159], v15 offset:12800
    v_mfma_f32_16x16x32_bf16 v[64:67], v[220:223], v[208:211], v[64:67]
    buffer_load_dwordx4 v20, s[48:51], s17 offen lds
    s_add_u32 s17, s17, 81920
    ds_read_b128 v[144:147], v12 offset:13312
    v_mfma_f32_16x16x32_bf16 v[68:71], v[220:223], v[212:215], v[68:71]
    ds_read_b128 v[148:151], v12 offset:15360
    v_mfma_f32_16x16x32_bf16 v[72:75], v[220:223], v[216:219], v[72:75]
    ds_read_b128 v[152:155], v12 offset:17408
    s_waitcnt vmcnt(6) lgkmcnt(0)
    s_barrier
    v_mfma_f32_16x16x32_bf16 v[64:67], v[108:111], v[96:99], v[64:67]
    s_add_u32 m0, s18, 0x0
    ds_read_b64_tr_b16 v[172:173], v15 offset:16384
    ds_read_b64_tr_b16 v[174:175], v15 offset:16896
    v_mfma_f32_16x16x32_bf16 v[68:71], v[108:111], v[100:103], v[68:71]
    buffer_load_dwordx4 v10, s[12:15], s16 offen lds
    ds_read_b128 v[160:163], v12 offset:24576
    ds_read_b128 v[164:167], v12 offset:26624
    v_mfma_f32_16x16x32_bf16 v[72:75], v[108:111], v[104:107], v[72:75]
    buffer_load_dwordx4 v10, s[12:15], s16 offen offset:1024 lds
    s_add_u32 s16, s16, 2048
    ds_read_b128 v[168:171], v12 offset:28672
    ds_read_b64_tr_b16 v[188:189], v15 offset:20480
    v_mfma_f32_16x16x32_bf16 v[64:67], v[124:127], v[112:115], v[64:67]
    s_add_u32 m0, s19, 0x18000
    ds_read_b64_tr_b16 v[190:191], v15 offset:20992
    ds_read_b128 v[176:179], v12 offset:25600
    v_mfma_f32_16x16x32_bf16 v[68:71], v[124:127], v[116:119], v[68:71]
    buffer_load_dwordx4 v20, s[48:51], s17 offen lds
    s_add_u32 s17, s17, 81920
    ds_read_b128 v[180:183], v12 offset:27648
    ds_read_b128 v[184:187], v12 offset:29696
    v_mfma_f32_16x16x32_bf16 v[72:75], v[124:127], v[120:123], v[72:75]
    s_add_u32 m0, s18, 0x3000
    ds_read_b64_tr_b16 v[204:205], v15 offset:24576
    ds_read_b64_tr_b16 v[206:207], v15 offset:25088
    v_mfma_f32_16x16x32_bf16 v[64:67], v[140:143], v[128:131], v[64:67]
    buffer_load_dwordx4 v10, s[12:15], s16 offen lds
    ds_read_b128 v[192:195], v12 offset:36864
    ds_read_b128 v[196:199], v12 offset:38912
    v_mfma_f32_16x16x32_bf16 v[68:71], v[140:143], v[132:135], v[68:71]
    buffer_load_dwordx4 v10, s[12:15], s16 offen offset:1024 lds
    s_add_u32 s16, s16, 2048
    ds_read_b128 v[200:203], v12 offset:40960
    ds_read_b64_tr_b16 v[220:221], v15 offset:28672
    v_mfma_f32_16x16x32_bf16 v[72:75], v[140:143], v[136:139], v[72:75]
    s_add_u32 m0, s19, 0x1a000
    ds_read_b64_tr_b16 v[222:223], v15 offset:29184
    v_mfma_f32_16x16x32_bf16 v[64:67], v[156:159], v[144:147], v[64:67]
    buffer_load_dwordx4 v20, s[48:51], s17 offen lds
    s_add_u32 s17, s17, 81920
    ds_read_b128 v[208:211], v12 offset:37888
    v_mfma_f32_16x16x32_bf16 v[68:71], v[156:159], v[148:151], v[68:71]
    ds_read_b128 v[212:215], v12 offset:39936
    v_mfma_f32_16x16x32_bf16 v[72:75], v[156:159], v[152:155], v[72:75]
    ds_read_b128 v[216:219], v12 offset:41984
    s_waitcnt vmcnt(6) lgkmcnt(0)
    s_barrier
    v_mfma_f32_16x16x32_bf16 v[64:67], v[172:175], v[160:163], v[64:67]
    s_add_u32 m0, s18, 0x6000
    ds_read_b64_tr_b16 v[108:109], v15 offset:32768
    ds_read_b64_tr_b16 v[110:111], v15 offset:33280
    v_mfma_f32_16x16x32_bf16 v[68:71], v[172:175], v[164:167], v[68:71]
    buffer_load_dwordx4 v10, s[12:15], s16 offen lds
    ds_read_b128 v[96:99], v12 offset:49152
    ds_read_b128 v[100:103], v12 offset:51200
    v_mfma_f32_16x16x32_bf16 v[72:75], v[172:175], v[168:171], v[72:75]
    buffer_load_dwordx4 v10, s[12:15], s16 offen offset:1024 lds
    s_add_u32 s16, s16, 2048
    ds_read_b128 v[104:107], v12 offset:53248
    ds_read_b64_tr_b16 v[124:125], v15 offset:36864
    v_mfma_f32_16x16x32_bf16 v[64:67], v[188:191], v[176:179], v[64:67]
    s_add_u32 m0, s19, 0x1c000
    ds_read_b64_tr_b16 v[126:127], v15 offset:37376
    ds_read_b128 v[112:115], v12 offset:50176
    v_mfma_f32_16x16x32_bf16 v[68:71], v[188:191], v[180:183], v[68:71]
    buffer_load_dwordx4 v20, s[48:51], s17 offen lds
    s_add_u32 s17, s17, 81920
    ds_read_b128 v[116:119], v12 offset:52224
    ds_read_b128 v[120:123], v12 offset:54272
    v_mfma_f32_16x16x32_bf16 v[72:75], v[188:191], v[184:187], v[72:75]
    s_add_u32 m0, s18, 0x9000
    ds_read_b64_tr_b16 v[140:141], v15 offset:40960
    ds_read_b64_tr_b16 v[142:143], v15 offset:41472
    v_mfma_f32_16x16x32_bf16 v[64:67], v[204:207], v[192:195], v[64:67]
    buffer_load_dwordx4 v10, s[12:15], s16 offen lds
    ds_read_b128 v[128:131], v12 offset:61440
    ds_read_b128 v[132:135], v12 offset:63488
    v_mfma_f32_16x16x32_bf16 v[68:71], v[204:207], v[196:199], v[68:71]
    buffer_load_dwordx4 v10, s[12:15], s16 offen offset:1024 lds
    s_add_u32 s16, s16, 2048
    ds_read_b128 v[136:139], v13 offset:0
    ds_read_b64_tr_b16 v[156:157], v15 offset:45056
    v_mfma_f32_16x16x32_bf16 v[72:75], v[204:207], v[200:203], v[72:75]
    s_add_u32 m0, s19, 0x1e000
    ds_read_b64_tr_b16 v[158:159], v15 offset:45568
    v_mfma_f32_16x16x32_bf16 v[64:67], v[220:223], v[208:211], v[64:67]
    buffer_load_dwordx4 v20, s[48:51], s17 offen lds
    s_add_u32 s17, s17, 81920
    ds_read_b128 v[144:147], v12 offset:62464
    v_mfma_f32_16x16x32_bf16 v[68:71], v[220:223], v[212:215], v[68:71]
    ds_read_b128 v[148:151], v12 offset:64512
    v_mfma_f32_16x16x32_bf16 v[72:75], v[220:223], v[216:219], v[72:75]
    ds_read_b128 v[152:155], v13 offset:1024
    s_waitcnt vmcnt(6) lgkmcnt(0)
    s_barrier
    v_mfma_f32_16x16x32_bf16 v[64:67], v[108:111], v[96:99], v[64:67]
    s_add_u32 m0, s18, 0xc000
    ds_read_b64_tr_b16 v[172:173], v15 offset:0
    ds_read_b64_tr_b16 v[174:175], v15 offset:512
    v_mfma_f32_16x16x32_bf16 v[68:71], v[108:111], v[100:103], v[68:71]
    buffer_load_dwordx4 v10, s[12:15], s16 offen lds
    ds_read_b128 v[160:163], v12 offset:0
    ds_read_b128 v[164:167], v12 offset:2048
    v_mfma_f32_16x16x32_bf16 v[72:75], v[108:111], v[104:107], v[72:75]
    buffer_load_dwordx4 v10, s[12:15], s16 offen offset:1024 lds
    s_add_u32 s16, s16, 2048
    ds_read_b128 v[168:171], v12 offset:4096
    ds_read_b64_tr_b16 v[188:189], v15 offset:4096
    v_mfma_f32_16x16x32_bf16 v[64:67], v[124:127], v[112:115], v[64:67]
    s_add_u32 m0, s19, 0x20000
    ds_read_b64_tr_b16 v[190:191], v15 offset:4608
    ds_read_b128 v[176:179], v12 offset:1024
    v_mfma_f32_16x16x32_bf16 v[68:71], v[124:127], v[116:119], v[68:71]
    buffer_load_dwordx4 v20, s[48:51], s17 offen lds
    s_add_u32 s17, s17, 81920
    ds_read_b128 v[180:183], v12 offset:3072
    ds_read_b128 v[184:187], v12 offset:5120
    v_mfma_f32_16x16x32_bf16 v[72:75], v[124:127], v[120:123], v[72:75]
    s_add_u32 m0, s18, 0xf000
    ds_read_b64_tr_b16 v[204:205], v15 offset:8192
    ds_read_b64_tr_b16 v[206:207], v15 offset:8704
    v_mfma_f32_16x16x32_bf16 v[64:67], v[140:143], v[128:131], v[64:67]
    buffer_load_dwordx4 v10, s[12:15], s16 offen lds
    ds_read_b128 v[192:195], v12 offset:12288
    ds_read_b128 v[196:199], v12 offset:14336
    v_mfma_f32_16x16x32_bf16 v[68:71], v[140:143], v[132:135], v[68:71]
    buffer_load_dwordx4 v10, s[12:15], s16 offen offset:1024 lds
    s_add_u32 s16, s16, 2048
    ds_read_b128 v[200:203], v12 offset:16384
    ds_read_b64_tr_b16 v[220:221], v15 offset:12288
    v_mfma_f32_16x16x32_bf16 v[72:75], v[140:143], v[136:139], v[72:75]
    s_add_u32 m0, s19, 0x22000
    ds_read_b64_tr_b16 v[222:223], v15 offset:12800
    v_mfma_f32_16x16x32_bf16 v[64:67], v[156:159], v[144:147], v[64:67]
    buffer_load_dwordx4 v20, s[48:51], s17 offen lds
    s_add_u32 s17, s17, 81920
    ds_read_b128 v[208:211], v12 offset:13312
    v_mfma_f32_16x16x32_bf16 v[68:71], v[156:159], v[148:151], v[68:71]
    ds_read_b128 v[212:215], v12 offset:15360
    v_mfma_f32_16x16x32_bf16 v[72:75], v[156:159], v[152:155], v[72:75]
    ds_read_b128 v[216:219], v12 offset:17408
    s_waitcnt vmcnt(6) lgkmcnt(0)
    s_barrier
    v_mfma_f32_16x16x32_bf16 v[64:67], v[172:175], v[160:163], v[64:67]
    s_add_u32 m0, s18, 0x0
    ds_read_b64_tr_b16 v[108:109], v15 offset:16384
    ds_read_b64_tr_b16 v[110:111], v15 offset:16896
    v_mfma_f32_16x16x32_bf16 v[68:71], v[172:175], v[164:167], v[68:71]
    buffer_load_dwordx4 v10, s[12:15], s16 offen lds
    ds_read_b128 v[96:99], v12 offset:24576
    ds_read_b128 v[100:103], v12 offset:26624
    v_mfma_f32_16x16x32_bf16 v[72:75], v[172:175], v[168:171], v[72:75]
    buffer_load_dwordx4 v10, s[12:15], s16 offen offset:1024 lds
    s_add_u32 s16, s16, 2048
    ds_read_b128 v[104:107], v12 offset:28672
    ds_read_b64_tr_b16 v[124:125], v15 offset:20480
    v_mfma_f32_16x16x32_bf16 v[64:67], v[188:191], v[176:179], v[64:67]
    s_add_u32 m0, s19, 0x18000
    ds_read_b64_tr_b16 v[126:127], v15 offset:20992
    ds_read_b128 v[112:115], v12 offset:25600
    v_mfma_f32_16x16x32_bf16 v[68:71], v[188:191], v[180:183], v[68:71]
    buffer_load_dwordx4 v20, s[48:51], s17 offen lds
    s_add_u32 s17, s17, 81920
    ds_read_b128 v[116:119], v12 offset:27648
    ds_read_b128 v[120:123], v12 offset:29696
    v_mfma_f32_16x16x32_bf16 v[72:75], v[188:191], v[184:187], v[72:75]
    ds_read_b64_tr_b16 v[140:141], v15 offset:24576
    ds_read_b64_tr_b16 v[142:143], v15 offset:25088
    v_mfma_f32_16x16x32_bf16 v[64:67], v[204:207], v[192:195], v[64:67]
    ds_read_b128 v[128:131], v12 offset:36864
    ds_read_b128 v[132:135], v12 offset:38912
    v_mfma_f32_16x16x32_bf16 v[68:71], v[204:207], v[196:199], v[68:71]
    ds_read_b128 v[136:139], v12 offset:40960
    ds_read_b64_tr_b16 v[156:157], v15 offset:28672
    v_mfma_f32_16x16x32_bf16 v[72:75], v[204:207], v[200:203], v[72:75]
    ds_read_b64_tr_b16 v[158:159], v15 offset:29184
    v_mfma_f32_16x16x32_bf16 v[64:67], v[220:223], v[208:211], v[64:67]
    ds_read_b128 v[144:147], v12 offset:37888
    v_mfma_f32_16x16x32_bf16 v[68:71], v[220:223], v[212:215], v[68:71]
    ds_read_b128 v[148:151], v12 offset:39936
    v_mfma_f32_16x16x32_bf16 v[72:75], v[220:223], v[216:219], v[72:75]
    ds_read_b128 v[152:155], v12 offset:41984
    s_waitcnt vmcnt(3) lgkmcnt(0)
    s_barrier
    v_mfma_f32_16x16x32_bf16 v[64:67], v[108:111], v[96:99], v[64:67]
    ds_read_b64_tr_b16 v[172:173], v15 offset:32768
    ds_read_b64_tr_b16 v[174:175], v15 offset:33280
    v_mfma_f32_16x16x32_bf16 v[68:71], v[108:111], v[100:103], v[68:71]
    ds_read_b128 v[160:163], v12 offset:49152
    ds_read_b128 v[164:167], v12 offset:51200
    v_mfma_f32_16x16x32_bf16 v[72:75], v[108:111], v[104:107], v[72:75]
    ds_read_b128 v[168:171], v12 offset:53248
    ds_read_b64_tr_b16 v[188:189], v15 offset:36864
    v_mfma_f32_16x16x32_bf16 v[64:67], v[124:127], v[112:115], v[64:67]
    ds_read_b64_tr_b16 v[190:191], v15 offset:37376
    ds_read_b128 v[176:179], v12 offset:50176
    v_mfma_f32_16x16x32_bf16 v[68:71], v[124:127], v[116:119], v[68:71]
    ds_read_b128 v[180:183], v12 offset:52224
    ds_read_b128 v[184:187], v12 offset:54272
    v_mfma_f32_16x16x32_bf16 v[72:75], v[124:127], v[120:123], v[72:75]
    ds_read_b64_tr_b16 v[204:205], v15 offset:40960
    ds_read_b64_tr_b16 v[206:207], v15 offset:41472
    v_mfma_f32_16x16x32_bf16 v[64:67], v[140:143], v[128:131], v[64:67]
    ds_read_b128 v[192:195], v12 offset:61440
    ds_read_b128 v[196:199], v12 offset:63488
    v_mfma_f32_16x16x32_bf16 v[68:71], v[140:143], v[132:135], v[68:71]
    ds_read_b128 v[200:203], v13 offset:0
    ds_read_b64_tr_b16 v[220:221], v15 offset:45056
    v_mfma_f32_16x16x32_bf16 v[72:75], v[140:143], v[136:139], v[72:75]
    ds_read_b64_tr_b16 v[222:223], v15 offset:45568
    v_mfma_f32_16x16x32_bf16 v[64:67], v[156:159], v[144:147], v[64:67]
    ds_read_b128 v[208:211], v12 offset:62464
    v_mfma_f32_16x16x32_bf16 v[68:71], v[156:159], v[148:151], v[68:71]
    ds_read_b128 v[212:215], v12 offset:64512
    v_mfma_f32_16x16x32_bf16 v[72:75], v[156:159], v[152:155], v[72:75]
    ds_read_b128 v[216:219], v13 offset:1024
    s_waitcnt vmcnt(0) lgkmcnt(0)
    s_barrier
    v_mfma_f32_16x16x32_bf16 v[64:67], v[172:175], v[160:163], v[64:67]
    ds_read_b64_tr_b16 v[108:109], v15 offset:0
    v_mfma_f32_16x16x32_bf16 v[68:71], v[172:175], v[164:167], v[68:71]
    ds_read_b64_tr_b16 v[110:111], v15 offset:512
    v_mfma_f32_16x16x32_bf16 v[72:75], v[172:175], v[168:171], v[72:75]
    ds_read_b128 v[96:99], v12 offset:0
    v_mfma_f32_16x16x32_bf16 v[64:67], v[188:191], v[176:179], v[64:67]
    ds_read_b128 v[100:103], v12 offset:2048
    v_mfma_f32_16x16x32_bf16 v[68:71], v[188:191], v[180:183], v[68:71]
    ds_read_b128 v[104:107], v12 offset:4096
    v_mfma_f32_16x16x32_bf16 v[72:75], v[188:191], v[184:187], v[72:75]
    ds_read_b64_tr_b16 v[124:125], v15 offset:4096
    v_mfma_f32_16x16x32_bf16 v[64:67], v[204:207], v[192:195], v[64:67]
    ds_read_b64_tr_b16 v[126:127], v15 offset:4608
    v_mfma_f32_16x16x32_bf16 v[68:71], v[204:207], v[196:199], v[68:71]
    ds_read_b128 v[112:115], v12 offset:1024
    v_mfma_f32_16x16x32_bf16 v[72:75], v[204:207], v[200:203], v[72:75]
    ds_read_b128 v[116:119], v12 offset:3072
    v_mfma_f32_16x16x32_bf16 v[64:67], v[220:223], v[208:211], v[64:67]
    ds_read_b128 v[120:123], v12 offset:5120
    v_mfma_f32_16x16x32_bf16 v[68:71], v[220:223], v[212:215], v[68:71]
    v_mfma_f32_16x16x32_bf16 v[72:75], v[220:223], v[216:219], v[72:75]
    s_waitcnt lgkmcnt(0)
    s_barrier
    v_mfma_f32_16x16x32_bf16 v[64:67], v[108:111], v[96:99], v[64:67]
    v_mfma_f32_16x16x32_bf16 v[68:71], v[108:111], v[100:103], v[68:71]
    v_mfma_f32_16x16x32_bf16 v[72:75], v[108:111], v[104:107], v[72:75]
    v_mfma_f32_16x16x32_bf16 v[64:67], v[124:127], v[112:115], v[64:67]
    v_mfma_f32_16x16x32_bf16 v[68:71], v[124:127], v[116:119], v[68:71]
    v_mfma_f32_16x16x32_bf16 v[72:75], v[124:127], v[120:123], v[72:75]
    s_branch L_k2_epi
L_k2_nl:
    s_waitcnt vmcnt(63)
    s_barrier
    ds_read_b64_tr_b16 v[108:109], v15 offset:0
    ds_read_b64_tr_b16 v[110:111], v15 offset:512
    ds_read_b128 v[96:99], v12 offset:0
    ds_read_b128 v[100:103], v12 offset:2048
    ds_read_b128 v[104:107], v12 offset:4096
    ds_read_b64_tr_b16 v[124:125], v15 offset:4096
    ds_read_b64_tr_b16 v[126:127], v15 offset:4608
    ds_read_b128 v[112:115], v12 offset:1024
    ds_read_b128 v[116:119], v12 offset:3072
    ds_read_b128 v[120:123], v12 offset:5120
    ds_read_b64_tr_b16 v[140:141], v15 offset:8192
    ds_read_b64_tr_b16 v[142:143], v15 offset:8704
    ds_read_b128 v[128:131], v12 offset:12288
    ds_read_b128 v[132:135], v12 offset:14336
    ds_read_b128 v[136:139], v12 offset:16384
    ds_read_b64_tr_b16 v[156:157], v15 offset:12288
    ds_read_b64_tr_b16 v[158:159], v15 offset:12800
    ds_read_b128 v[144:147], v12 offset:13312
    ds_read_b128 v[148:151], v12 offset:15360
    ds_read_b128 v[152:155], v12 offset:17408
    s_waitcnt lgkmcnt(0)
    s_barrier
    v_mfma_f32_16x16x32_bf16 v[64:67], v[108:111], v[96:99], 0
    s_add_u32 m0, s19, 0x18000
    ds_read_b64_tr_b16 v[172:173], v15 offset:16384
    ds_read_b64_tr_b16 v[174:175], v15 offset:16896
    v_mfma_f32_16x16x32_bf16 v[68:71], v[108:111], v[100:103], 0
    buffer_load_dwordx4 v20, s[44:47], s17 offen lds
    s_add_u32 s17, s17, 81920
    ds_read_b128 v[160:163], v12 offset:24576
    ds_read_b128 v[164:167], v12 offset:26624
    v_mfma_f32_16x16x32_bf16 v[72:75], v[108:111], v[104:107], 0
    s_add_u32 m0, s19, 0x1a000
    ds_read_b128 v[168:171], v12 offset:28672
    ds_read_b64_tr_b16 v[188:189], v15 offset:20480
    v_mfma_f32_16x16x32_bf16 v[64:67], v[124:127], v[112:115], v[64:67]
    buffer_load_dwordx4 v20, s[44:47], s17 offen lds
    s_add_u32 s17, s17, 81920
    ds_read_b64_tr_b16 v[190:191], v15 offset:20992
    ds_read_b128 v[176:179], v12 offset:25600
    v_mfma_f32_16x16x32_bf16 v[68:71], v[124:127], v[116:119], v[68:71]
    ds_read_b128 v[180:183], v12 offset:27648
    ds_read_b128 v[184:187], v12 offset:29696
    v_mfma_f32_16x16x32_bf16 v[72:75], v[124:127], v[120:123], v[72:75]
    ds_read_b64_tr_b16 v[204:205], v15 offset:24576
    ds_read_b64_tr_b16 v[206:207], v15 offset:25088
    v_mfma_f32_16x16x32_bf16 v[64:67], v[140:143], v[128:131], v[64:67]
    ds_read_b128 v[192:195], v12 offset:36864
    ds_read_b128 v[196:199], v12 offset:38912
    v_mfma_f32_16x16x32_bf16 v[68:71], v[140:143], v[132:135], v[68:71]
    ds_read_b128 v[200:203], v12 offset:40960
    ds_read_b64_tr_b16 v[220:221], v15 offset:28672
    v_mfma_f32_16x16x32_bf16 v[72:75], v[140:143], v[136:139], v[72:75]
    ds_read_b64_tr_b16 v[222:223], v15 offset:29184
    v_mfma_f32_16x16x32_bf16 v[64:67], v[156:159], v[144:147], v[64:67]
    ds_read_b128 v[208:211], v12 offset:37888
    v_mfma_f32_16x16x32_bf16 v[68:71], v[156:159], v[148:151], v[68:71]
    ds_read_b128 v[212:215], v12 offset:39936
    v_mfma_f32_16x16x32_bf16 v[72:75], v[156:159], v[152:155], v[72:75]
    ds_read_b128 v[216:219], v12 offset:41984
    s_waitcnt lgkmcnt(0)
    s_barrier
    v_mfma_f32_16x16x32_bf16 v[64:67], v[172:175], v[160:163], v[64:67]
    s_add_u32 m0, s19, 0x1c000
    ds_read_b64_tr_b16 v[108:109], v15 offset:32768
    ds_read_b64_tr_b16 v[110:111], v15 offset:33280
    v_mfma_f32_16x16x32_bf16 v[68:71], v[172:175], v[164:167], v[68:71]
    buffer_load_dwordx4 v20, s[44:47], s17 offen lds
    s_add_u32 s17, s17, 81920
    ds_read_b128 v[96:99], v12 offset:49152
    ds_read_b128 v[100:103], v12 offset:51200
    v_mfma_f32_16x16x32_bf16 v[72:75], v[172:175], v[168:171], v[72:75]
    s_add_u32 m0, s19, 0x1e000
    ds_read_b128 v[104:107], v12 offset:53248
    ds_read_b64_tr_b16 v[124:125], v15 offset:36864
    v_mfma_f32_16x16x32_bf16 v[64:67], v[188:191], v[176:179], v[64:67]
    buffer_load_dwordx4 v20, s[44:47], s17 offen lds
    s_add_u32 s17, s17, 81920
    ds_read_b64_tr_b16 v[126:127], v15 offset:37376
    ds_read_b128 v[112:115], v12 offset:50176
    v_mfma_f32_16x16x32_bf16 v[68:71], v[188:191], v[180:183], v[68:71]
    ds_read_b128 v[116:119], v12 offset:52224
    ds_read_b128 v[120:123], v12 offset:54272
    v_mfma_f32_16x16x32_bf16 v[72:75], v[188:191], v[184:187], v[72:75]
    ds_read_b64_tr_b16 v[140:141], v15 offset:40960
    ds_read_b64_tr_b16 v[142:143], v15 offset:41472
    v_mfma_f32_16x16x32_bf16 v[64:67], v[204:207], v[192:195], v[64:67]
    ds_read_b128 v[128:131], v12 offset:61440
    ds_read_b128 v[132:135], v12 offset:63488
    v_mfma_f32_16x16x32_bf16 v[68:71], v[204:207], v[196:199], v[68:71]
    ds_read_b128 v[136:139], v13 offset:0
    ds_read_b64_tr_b16 v[156:157], v15 offset:45056
    v_mfma_f32_16x16x32_bf16 v[72:75], v[204:207], v[200:203], v[72:75]
    ds_read_b64_tr_b16 v[158:159], v15 offset:45568
    v_mfma_f32_16x16x32_bf16 v[64:67], v[220:223], v[208:211], v[64:67]
    ds_read_b128 v[144:147], v12 offset:62464
    v_mfma_f32_16x16x32_bf16 v[68:71], v[220:223], v[212:215], v[68:71]
    ds_read_b128 v[148:151], v12 offset:64512
    v_mfma_f32_16x16x32_bf16 v[72:75], v[220:223], v[216:219], v[72:75]
    ds_read_b128 v[152:155], v13 offset:1024
    s_waitcnt vmcnt(2) lgkmcnt(0)
    s_barrier
    v_mfma_f32_16x16x32_bf16 v[64:67], v[108:111], v[96:99], v[64:67]
    s_add_u32 m0, s19, 0x20000
    ds_read_b64_tr_b16 v[172:173], v15 offset:0
    ds_read_b64_tr_b16 v[174:175], v15 offset:512
    v_mfma_f32_16x16x32_bf16 v[68:71], v[108:111], v[100:103], v[68:71]
    buffer_load_dwordx4 v20, s[44:47], s17 offen lds
    s_add_u32 s17, s17, 81920
    ds_read_b128 v[160:163], v12 offset:0
    ds_read_b128 v[164:167], v12 offset:2048
    v_mfma_f32_16x16x32_bf16 v[72:75], v[108:111], v[104:107], v[72:75]
    s_add_u32 m0, s19, 0x22000
    ds_read_b128 v[168:171], v12 offset:4096
    ds_read_b64_tr_b16 v[188:189], v15 offset:4096
    v_mfma_f32_16x16x32_bf16 v[64:67], v[124:127], v[112:115], v[64:67]
    buffer_load_dwordx4 v20, s[44:47], s17 offen lds
    s_add_u32 s17, s17, 81920
    ds_read_b64_tr_b16 v[190:191], v15 offset:4608
    ds_read_b128 v[176:179], v12 offset:1024
    v_mfma_f32_16x16x32_bf16 v[68:71], v[124:127], v[116:119], v[68:71]
    ds_read_b128 v[180:183], v12 offset:3072
    ds_read_b128 v[184:187], v12 offset:5120
    v_mfma_f32_16x16x32_bf16 v[72:75], v[124:127], v[120:123], v[72:75]
    ds_read_b64_tr_b16 v[204:205], v15 offset:8192
    ds_read_b64_tr_b16 v[206:207], v15 offset:8704
    v_mfma_f32_16x16x32_bf16 v[64:67], v[140:143], v[128:131], v[64:67]
    ds_read_b128 v[192:195], v12 offset:12288
    ds_read_b128 v[196:199], v12 offset:14336
    v_mfma_f32_16x16x32_bf16 v[68:71], v[140:143], v[132:135], v[68:71]
    ds_read_b128 v[200:203], v12 offset:16384
    ds_read_b64_tr_b16 v[220:221], v15 offset:12288
    v_mfma_f32_16x16x32_bf16 v[72:75], v[140:143], v[136:139], v[72:75]
    ds_read_b64_tr_b16 v[222:223], v15 offset:12800
    v_mfma_f32_16x16x32_bf16 v[64:67], v[156:159], v[144:147], v[64:67]
    ds_read_b128 v[208:211], v12 offset:13312
    v_mfma_f32_16x16x32_bf16 v[68:71], v[156:159], v[148:151], v[68:71]
    ds_read_b128 v[212:215], v12 offset:15360
    v_mfma_f32_16x16x32_bf16 v[72:75], v[156:159], v[152:155], v[72:75]
    ds_read_b128 v[216:219], v12 offset:17408
    s_waitcnt vmcnt(2) lgkmcnt(0)
    s_barrier
    v_mfma_f32_16x16x32_bf16 v[64:67], v[172:175], v[160:163], v[64:67]
    s_add_u32 m0, s19, 0x18000
    ds_read_b64_tr_b16 v[108:109], v15 offset:16384
    ds_read_b64_tr_b16 v[110:111], v15 offset:16896
    v_mfma_f32_16x16x32_bf16 v[68:71], v[172:175], v[164:167], v[68:71]
    buffer_load_dwordx4 v20, s[44:47], s17 offen lds
    s_add_u32 s17, s17, 81920
    ds_read_b128 v[96:99], v12 offset:24576
    ds_read_b128 v[100:103], v12 offset:26624
    v_mfma_f32_16x16x32_bf16 v[72:75], v[172:175], v[168:171], v[72:75]
    s_add_u32 m0, s19, 0x1a000
    ds_read_b128 v[104:107], v12 offset:28672
    ds_read_b64_tr_b16 v[124:125], v15 offset:20480
    v_mfma_f32_16x16x32_bf16 v[64:67], v[188:191], v[176:179], v[64:67]
    buffer_load_dwordx4 v20, s[44:47], s17 offen lds
    s_add_u32 s17, s17, 81920
    ds_read_b64_tr_b16 v[126:127], v15 offset:20992
    ds_read_b128 v[112:115], v12 offset:25600
    v_mfma_f32_16x16x32_bf16 v[68:71], v[188:191], v[180:183], v[68:71]
    ds_read_b128 v[116:119], v12 offset:27648
    ds_read_b128 v[120:123], v12 offset:29696
    v_mfma_f32_16x16x32_bf16 v[72:75], v[188:191], v[184:187], v[72:75]
    ds_read_b64_tr_b16 v[140:141], v15 offset:24576
    ds_read_b64_tr_b16 v[142:143], v15 offset:25088
    v_mfma_f32_16x16x32_bf16 v[64:67], v[204:207], v[192:195], v[64:67]
    ds_read_b128 v[128:131], v12 offset:36864
    ds_read_b128 v[132:135], v12 offset:38912
    v_mfma_f32_16x16x32_bf16 v[68:71], v[204:207], v[196:199], v[68:71]
    ds_read_b128 v[136:139], v12 offset:40960
    ds_read_b64_tr_b16 v[156:157], v15 offset:28672
    v_mfma_f32_16x16x32_bf16 v[72:75], v[204:207], v[200:203], v[72:75]
    ds_read_b64_tr_b16 v[158:159], v15 offset:29184
    v_mfma_f32_16x16x32_bf16 v[64:67], v[220:223], v[208:211], v[64:67]
    ds_read_b128 v[144:147], v12 offset:37888
    v_mfma_f32_16x16x32_bf16 v[68:71], v[220:223], v[212:215], v[68:71]
    ds_read_b128 v[148:151], v12 offset:39936
    v_mfma_f32_16x16x32_bf16 v[72:75], v[220:223], v[216:219], v[72:75]
    ds_read_b128 v[152:155], v12 offset:41984
    s_waitcnt vmcnt(2) lgkmcnt(0)
    s_barrier
    v_mfma_f32_16x16x32_bf16 v[64:67], v[108:111], v[96:99], v[64:67]
    s_add_u32 m0, s19, 0x1c000
    ds_read_b64_tr_b16 v[172:173], v15 offset:32768
    ds_read_b64_tr_b16 v[174:175], v15 offset:33280
    v_mfma_f32_16x16x32_bf16 v[68:71], v[108:111], v[100:103], v[68:71]
    buffer_load_dwordx4 v20, s[44:47], s17 offen lds
    s_add_u32 s17, s17, 81920
    ds_read_b128 v[160:163], v12 offset:49152
    ds_read_b128 v[164:167], v12 offset:51200
    v_mfma_f32_16x16x32_bf16 v[72:75], v[108:111], v[104:107], v[72:75]
    s_add_u32 m0, s19, 0x1e000
    ds_read_b128 v[168:171], v12 offset:53248
    ds_read_b64_tr_b16 v[188:189], v15 offset:36864
    v_mfma_f32_16x16x32_bf16 v[64:67], v[124:127], v[112:115], v[64:67]
    buffer_load_dwordx4 v20, s[44:47], s17 offen lds
    s_add_u32 s17, s17, 81920
    ds_read_b64_tr_b16 v[190:191], v15 offset:37376
    ds_read_b128 v[176:179], v12 offset:50176
    v_mfma_f32_16x16x32_bf16 v[68:71], v[124:127], v[116:119], v[68:71]
    ds_read_b128 v[180:183], v12 offset:52224
    ds_read_b128 v[184:187], v12 offset:54272
    v_mfma_f32_16x16x32_bf16 v[72:75], v[124:127], v[120:123], v[72:75]
    ds_read_b64_tr_b16 v[204:205], v15 offset:40960
    ds_read_b64_tr_b16 v[206:207], v15 offset:41472
    v_mfma_f32_16x16x32_bf16 v[64:67], v[140:143], v[128:131], v[64:67]
    ds_read_b128 v[192:195], v12 offset:61440
    ds_read_b128 v[196:199], v12 offset:63488
    v_mfma_f32_16x16x32_bf16 v[68:71], v[140:143], v[132:135], v[68:71]
    ds_read_b128 v[200:203], v13 offset:0
    ds_read_b64_tr_b16 v[220:221], v15 offset:45056
    v_mfma_f32_16x16x32_bf16 v[72:75], v[140:143], v[136:139], v[72:75]
    ds_read_b64_tr_b16 v[222:223], v15 offset:45568
    v_mfma_f32_16x16x32_bf16 v[64:67], v[156:159], v[144:147], v[64:67]
    ds_read_b128 v[208:211], v12 offset:62464
    v_mfma_f32_16x16x32_bf16 v[68:71], v[156:159], v[148:151], v[68:71]
    ds_read_b128 v[212:215], v12 offset:64512
    v_mfma_f32_16x16x32_bf16 v[72:75], v[156:159], v[152:155], v[72:75]
    ds_read_b128 v[216:219], v13 offset:1024
    s_waitcnt vmcnt(2) lgkmcnt(0)
    s_barrier
    v_mfma_f32_16x16x32_bf16 v[64:67], v[172:175], v[160:163], v[64:67]
    s_add_u32 m0, s19, 0x20000
    ds_read_b64_tr_b16 v[108:109], v15 offset:0
    ds_read_b64_tr_b16 v[110:111], v15 offset:512
    v_mfma_f32_16x16x32_bf16 v[68:71], v[172:175], v[164:167], v[68:71]
    buffer_load_dwordx4 v20, s[44:47], s17 offen lds
    s_add_u32 s17, s17, 81920
    ds_read_b128 v[96:99], v12 offset:0
    ds_read_b128 v[100:103], v12 offset:2048
    v_mfma_f32_16x16x32_bf16 v[72:75], v[172:175], v[168:171], v[72:75]
    s_add_u32 m0, s19, 0x22000
    ds_read_b128 v[104:107], v12 offset:4096
    ds_read_b64_tr_b16 v[124:125], v15 offset:4096
    v_mfma_f32_16x16x32_bf16 v[64:67], v[188:191], v[176:179], v[64:67]
    buffer_load_dwordx4 v20, s[44:47], s17 offen lds
    s_add_u32 s17, s17, 81920
    ds_read_b64_tr_b16 v[126:127], v15 offset:4608
    ds_read_b128 v[112:115], v12 offset:1024
    v_mfma_f32_16x16x32_bf16 v[68:71], v[188:191], v[180:183], v[68:71]
    ds_read_b128 v[116:119], v12 offset:3072
    ds_read_b128 v[120:123], v12 offset:5120
    v_mfma_f32_16x16x32_bf16 v[72:75], v[188:191], v[184:187], v[72:75]
    ds_read_b64_tr_b16 v[140:141], v15 offset:8192
    ds_read_b64_tr_b16 v[142:143], v15 offset:8704
    v_mfma_f32_16x16x32_bf16 v[64:67], v[204:207], v[192:195], v[64:67]
    ds_read_b128 v[128:131], v12 offset:12288
    ds_read_b128 v[132:135], v12 offset:14336
    v_mfma_f32_16x16x32_bf16 v[68:71], v[204:207], v[196:199], v[68:71]
    ds_read_b128 v[136:139], v12 offset:16384
    ds_read_b64_tr_b16 v[156:157], v15 offset:12288
    v_mfma_f32_16x16x32_bf16 v[72:75], v[204:207], v[200:203], v[72:75]
    ds_read_b64_tr_b16 v[158:159], v15 offset:12800
    v_mfma_f32_16x16x32_bf16 v[64:67], v[220:223], v[208:211], v[64:67]
    ds_read_b128 v[144:147], v12 offset:13312
    v_mfma_f32_16x16x32_bf16 v[68:71], v[220:223], v[212:215], v[68:71]
    ds_read_b128 v[148:151], v12 offset:15360
    v_mfma_f32_16x16x32_bf16 v[72:75], v[220:223], v[216:219], v[72:75]
    ds_read_b128 v[152:155], v12 offset:17408
    s_waitcnt vmcnt(2) lgkmcnt(0)
    s_barrier
    v_mfma_f32_16x16x32_bf16 v[64:67], v[108:111], v[96:99], v[64:67]
    s_add_u32 m0, s19, 0x18000
    ds_read_b64_tr_b16 v[172:173], v15 offset:16384
    ds_read_b64_tr_b16 v[174:175], v15 offset:16896
    v_mfma_f32_16x16x32_bf16 v[68:71], v[108:111], v[100:103], v[68:71]
    buffer_load_dwordx4 v20, s[44:47], s17 offen lds
    s_add_u32 s17, s17, 81920
    ds_read_b128 v[160:163], v12 offset:24576
    ds_read_b128 v[164:167], v12 offset:26624
    v_mfma_f32_16x16x32_bf16 v[72:75], v[108:111], v[104:107], v[72:75]
    s_add_u32 m0, s19, 0x1a000
    ds_read_b128 v[168:171], v12 offset:28672
    ds_read_b64_tr_b16 v[188:189], v15 offset:20480
    v_mfma_f32_16x16x32_bf16 v[64:67], v[124:127], v[112:115], v[64:67]
    buffer_load_dwordx4 v20, s[44:47], s17 offen lds
    s_add_u32 s17, s17, 81920
    ds_read_b64_tr_b16 v[190:191], v15 offset:20992
    ds_read_b128 v[176:179], v12 offset:25600
    v_mfma_f32_16x16x32_bf16 v[68:71], v[124:127], v[116:119], v[68:71]
    ds_read_b128 v[180:183], v12 offset:27648
    ds_read_b128 v[184:187], v12 offset:29696
    v_mfma_f32_16x16x32_bf16 v[72:75], v[124:127], v[120:123], v[72:75]
    ds_read_b64_tr_b16 v[204:205], v15 offset:24576
    ds_read_b64_tr_b16 v[206:207], v15 offset:25088
    v_mfma_f32_16x16x32_bf16 v[64:67], v[140:143], v[128:131], v[64:67]
    ds_read_b128 v[192:195], v12 offset:36864
    ds_read_b128 v[196:199], v12 offset:38912
    v_mfma_f32_16x16x32_bf16 v[68:71], v[140:143], v[132:135], v[68:71]
    ds_read_b128 v[200:203], v12 offset:40960
    ds_read_b64_tr_b16 v[220:221], v15 offset:28672
    v_mfma_f32_16x16x32_bf16 v[72:75], v[140:143], v[136:139], v[72:75]
    ds_read_b64_tr_b16 v[222:223], v15 offset:29184
    v_mfma_f32_16x16x32_bf16 v[64:67], v[156:159], v[144:147], v[64:67]
    ds_read_b128 v[208:211], v12 offset:37888
    v_mfma_f32_16x16x32_bf16 v[68:71], v[156:159], v[148:151], v[68:71]
    ds_read_b128 v[212:215], v12 offset:39936
    v_mfma_f32_16x16x32_bf16 v[72:75], v[156:159], v[152:155], v[72:75]
    ds_read_b128 v[216:219], v12 offset:41984
    s_waitcnt vmcnt(2) lgkmcnt(0)
    s_barrier
    v_mfma_f32_16x16x32_bf16 v[64:67], v[172:175], v[160:163], v[64:67]
    s_add_u32 m0, s19, 0x1c000
    ds_read_b64_tr_b16 v[108:109], v15 offset:32768
    ds_read_b64_tr_b16 v[110:111], v15 offset:33280
    v_mfma_f32_16x16x32_bf16 v[68:71], v[172:175], v[164:167], v[68:71]
    buffer_load_dwordx4 v20, s[44:47], s17 offen lds
    s_add_u32 s17, s17, 81920
    ds_read_b128 v[96:99], v12 offset:49152
    ds_read_b128 v[100:103], v12 offset:51200
    v_mfma_f32_16x16x32_bf16 v[72:75], v[172:175], v[168:171], v[72:75]
    s_add_u32 m0, s19, 0x1e000
    ds_read_b128 v[104:107], v12 offset:53248
    ds_read_b64_tr_b16 v[124:125], v15 offset:36864
    v_mfma_f32_16x16x32_bf16 v[64:67], v[188:191], v[176:179], v[64:67]
    buffer_load_dwordx4 v20, s[44:47], s17 offen lds
    s_add_u32 s17, s17, 81920
    ds_read_b64_tr_b16 v[126:127], v15 offset:37376
    ds_read_b128 v[112:115], v12 offset:50176
    v_mfma_f32_16x16x32_bf16 v[68:71], v[188:191], v[180:183], v[68:71]
    ds_read_b128 v[116:119], v12 offset:52224
    ds_read_b128 v[120:123], v12 offset:54272
    v_mfma_f32_16x16x32_bf16 v[72:75], v[188:191], v[184:187], v[72:75]
    ds_read_b64_tr_b16 v[140:141], v15 offset:40960
    ds_read_b64_tr_b16 v[142:143], v15 offset:41472
    v_mfma_f32_16x16x32_bf16 v[64:67], v[204:207], v[192:195], v[64:67]
    ds_read_b128 v[128:131], v12 offset:61440
    ds_read_b128 v[132:135], v12 offset:63488
    v_mfma_f32_16x16x32_bf16 v[68:71], v[204:207], v[196:199], v[68:71]
    ds_read_b128 v[136:139], v13 offset:0
    ds_read_b64_tr_b16 v[156:157], v15 offset:45056
    v_mfma_f32_16x16x32_bf16 v[72:75], v[204:207], v[200:203], v[72:75]
    ds_read_b64_tr_b16 v[158:159], v15 offset:45568
    v_mfma_f32_16x16x32_bf16 v[64:67], v[220:223], v[208:211], v[64:67]
    ds_read_b128 v[144:147], v12 offset:62464
    v_mfma_f32_16x16x32_bf16 v[68:71], v[220:223], v[212:215], v[68:71]
    ds_read_b128 v[148:151], v12 offset:64512
    v_mfma_f32_16x16x32_bf16 v[72:75], v[220:223], v[216:219], v[72:75]
    ds_read_b128 v[152:155], v13 offset:1024
    s_waitcnt vmcnt(2) lgkmcnt(0)
    s_barrier
    v_mfma_f32_16x16x32_bf16 v[64:67], v[108:111], v[96:99], v[64:67]
    s_add_u32 m0, s19, 0x20000
    ds_read_b64_tr_b16 v[172:173], v15 offset:0
    ds_read_b64_tr_b16 v[174:175], v15 offset:512
    v_mfma_f32_16x16x32_bf16 v[68:71], v[108:111], v[100:103], v[68:71]
    buffer_load_dwordx4 v20, s[44:47], s17 offen lds
    s_add_u32 s17, s17, 81920
    ds_read_b128 v[160:163], v12 offset:0
    ds_read_b128 v[164:167], v12 offset:2048
    v_mfma_f32_16x16x32_bf16 v[72:75], v[108:111], v[104:107], v[72:75]
    s_add_u32 m0, s19, 0x22000
    ds_read_b128 v[168:171], v12 offset:4096
    ds_read_b64_tr_b16 v[188:189], v15 offset:4096
    v_mfma_f32_16x16x32_bf16 v[64:67], v[124:127], v[112:115], v[64:67]
    buffer_load_dwordx4 v20, s[44:47], s17 offen lds
    s_add_u32 s17, s17, 81920
    ds_read_b64_tr_b16 v[190:191], v15 offset:4608
    ds_read_b128 v[176:179], v12 offset:1024
    v_mfma_f32_16x16x32_bf16 v[68:71], v[124:127], v[116:119], v[68:71]
    ds_read_b128 v[180:183], v12 offset:3072
    ds_read_b128 v[184:187], v12 offset:5120
    v_mfma_f32_16x16x32_bf16 v[72:75], v[124:127], v[120:123], v[72:75]
    ds_read_b64_tr_b16 v[204:205], v15 offset:8192
    ds_read_b64_tr_b16 v[206:207], v15 offset:8704
    v_mfma_f32_16x16x32_bf16 v[64:67], v[140:143], v[128:131], v[64:67]
    ds_read_b128 v[192:195], v12 offset:12288
    ds_read_b128 v[196:199], v12 offset:14336
    v_mfma_f32_16x16x32_bf16 v[68:71], v[140:143], v[132:135], v[68:71]
    ds_read_b128 v[200:203], v12 offset:16384
    ds_read_b64_tr_b16 v[220:221], v15 offset:12288
    v_mfma_f32_16x16x32_bf16 v[72:75], v[140:143], v[136:139], v[72:75]
    ds_read_b64_tr_b16 v[222:223], v15 offset:12800
    v_mfma_f32_16x16x32_bf16 v[64:67], v[156:159], v[144:147], v[64:67]
    ds_read_b128 v[208:211], v12 offset:13312
    v_mfma_f32_16x16x32_bf16 v[68:71], v[156:159], v[148:151], v[68:71]
    ds_read_b128 v[212:215], v12 offset:15360
    v_mfma_f32_16x16x32_bf16 v[72:75], v[156:159], v[152:155], v[72:75]
    ds_read_b128 v[216:219], v12 offset:17408
    s_waitcnt vmcnt(2) lgkmcnt(0)
    s_barrier
    v_mfma_f32_16x16x32_bf16 v[64:67], v[172:175], v[160:163], v[64:67]
    s_add_u32 m0, s19, 0x18000
    ds_read_b64_tr_b16 v[108:109], v15 offset:16384
    ds_read_b64_tr_b16 v[110:111], v15 offset:16896
    v_mfma_f32_16x16x32_bf16 v[68:71], v[172:175], v[164:167], v[68:71]
    buffer_load_dwordx4 v20, s[44:47], s17 offen lds
    s_add_u32 s17, s17, 81920
    ds_read_b128 v[96:99], v12 offset:24576
    ds_read_b128 v[100:103], v12 offset:26624
    v_mfma_f32_16x16x32_bf16 v[72:75], v[172:175], v[168:171], v[72:75]
    s_add_u32 m0, s19, 0x1a000
    ds_read_b128 v[104:107], v12 offset:28672
    ds_read_b64_tr_b16 v[124:125], v15 offset:20480
    v_mfma_f32_16x16x32_bf16 v[64:67], v[188:191], v[176:179], v[64:67]
    buffer_load_dwordx4 v20, s[44:47], s17 offen lds
    s_add_u32 s17, s17, 81920
    ds_read_b64_tr_b16 v[126:127], v15 offset:20992
    ds_read_b128 v[112:115], v12 offset:25600
    v_mfma_f32_16x16x32_bf16 v[68:71], v[188:191], v[180:183], v[68:71]
    ds_read_b128 v[116:119], v12 offset:27648
    ds_read_b128 v[120:123], v12 offset:29696
    v_mfma_f32_16x16x32_bf16 v[72:75], v[188:191], v[184:187], v[72:75]
    ds_read_b64_tr_b16 v[140:141], v15 offset:24576
    ds_read_b64_tr_b16 v[142:143], v15 offset:25088
    v_mfma_f32_16x16x32_bf16 v[64:67], v[204:207], v[192:195], v[64:67]
    ds_read_b128 v[128:131], v12 offset:36864
    ds_read_b128 v[132:135], v12 offset:38912
    v_mfma_f32_16x16x32_bf16 v[68:71], v[204:207], v[196:199], v[68:71]
    ds_read_b128 v[136:139], v12 offset:40960
    ds_read_b64_tr_b16 v[156:157], v15 offset:28672
    v_mfma_f32_16x16x32_bf16 v[72:75], v[204:207], v[200:203], v[72:75]
    ds_read_b64_tr_b16 v[158:159], v15 offset:29184
    v_mfma_f32_16x16x32_bf16 v[64:67], v[220:223], v[208:211], v[64:67]
    ds_read_b128 v[144:147], v12 offset:37888
    v_mfma_f32_16x16x32_bf16 v[68:71], v[220:223], v[212:215], v[68:71]
    ds_read_b128 v[148:151], v12 offset:39936
    v_mfma_f32_16x16x32_bf16 v[72:75], v[220:223], v[216:219], v[72:75]
    ds_read_b128 v[152:155], v12 offset:41984
    s_waitcnt vmcnt(2) lgkmcnt(0)
    s_barrier
    v_mfma_f32_16x16x32_bf16 v[64:67], v[108:111], v[96:99], v[64:67]
    s_add_u32 m0, s19, 0x1c000
    ds_read_b64_tr_b16 v[172:173], v15 offset:32768
    ds_read_b64_tr_b16 v[174:175], v15 offset:33280
    v_mfma_f32_16x16x32_bf16 v[68:71], v[108:111], v[100:103], v[68:71]
    buffer_load_dwordx4 v20, s[44:47], s17 offen lds
    s_add_u32 s17, s17, 81920
    ds_read_b128 v[160:163], v12 offset:49152
    ds_read_b128 v[164:167], v12 offset:51200
    v_mfma_f32_16x16x32_bf16 v[72:75], v[108:111], v[104:107], v[72:75]
    s_mov_b32 s17, 0
    s_add_u32 m0, s19, 0x1e000
    ds_read_b128 v[168:171], v12 offset:53248
    ds_read_b64_tr_b16 v[188:189], v15 offset:36864
    v_mfma_f32_16x16x32_bf16 v[64:67], v[124:127], v[112:115], v[64:67]
    buffer_load_dwordx4 v20, s[48:51], s17 offen lds
    s_add_u32 s17, s17, 81920
    ds_read_b64_tr_b16 v[190:191], v15 offset:37376
    ds_read_b128 v[176:179], v12 offset:50176
    v_mfma_f32_16x16x32_bf16 v[68:71], v[124:127], v[116:119], v[68:71]
    ds_read_b128 v[180:183], v12 offset:52224
    ds_read_b128 v[184:187], v12 offset:54272
    v_mfma_f32_16x16x32_bf16 v[72:75], v[124:127], v[120:123], v[72:75]
    ds_read_b64_tr_b16 v[204:205], v15 offset:40960
    ds_read_b64_tr_b16 v[206:207], v15 offset:41472
    v_mfma_f32_16x16x32_bf16 v[64:67], v[140:143], v[128:131], v[64:67]
    ds_read_b128 v[192:195], v12 offset:61440
    ds_read_b128 v[196:199], v12 offset:63488
    v_mfma_f32_16x16x32_bf16 v[68:71], v[140:143], v[132:135], v[68:71]
    ds_read_b128 v[200:203], v13 offset:0
    ds_read_b64_tr_b16 v[220:221], v15 offset:45056
    v_mfma_f32_16x16x32_bf16 v[72:75], v[140:143], v[136:139], v[72:75]
    ds_read_b64_tr_b16 v[222:223], v15 offset:45568
    v_mfma_f32_16x16x32_bf16 v[64:67], v[156:159], v[144:147], v[64:67]
    ds_read_b128 v[208:211], v12 offset:62464
    v_mfma_f32_16x16x32_bf16 v[68:71], v[156:159], v[148:151], v[68:71]
    ds_read_b128 v[212:215], v12 offset:64512
    v_mfma_f32_16x16x32_bf16 v[72:75], v[156:159], v[152:155], v[72:75]
    ds_read_b128 v[216:219], v13 offset:1024
    s_waitcnt vmcnt(2) lgkmcnt(0)
    s_barrier
    v_mfma_f32_16x16x32_bf16 v[64:67], v[172:175], v[160:163], v[64:67]
    s_add_u32 m0, s19, 0x20000
    ds_read_b64_tr_b16 v[108:109], v15 offset:0
    ds_read_b64_tr_b16 v[110:111], v15 offset:512
    v_mfma_f32_16x16x32_bf16 v[68:71], v[172:175], v[164:167], v[68:71]
    buffer_load_dwordx4 v20, s[48:51], s17 offen lds
    s_add_u32 s17, s17, 81920
    ds_read_b128 v[96:99], v12 offset:0
    ds_read_b128 v[100:103], v12 offset:2048
    v_mfma_f32_16x16x32_bf16 v[72:75], v[172:175], v[168:171], v[72:75]
    s_add_u32 m0, s19, 0x22000
    ds_read_b128 v[104:107], v12 offset:4096
    ds_read_b64_tr_b16 v[124:125], v15 offset:4096
    v_mfma_f32_16x16x32_bf16 v[64:67], v[188:191], v[176:179], v[64:67]
    buffer_load_dwordx4 v20, s[48:51], s17 offen lds
    s_add_u32 s17, s17, 81920
    ds_read_b64_tr_b16 v[126:127], v15 offset:4608
    ds_read_b128 v[112:115], v12 offset:1024
    v_mfma_f32_16x16x32_bf16 v[68:71], v[188:191], v[180:183], v[68:71]
    ds_read_b128 v[116:119], v12 offset:3072
    ds_read_b128 v[120:123], v12 offset:5120
    v_mfma_f32_16x16x32_bf16 v[72:75], v[188:191], v[184:187], v[72:75]
    ds_read_b64_tr_b16 v[140:141], v15 offset:8192
    ds_read_b64_tr_b16 v[142:143], v15 offset:8704
    v_mfma_f32_16x16x32_bf16 v[64:67], v[204:207], v[192:195], v[64:67]
    ds_read_b128 v[128:131], v12 offset:12288
    ds_read_b128 v[132:135], v12 offset:14336
    v_mfma_f32_16x16x32_bf16 v[68:71], v[204:207], v[196:199], v[68:71]
    ds_read_b128 v[136:139], v12 offset:16384
    ds_read_b64_tr_b16 v[156:157], v15 offset:12288
    v_mfma_f32_16x16x32_bf16 v[72:75], v[204:207], v[200:203], v[72:75]
    ds_read_b64_tr_b16 v[158:159], v15 offset:12800
    v_mfma_f32_16x16x32_bf16 v[64:67], v[220:223], v[208:211], v[64:67]
    ds_read_b128 v[144:147], v12 offset:13312
    v_mfma_f32_16x16x32_bf16 v[68:71], v[220:223], v[212:215], v[68:71]
    ds_read_b128 v[148:151], v12 offset:15360
    v_mfma_f32_16x16x32_bf16 v[72:75], v[220:223], v[216:219], v[72:75]
    ds_read_b128 v[152:155], v12 offset:17408
    s_waitcnt vmcnt(2) lgkmcnt(0)
    s_barrier
    v_mfma_f32_16x16x32_bf16 v[64:67], v[108:111], v[96:99], v[64:67]
    s_add_u32 m0, s19, 0x18000
    ds_read_b64_tr_b16 v[172:173], v15 offset:16384
    ds_read_b64_tr_b16 v[174:175], v15 offset:16896
    v_mfma_f32_16x16x32_bf16 v[68:71], v[108:111], v[100:103], v[68:71]
    buffer_load_dwordx4 v20, s[48:51], s17 offen lds
    s_add_u32 s17, s17, 81920
    ds_read_b128 v[160:163], v12 offset:24576
    ds_read_b128 v[164:167], v12 offset:26624
    v_mfma_f32_16x16x32_bf16 v[72:75], v[108:111], v[104:107], v[72:75]
    s_add_u32 m0, s19, 0x1a000
    ds_read_b128 v[168:171], v12 offset:28672
    ds_read_b64_tr_b16 v[188:189], v15 offset:20480
    v_mfma_f32_16x16x32_bf16 v[64:67], v[124:127], v[112:115], v[64:67]
    buffer_load_dwordx4 v20, s[48:51], s17 offen lds
    s_add_u32 s17, s17, 81920
    ds_read_b64_tr_b16 v[190:191], v15 offset:20992
    ds_read_b128 v[176:179], v12 offset:25600
    v_mfma_f32_16x16x32_bf16 v[68:71], v[124:127], v[116:119], v[68:71]
    ds_read_b128 v[180:183], v12 offset:27648
    ds_read_b128 v[184:187], v12 offset:29696
    v_mfma_f32_16x16x32_bf16 v[72:75], v[124:127], v[120:123], v[72:75]
    ds_read_b64_tr_b16 v[204:205], v15 offset:24576
    ds_read_b64_tr_b16 v[206:207], v15 offset:25088
    v_mfma_f32_16x16x32_bf16 v[64:67], v[140:143], v[128:131], v[64:67]
    ds_read_b128 v[192:195], v12 offset:36864
    ds_read_b128 v[196:199], v12 offset:38912
    v_mfma_f32_16x16x32_bf16 v[68:71], v[140:143], v[132:135], v[68:71]
    ds_read_b128 v[200:203], v12 offset:40960
    ds_read_b64_tr_b16 v[220:221], v15 offset:28672
    v_mfma_f32_16x16x32_bf16 v[72:75], v[140:143], v[136:139], v[72:75]
    ds_read_b64_tr_b16 v[222:223], v15 offset:29184
    v_mfma_f32_16x16x32_bf16 v[64:67], v[156:159], v[144:147], v[64:67]
    ds_read_b128 v[208:211], v12 offset:37888
    v_mfma_f32_16x16x32_bf16 v[68:71], v[156:159], v[148:151], v[68:71]
    ds_read_b128 v[212:215], v12 offset:39936
    v_mfma_f32_16x16x32_bf16 v[72:75], v[156:159], v[152:155], v[72:75]
    ds_read_b128 v[216:219], v12 offset:41984
    s_waitcnt vmcnt(2) lgkmcnt(0)
    s_barrier
    v_mfma_f32_16x16x32_bf16 v[64:67], v[172:175], v[160:163], v[64:67]
    s_add_u32 m0, s19, 0x1c000
    ds_read_b64_tr_b16 v[108:109], v15 offset:32768
    ds_read_b64_tr_b16 v[110:111], v15 offset:33280
    v_mfma_f32_16x16x32_bf16 v[68:71], v[172:175], v[164:167], v[68:71]
    buffer_load_dwordx4 v20, s[48:51], s17 offen lds
    s_add_u32 s17, s17, 81920
    ds_read_b128 v[96:99], v12 offset:49152
    ds_read_b128 v[100:103], v12 offset:51200
    v_mfma_f32_16x16x32_bf16 v[72:75], v[172:175], v[168:171], v[72:75]
    s_add_u32 m0, s19, 0x1e000
    ds_read_b128 v[104:107], v12 offset:53248
    ds_read_b64_tr_b16 v[124:125], v15 offset:36864
    v_mfma_f32_16x16x32_bf16 v[64:67], v[188:191], v[176:179], v[64:67]
    buffer_load_dwordx4 v20, s[48:51], s17 offen lds
    s_add_u32 s17, s17, 81920
    ds_read_b64_tr_b16 v[126:127], v15 offset:37376
    ds_read_b128 v[112:115], v12 offset:50176
    v_mfma_f32_16x16x32_bf16 v[68:71], v[188:191], v[180:183], v[68:71]
    ds_read_b128 v[116:119], v12 offset:52224
    ds_read_b128 v[120:123], v12 offset:54272
    v_mfma_f32_16x16x32_bf16 v[72:75], v[188:191], v[184:187], v[72:75]
    ds_read_b64_tr_b16 v[140:141], v15 offset:40960
    ds_read_b64_tr_b16 v[142:143], v15 offset:41472
    v_mfma_f32_16x16x32_bf16 v[64:67], v[204:207], v[192:195], v[64:67]
    ds_read_b128 v[128:131], v12 offset:61440
    ds_read_b128 v[132:135], v12 offset:63488
    v_mfma_f32_16x16x32_bf16 v[68:71], v[204:207], v[196:199], v[68:71]
    ds_read_b128 v[136:139], v13 offset:0
    ds_read_b64_tr_b16 v[156:157], v15 offset:45056
    v_mfma_f32_16x16x32_bf16 v[72:75], v[204:207], v[200:203], v[72:75]
    ds_read_b64_tr_b16 v[158:159], v15 offset:45568
    v_mfma_f32_16x16x32_bf16 v[64:67], v[220:223], v[208:211], v[64:67]
    ds_read_b128 v[144:147], v12 offset:62464
    v_mfma_f32_16x16x32_bf16 v[68:71], v[220:223], v[212:215], v[68:71]
    ds_read_b128 v[148:151], v12 offset:64512
    v_mfma_f32_16x16x32_bf16 v[72:75], v[220:223], v[216:219], v[72:75]
    ds_read_b128 v[152:155], v13 offset:1024
    s_waitcnt vmcnt(2) lgkmcnt(0)
    s_barrier
    v_mfma_f32_16x16x32_bf16 v[64:67], v[108:111], v[96:99], v[64:67]
    s_add_u32 m0, s19, 0x20000
    ds_read_b64_tr_b16 v[172:173], v15 offset:0
    ds_read_b64_tr_b16 v[174:175], v15 offset:512
    v_mfma_f32_16x16x32_bf16 v[68:71], v[108:111], v[100:103], v[68:71]
    buffer_load_dwordx4 v20, s[48:51], s17 offen lds
    s_add_u32 s17, s17, 81920
    ds_read_b128 v[160:163], v12 offset:0
    ds_read_b128 v[164:167], v12 offset:2048
    v_mfma_f32_16x16x32_bf16 v[72:75], v[108:111], v[104:107], v[72:75]
    s_add_u32 m0, s19, 0x22000
    ds_read_b128 v[168:171], v12 offset:4096
    ds_read_b64_tr_b16 v[188:189], v15 offset:4096
    v_mfma_f32_16x16x32_bf16 v[64:67], v[124:127], v[112:115], v[64:67]
    buffer_load_dwordx4 v20, s[48:51], s17 offen lds
    s_add_u32 s17, s17, 81920
    ds_read_b64_tr_b16 v[190:191], v15 offset:4608
    ds_read_b128 v[176:179], v12 offset:1024
    v_mfma_f32_16x16x32_bf16 v[68:71], v[124:127], v[116:119], v[68:71]
    ds_read_b128 v[180:183], v12 offset:3072
    ds_read_b128 v[184:187], v12 offset:5120
    v_mfma_f32_16x16x32_bf16 v[72:75], v[124:127], v[120:123], v[72:75]
    ds_read_b64_tr_b16 v[204:205], v15 offset:8192
    ds_read_b64_tr_b16 v[206:207], v15 offset:8704
    v_mfma_f32_16x16x32_bf16 v[64:67], v[140:143], v[128:131], v[64:67]
    ds_read_b128 v[192:195], v12 offset:12288
    ds_read_b128 v[196:199], v12 offset:14336
    v_mfma_f32_16x16x32_bf16 v[68:71], v[140:143], v[132:135], v[68:71]
    ds_read_b128 v[200:203], v12 offset:16384
    ds_read_b64_tr_b16 v[220:221], v15 offset:12288
    v_mfma_f32_16x16x32_bf16 v[72:75], v[140:143], v[136:139], v[72:75]
    ds_read_b64_tr_b16 v[222:223], v15 offset:12800
    v_mfma_f32_16x16x32_bf16 v[64:67], v[156:159], v[144:147], v[64:67]
    ds_read_b128 v[208:211], v12 offset:13312
    v_mfma_f32_16x16x32_bf16 v[68:71], v[156:159], v[148:151], v[68:71]
    ds_read_b128 v[212:215], v12 offset:15360
    v_mfma_f32_16x16x32_bf16 v[72:75], v[156:159], v[152:155], v[72:75]
    ds_read_b128 v[216:219], v12 offset:17408
    s_waitcnt vmcnt(2) lgkmcnt(0)
    s_barrier
    v_mfma_f32_16x16x32_bf16 v[64:67], v[172:175], v[160:163], v[64:67]
    s_add_u32 m0, s19, 0x18000
    ds_read_b64_tr_b16 v[108:109], v15 offset:16384
    ds_read_b64_tr_b16 v[110:111], v15 offset:16896
    v_mfma_f32_16x16x32_bf16 v[68:71], v[172:175], v[164:167], v[68:71]
    buffer_load_dwordx4 v20, s[48:51], s17 offen lds
    s_add_u32 s17, s17, 81920
    ds_read_b128 v[96:99], v12 offset:24576
    ds_read_b128 v[100:103], v12 offset:26624
    v_mfma_f32_16x16x32_bf16 v[72:75], v[172:175], v[168:171], v[72:75]
    ds_read_b128 v[104:107], v12 offset:28672
    ds_read_b64_tr_b16 v[124:125], v15 offset:20480
    v_mfma_f32_16x16x32_bf16 v[64:67], v[188:191], v[176:179], v[64:67]
    ds_read_b64_tr_b16 v[126:127], v15 offset:20992
    ds_read_b128 v[112:115], v12 offset:25600
    v_mfma_f32_16x16x32_bf16 v[68:71], v[188:191], v[180:183], v[68:71]
    ds_read_b128 v[116:119], v12 offset:27648
    ds_read_b128 v[120:123], v12 offset:29696
    v_mfma_f32_16x16x32_bf16 v[72:75], v[188:191], v[184:187], v[72:75]
    ds_read_b64_tr_b16 v[140:141], v15 offset:24576
    ds_read_b64_tr_b16 v[142:143], v15 offset:25088
    v_mfma_f32_16x16x32_bf16 v[64:67], v[204:207], v[192:195], v[64:67]
    ds_read_b128 v[128:131], v12 offset:36864
    ds_read_b128 v[132:135], v12 offset:38912
    v_mfma_f32_16x16x32_bf16 v[68:71], v[204:207], v[196:199], v[68:71]
    ds_read_b128 v[136:139], v12 offset:40960
    ds_read_b64_tr_b16 v[156:157], v15 offset:28672
    v_mfma_f32_16x16x32_bf16 v[72:75], v[204:207], v[200:203], v[72:75]
    ds_read_b64_tr_b16 v[158:159], v15 offset:29184
    v_mfma_f32_16x16x32_bf16 v[64:67], v[220:223], v[208:211], v[64:67]
    ds_read_b128 v[144:147], v12 offset:37888
    v_mfma_f32_16x16x32_bf16 v[68:71], v[220:223], v[212:215], v[68:71]
    ds_read_b128 v[148:151], v12 offset:39936
    v_mfma_f32_16x16x32_bf16 v[72:75], v[220:223], v[216:219], v[72:75]
    ds_read_b128 v[152:155], v12 offset:41984
    s_waitcnt vmcnt(1) lgkmcnt(0)
    s_barrier
    v_mfma_f32_16x16x32_bf16 v[64:67], v[108:111], v[96:99], v[64:67]
    ds_read_b64_tr_b16 v[172:173], v15 offset:32768
    ds_read_b64_tr_b16 v[174:175], v15 offset:33280
    v_mfma_f32_16x16x32_bf16 v[68:71], v[108:111], v[100:103], v[68:71]
    ds_read_b128 v[160:163], v12 offset:49152
    ds_read_b128 v[164:167], v12 offset:51200
    v_mfma_f32_16x16x32_bf16 v[72:75], v[108:111], v[104:107], v[72:75]
    ds_read_b128 v[168:171], v12 offset:53248
    ds_read_b64_tr_b16 v[188:189], v15 offset:36864
    v_mfma_f32_16x16x32_bf16 v[64:67], v[124:127], v[112:115], v[64:67]
    ds_read_b64_tr_b16 v[190:191], v15 offset:37376
    ds_read_b128 v[176:179], v12 offset:50176
    v_mfma_f32_16x16x32_bf16 v[68:71], v[124:127], v[116:119], v[68:71]
    ds_read_b128 v[180:183], v12 offset:52224
    ds_read_b128 v[184:187], v12 offset:54272
    v_mfma_f32_16x16x32_bf16 v[72:75], v[124:127], v[120:123], v[72:75]
    ds_read_b64_tr_b16 v[204:205], v15 offset:40960
    ds_read_b64_tr_b16 v[206:207], v15 offset:41472
    v_mfma_f32_16x16x32_bf16 v[64:67], v[140:143], v[128:131], v[64:67]
    ds_read_b128 v[192:195], v12 offset:61440
    ds_read_b128 v[196:199], v12 offset:63488
    v_mfma_f32_16x16x32_bf16 v[68:71], v[140:143], v[132:135], v[68:71]
    ds_read_b128 v[200:203], v13 offset:0
    ds_read_b64_tr_b16 v[220:221], v15 offset:45056
    v_mfma_f32_16x16x32_bf16 v[72:75], v[140:143], v[136:139], v[72:75]
    ds_read_b64_tr_b16 v[222:223], v15 offset:45568
    v_mfma_f32_16x16x32_bf16 v[64:67], v[156:159], v[144:147], v[64:67]
    ds_read_b128 v[208:211], v12 offset:62464
    v_mfma_f32_16x16x32_bf16 v[68:71], v[156:159], v[148:151], v[68:71]
    ds_read_b128 v[212:215], v12 offset:64512
    v_mfma_f32_16x16x32_bf16 v[72:75], v[156:159], v[152:155], v[72:75]
    ds_read_b128 v[216:219], v13 offset:1024
    s_waitcnt vmcnt(0) lgkmcnt(0)
    s_barrier
    v_mfma_f32_16x16x32_bf16 v[64:67], v[172:175], v[160:163], v[64:67]
    ds_read_b64_tr_b16 v[108:109], v15 offset:0
    v_mfma_f32_16x16x32_bf16 v[68:71], v[172:175], v[164:167], v[68:71]
    ds_read_b64_tr_b16 v[110:111], v15 offset:512
    v_mfma_f32_16x16x32_bf16 v[72:75], v[172:175], v[168:171], v[72:75]
    ds_read_b128 v[96:99], v12 offset:0
    v_mfma_f32_16x16x32_bf16 v[64:67], v[188:191], v[176:179], v[64:67]
    ds_read_b128 v[100:103], v12 offset:2048
    v_mfma_f32_16x16x32_bf16 v[68:71], v[188:191], v[180:183], v[68:71]
    ds_read_b128 v[104:107], v12 offset:4096
    v_mfma_f32_16x16x32_bf16 v[72:75], v[188:191], v[184:187], v[72:75]
    ds_read_b64_tr_b16 v[124:125], v15 offset:4096
    v_mfma_f32_16x16x32_bf16 v[64:67], v[204:207], v[192:195], v[64:67]
    ds_read_b64_tr_b16 v[126:127], v15 offset:4608
    v_mfma_f32_16x16x32_bf16 v[68:71], v[204:207], v[196:199], v[68:71]
    ds_read_b128 v[112:115], v12 offset:1024
    v_mfma_f32_16x16x32_bf16 v[72:75], v[204:207], v[200:203], v[72:75]
    ds_read_b128 v[116:119], v12 offset:3072
    v_mfma_f32_16x16x32_bf16 v[64:67], v[220:223], v[208:211], v[64:67]
    ds_read_b128 v[120:123], v12 offset:5120
    v_mfma_f32_16x16x32_bf16 v[68:71], v[220:223], v[212:215], v[68:71]
    v_mfma_f32_16x16x32_bf16 v[72:75], v[220:223], v[216:219], v[72:75]
    s_waitcnt lgkmcnt(0)
    s_barrier
    v_mfma_f32_16x16x32_bf16 v[64:67], v[108:111], v[96:99], v[64:67]
    v_mfma_f32_16x16x32_bf16 v[68:71], v[108:111], v[100:103], v[68:71]
    v_mfma_f32_16x16x32_bf16 v[72:75], v[108:111], v[104:107], v[72:75]
    v_mfma_f32_16x16x32_bf16 v[64:67], v[124:127], v[112:115], v[64:67]
    v_mfma_f32_16x16x32_bf16 v[68:71], v[124:127], v[116:119], v[68:71]
    v_mfma_f32_16x16x32_bf16 v[72:75], v[124:127], v[120:123], v[72:75]
L_k2_epi:
    s_mov_b32 s37, 0xffff0000
    s_nop 7
    v_lshlrev_b32 v96, 16, v28
    v_and_b32 v97, s37, v28
    v_add_f32 v64, v64, v96
    v_add_f32 v65, v65, v97
    v_lshlrev_b32 v96, 16, v29
    v_and_b32 v97, s37, v29
    v_add_f32 v66, v66, v96
    v_add_f32 v67, v67, v97
    v_cvt_pk_bf16_f32 v28, v64, v65
    v_cvt_pk_bf16_f32 v29, v66, v67
    v_lshlrev_b32 v96, 16, v30
    v_and_b32 v97, s37, v30
    v_add_f32 v68, v68, v96
    v_add_f32 v69, v69, v97
    v_lshlrev_b32 v96, 16, v31
    v_and_b32 v97, s37, v31
    v_add_f32 v70, v70, v96
    v_add_f32 v71, v71, v97
    v_cvt_pk_bf16_f32 v30, v68, v69
    v_cvt_pk_bf16_f32 v31, v70, v71
    v_lshlrev_b32 v96, 16, v32
    v_and_b32 v97, s37, v32
    v_add_f32 v72, v72, v96
    v_add_f32 v73, v73, v97
    v_lshlrev_b32 v96, 16, v33
    v_and_b32 v97, s37, v33
    v_add_f32 v74, v74, v96
    v_add_f32 v75, v75, v97
    v_cvt_pk_bf16_f32 v32, v72, v73
    v_cvt_pk_bf16_f32 v33, v74, v75
    buffer_store_dwordx2 v[28:29], v26, s[8:11], 0 offen
    buffer_store_dwordx2 v[30:31], v26, s[8:11], s38 offen
    s_sub_u32 s37, s27, s35
    s_cmp_eq_u32 s37, 4
    s_cbranch_scc1 L_k2_fl
    buffer_store_dwordx2 v[32:33], v26, s[8:11], s39 offen
L_k2_fl:
L_p2_end:
L_k1_end:
    s_endpgm
L_code_end:
.section .rodata,"a"
.p2align 6
.amdhsa_kernel parallel_sum__sliding_local_dilated__geglu_ffn__prompt_kernel
  .amdhsa_next_free_vgpr 256
  .amdhsa_next_free_sgpr 80
  .amdhsa_accum_offset 256
  .amdhsa_group_segment_fixed_size 0
  .amdhsa_kernarg_size 80
  .amdhsa_user_sgpr_count 2
  .amdhsa_user_sgpr_kernarg_segment_ptr 1
  .amdhsa_system_sgpr_workgroup_id_x 1
.end_amdhsa_kernel
```
